```python
import torch

def _softmax(x, axis=-1):
    return torch.softmax(x, dim=axis)
def _gelu(x):
    return torch.nn.functional.gelu(x, approximate="tanh")
def _silu(x):
    return torch.nn.functional.silu(x)
def _sigmoid(x):
    return torch.sigmoid(x)
def _layernorm(x, axis=-1, eps=1e-5):
    m = x.mean(dim=axis, keepdim=True)
    v = x.var(dim=axis, keepdim=True, unbiased=False)
    return (x - m) / torch.sqrt(v + eps)
def _scatter_add(tgt, idx, src, axis=0):
    return tgt.clone().index_add_(axis, idx, src)
def _segment_sum(src, seg, n):
    out = torch.zeros((n,) + src.shape[1:], dtype=src.dtype)
    return out.index_add_(0, seg, src)
def _pad(x, pw):
    flat = tuple(v for pair in reversed(pw) for v in pair)
    return torch.nn.functional.pad(x, flat)

kernel_name = 'sequential_preLN__softmax_full_mha__geglu_ffn__prompt'

def setup_inputs():

    _w = (lambda a: (lambda t: t.to(torch.bfloat16) if t.is_floating_point() else t)(torch.as_tensor(a)))
    def _A_setup():
        B, S, D = 1, 2048, 640
        return {
            "x": _w((lambda *s: torch.randn(*s, dtype=torch.bfloat16) * 0.05)(B, S, D)),
            "wqkv": _w((lambda *s: torch.randn(*s, dtype=torch.bfloat16) * 0.05)(D, 3 * D)),
            "wo": _w((lambda *s: torch.randn(*s, dtype=torch.bfloat16) * 0.05)(D, D)),
        }
    _A_in = _A_setup()

    def _B_setup():
        B, S, D, F = 1, 2048, 640, 1536
        return {
            "x": _w((lambda *s: torch.randn(*s, dtype=torch.bfloat16) * 0.05)(B, S, D)),
            "w_gate": _w((lambda *s: torch.randn(*s, dtype=torch.bfloat16) * 0.05)(D, F)),
            "w_up": _w((lambda *s: torch.randn(*s, dtype=torch.bfloat16) * 0.05)(D, F)),
            "w_down": _w((lambda *s: torch.randn(*s, dtype=torch.bfloat16) * 0.05)(F, D)),
        }
    _B_in = _B_setup()

    return {
        "A_x": _A_in["x"],
        "A_wqkv": _A_in["wqkv"],
        "A_wo": _A_in["wo"],
        "B_x": _B_in["x"],
        "B_w_gate": _B_in["w_gate"],
        "B_w_up": _B_in["w_up"],
        "B_w_down": _B_in["w_down"],
    }

def reference(A_x, A_wqkv, A_wo, B_x, B_w_gate, B_w_up, B_w_down):
    def _A_ref(x, wqkv, wo):
        B, S, D = x.shape
        H = 32; Dh = D // H
        qkv = (lambda x, *d: x.permute(*d))((x @ wqkv).reshape(B, S, 3, H, Dh), 2, 0, 3, 1, 4)
        q, k, v = qkv[0], qkv[1], qkv[2]
        scale = Dh ** -0.5
        scores = torch.einsum("bhqd,bhkd->bhqk", q, k) * scale
        p = _softmax(scores, axis=-1)
        o = torch.einsum("bhqk,bhkd->bhqd", p, v)
        return (lambda x, *d: x.permute(*d))(o, 0, 2, 1, 3).reshape(B, S, D) @ wo

    def _B_ref(x, w_gate, w_up, w_down):
        return (_gelu(x @ w_gate) * (x @ w_up)) @ w_down

    x = A_x
    h = x + _A_ref(_layernorm(x, axis=-1), A_wqkv, A_wo)
    h2 = h + _B_ref(_layernorm(h, axis=-1), B_w_gate, B_w_up, B_w_down)
    return h2
```

```asm
; @launch grid=(256,1,1) block=(512,1,1) lds=163840
.amdgcn_target "amdgcn-amd-amdhsa--gfx950"
.text
.globl sequential_preLN__softmax_full_mha__geglu_ffn__prompt_kernel
.p2align 8
.type sequential_preLN__softmax_full_mha__geglu_ffn__prompt_kernel,@function
sequential_preLN__softmax_full_mha__geglu_ffn__prompt_kernel:
    s_cmp_ge_u32 s2, 256
    s_cbranch_scc1 F_end
    s_load_dwordx4 s[4:7], s[0:1], 0
    s_load_dwordx4 s[60:63], s[0:1], 64
    s_getpc_b64 s[10:11]
A_pc:
    s_lshr_b32 s3, s2, 3
    s_lshl_b32 s3, s3, 11
    v_lshlrev_b32 v1, 7, v0
    v_add_u32 v1, s3, v1
    v_min_u32 v1, F_kend-A_pc-4, v1
    v_cmp_gt_u32 vcc, 16, v0
    s_and_saveexec_b64 s[12:13], vcc
    s_cbranch_execz A_nopf
    global_load_dword v255, v1, s[10:11]
A_nopf:
    s_mov_b64 exec, s[12:13]
    v_lshrrev_b32 v1, 6, v0
    v_and_b32 v2, 63, v0
    s_and_b32 s3, s2, 7
    v_readfirstlane_b32 s24, v1
    s_lshr_b32 s10, s2, 3
    s_and_b32 s11, s10, 3
    s_lshr_b32 s10, s10, 2
    s_lshr_b32 s27, s3, 1
    s_lshl_b32 s27, s27, 2
    s_add_u32 s27, s27, s11
    s_and_b32 s28, s3, 1
    s_mul_i32 s28, s28, 6
    s_add_u32 s28, s28, s10
    v_and_b32 v3, 31, v2
    v_lshrrev_b32 v4, 5, v2
    s_mov_b32 s22, 23805952
    s_mov_b32 s23, 0x20000
    s_mov_b32 s14, 2621440
    s_mov_b32 s15, 0x20000
    s_mov_b32 s18, 2457600
    s_mov_b32 s19, 0x20000
    s_sub_u32 s25, s24, 4
    s_cmp_ge_u32 s10, 6
    s_cbranch_scc1 A_pack
    s_cmp_lt_u32 s24, 4
    s_cbranch_scc1 A_comp
    s_mul_i32 s31, s11, 15
    s_mul_i32 s10, s10, 10
    s_add_u32 s31, s31, s10
    s_mul_i32 s31, s31, 43
    s_lshr_b32 s31, s31, 8
    s_sub_u32 s11, s31, 10
    s_cmp_ge_u32 s31, 10
    s_cselect_b32 s31, s11, s31
    s_lshl_b32 s29, s27, 7
    s_lshl_b32 s11, s25, 5
    s_add_u32 s29, s29, s11
    s_mul_i32 s29, s29, 1280
    s_mul_i32 s30, s25, 61440
    s_mul_i32 s11, s28, 320
    s_add_u32 s30, s30, s11
    s_lshl_b32 s33, s25, 12
    s_lshl_b32 s32, s25, 10
    s_add_u32 s32, s32, 16384
    v_lshrrev_b32 v17, 3, v2
    v_mul_u32_u24 v5, 1280, v17
    v_lshrrev_b32 v17, 4, v2
    v_and_b32 v6, 7, v2
    v_xor_b32 v6, v6, v17
    v_lshl_add_u32 v8, v6, 4, v5
    v_xor_b32 v6, 4, v6
    v_lshl_add_u32 v9, v6, 4, v5
    v_add_u32 v9, 9216, v9
    v_add_u32 v10, 18432, v8
    v_add_u32 v11, 18432, v9
    v_add_u32 v5, 0, v2
    v_mul_u32_u24 v6, 205, v5
    v_lshrrev_b32 v6, 12, v6
    v_mul_u32_u24 v7, 20, v6
    v_sub_u32 v5, v5, v7
    v_mul_u32_u24 v6, 3840, v6
    v_lshl_add_u32 v12, v5, 4, v6
    v_add_u32 v5, 64, v2
    v_mul_u32_u24 v6, 205, v5
    v_lshrrev_b32 v6, 12, v6
    v_mul_u32_u24 v7, 20, v6
    v_sub_u32 v5, v5, v7
    v_mul_u32_u24 v6, 3840, v6
    v_lshl_add_u32 v13, v5, 4, v6
    v_subrev_u32 v13, 1024, v13
    v_add_u32 v5, 128, v2
    v_mul_u32_u24 v6, 205, v5
    v_lshrrev_b32 v6, 12, v6
    v_mul_u32_u24 v7, 20, v6
    v_sub_u32 v5, v5, v7
    v_mul_u32_u24 v6, 3840, v6
    v_lshl_add_u32 v14, v5, 4, v6
    v_subrev_u32 v14, 2048, v14
    v_add_u32 v5, 192, v2
    v_mul_u32_u24 v6, 205, v5
    v_lshrrev_b32 v6, 12, v6
    v_mul_u32_u24 v7, 20, v6
    v_sub_u32 v5, v5, v7
    v_mul_u32_u24 v6, 3840, v6
    v_lshl_add_u32 v15, v5, 4, v6
    v_subrev_u32 v15, 3072, v15
    v_add_u32 v5, 256, v2
    v_mul_u32_u24 v6, 205, v5
    v_lshrrev_b32 v6, 12, v6
    v_mul_u32_u24 v7, 20, v6
    v_sub_u32 v5, v5, v7
    v_mul_u32_u24 v6, 3840, v6
    v_lshl_add_u32 v16, v5, 4, v6
    s_waitcnt lgkmcnt(0)
    s_mov_b32 s12, s4
    s_mov_b32 s13, s5
    s_mov_b32 s16, s6
    s_mov_b32 s17, s7
    s_mov_b32 s20, s62
    s_mov_b32 s21, s63
    s_branch A_l0
A_dma:
    s_lshl_b32 s10, s31, 7
    s_add_u32 s10, s10, s29
    s_mul_i32 s11, s31, 245760
    s_mov_b32 m0, s33
    s_add_u32 s11, s11, s30
    buffer_load_dwordx4 v8, s[12:15], s10 offen lds
    buffer_load_dwordx4 v9, s[12:15], s10 offen offset:1024 lds
    buffer_load_dwordx4 v10, s[12:15], s10 offen offset:2048 lds
    buffer_load_dwordx4 v11, s[12:15], s10 offen offset:3072 lds
    s_add_u32 m0, s33, s32
    s_add_u32 s31, s31, 1
    buffer_load_dwordx4 v12, s[16:19], s11 offen lds
    buffer_load_dwordx4 v13, s[16:19], s11 offen offset:1024 lds
    buffer_load_dwordx4 v14, s[16:19], s11 offen offset:2048 lds
    buffer_load_dwordx4 v15, s[16:19], s11 offen offset:3072 lds
    s_add_u32 m0, m0, 4096
    s_cmp_eq_u32 s31, 10
    buffer_load_dwordx4 v16, s[16:19], s11 offen lds
    s_cselect_b32 s31, 0, s31
    s_add_u32 s33, s33, 36864
    s_sub_u32 s10, s33, 147456
    s_cmp_ge_u32 s33, 147456
    s_cselect_b32 s33, s10, s33
    s_setpc_b64 s[34:35]
A_l0:
    s_mov_b32 s56, s60
    s_mov_b32 s57, s61
    s_mov_b32 s58, 256
    s_mov_b32 s59, 0x20000
    v_mov_b32 v18, 0
    s_cmp_lg_u32 s2, 0
    s_cbranch_scc1 A_z1
    s_cmp_lg_u32 s24, 4
    s_cbranch_scc1 A_z1
    s_memrealtime s[10:11]
    s_waitcnt lgkmcnt(0)
    s_or_b32 s11, s11, 0x80000000
    v_mov_b32 v24, s10
    v_mov_b32 v25, s11
    v_mov_b32 v26, 0
    v_mov_b32 v27, 0
    s_mov_b64 exec, 1
    buffer_atomic_cmpswap_x2 v[24:27], v18, s[56:59], 0 offen sc1
    s_mov_b64 exec, -1
A_z1:
    s_call_b64 s[34:35], A_dma
    s_call_b64 s[34:35], A_dma
    s_lshl_b32 s36, s2, 2
    s_add_u32 s36, s36, s25
    s_mul_i32 s37, s36, 2560
    v_mul_u32_u24 v5, 1280, v4
    v_lshl_add_u32 v5, v3, 4, v5
    v_cmp_gt_u32 vcc, 16, v3
    v_mov_b32 v6, 0x40000000
    buffer_load_dwordx4 v[32:35], v5, s[12:15], s37 offen
    v_cndmask_b32 v6, v6, v5, vcc
    buffer_load_dwordx4 v[36:39], v5, s[12:15], s37 offen offset:512
    buffer_load_dwordx4 v[40:43], v6, s[12:15], s37 offen offset:1024
    buffer_load_dwordx2 v[24:25], v18, s[56:59], 0 offen sc1
    s_waitcnt vmcnt(13)
    s_barrier
    s_call_b64 s[34:35], A_dma
    s_waitcnt vmcnt(13)
    s_barrier
    s_call_b64 s[34:35], A_dma
    s_waitcnt vmcnt(18)
    s_mov_b32 s11, 0x40000
A_tk:
    v_cmp_gt_i32 vcc, 0, v25
    s_cbranch_vccnz A_tk_ok
    buffer_load_dwordx2 v[24:25], v18, s[56:59], 0 offen sc1
    s_sub_u32 s11, s11, 1
    s_waitcnt vmcnt(0)
    s_cmp_lg_u32 s11, 0
    s_cbranch_scc1 A_tk
A_tk_ok:
    v_readfirstlane_b32 s98, v24
    v_readfirstlane_b32 s99, v25
    s_mov_b32 s38, 0x3f803f80
    v_mov_b32 v20, 0
    v_mov_b32 v21, 0
    v_dot2c_f32_bf16 v20, s38, v32
    v_dot2c_f32_bf16 v21, v32, v32
    v_dot2c_f32_bf16 v20, s38, v33
    v_dot2c_f32_bf16 v21, v33, v33
    v_dot2c_f32_bf16 v20, s38, v34
    v_dot2c_f32_bf16 v21, v34, v34
    v_dot2c_f32_bf16 v20, s38, v35
    v_dot2c_f32_bf16 v21, v35, v35
    v_dot2c_f32_bf16 v20, s38, v36
    v_dot2c_f32_bf16 v21, v36, v36
    v_dot2c_f32_bf16 v20, s38, v37
    v_dot2c_f32_bf16 v21, v37, v37
    v_dot2c_f32_bf16 v20, s38, v38
    v_dot2c_f32_bf16 v21, v38, v38
    v_dot2c_f32_bf16 v20, s38, v39
    v_dot2c_f32_bf16 v21, v39, v39
    v_dot2c_f32_bf16 v20, s38, v40
    v_dot2c_f32_bf16 v21, v40, v40
    v_dot2c_f32_bf16 v20, s38, v41
    v_dot2c_f32_bf16 v21, v41, v41
    v_dot2c_f32_bf16 v20, s38, v42
    v_dot2c_f32_bf16 v21, v42, v42
    v_dot2c_f32_bf16 v20, s38, v43
    v_dot2c_f32_bf16 v21, v43, v43
    s_nop 3
    v_add_f32_dpp v20, v20, v20 quad_perm:[1,0,3,2] row_mask:0xf bank_mask:0xf
    v_add_f32_dpp v21, v21, v21 quad_perm:[1,0,3,2] row_mask:0xf bank_mask:0xf
    s_nop 1
    v_add_f32_dpp v20, v20, v20 quad_perm:[2,3,0,1] row_mask:0xf bank_mask:0xf
    v_add_f32_dpp v21, v21, v21 quad_perm:[2,3,0,1] row_mask:0xf bank_mask:0xf
    s_nop 1
    v_add_f32_dpp v20, v20, v20 row_half_mirror row_mask:0xf bank_mask:0xf
    v_add_f32_dpp v21, v21, v21 row_half_mirror row_mask:0xf bank_mask:0xf
    s_nop 1
    v_add_f32_dpp v20, v20, v20 row_mirror row_mask:0xf bank_mask:0xf
    v_add_f32_dpp v21, v21, v21 row_mirror row_mask:0xf bank_mask:0xf
    s_nop 1
    v_mov_b32 v22, v20
    v_mov_b32 v23, v21
    s_nop 1
    v_permlane16_swap_b32 v20, v22
    v_permlane16_swap_b32 v21, v23
    s_nop 1
    v_add_f32 v20, v20, v22
    v_add_f32 v21, v21, v23
    v_mul_f32 v20, 0x3acccccd, v20
    v_mul_f32 v21, 0x3acccccd, v21
    v_fma_f32 v21, -v20, v20, v21
    v_max_f32 v21, 0, v21
    v_add_f32 v21, 0x3727c5ac, v21
    v_rsq_f32 v22, v21
    s_lshl_b32 s36, s36, 5
    s_add_u32 s36, s36, 17022976
    v_lshlrev_b32 v5, 4, v4
    v_mul_f32 v23, v20, v22
    v_sub_f32 v23, 0, v23
    s_mov_b32 exec_lo, 1
    s_mov_b32 exec_hi, 1
    buffer_store_dwordx4 v[22:25], v5, s[20:23], s36 offen sc1
    s_mov_b64 exec, -1
    s_waitcnt vmcnt(10)
    s_barrier
    s_call_b64 s[34:35], A_dma
    s_waitcnt vmcnt(10)
    s_barrier
    s_call_b64 s[34:35], A_dma
    s_waitcnt vmcnt(9)
    s_barrier
    s_call_b64 s[34:35], A_dma
    s_waitcnt vmcnt(9)
    s_barrier
    s_call_b64 s[34:35], A_dma
    s_waitcnt vmcnt(9)
    s_barrier
    s_call_b64 s[34:35], A_dma
    s_waitcnt vmcnt(9)
    s_barrier
    s_call_b64 s[34:35], A_dma
    s_lshl_b32 s37, s27, 2
    s_add_u32 s37, s37, s25
    s_lshl_b32 s37, s37, 9
    s_add_u32 s37, s37, 17022976
    v_lshlrev_b32 v19, 4, v3
    s_lshl_b32 s39, s28, 2
    s_add_u32 s39, s39, s25
    s_mul_i32 s39, s39, 320
    s_add_u32 s39, s39, 17055744
    v_min_u32 v5, 19, v3
    v_lshlrev_b32 v5, 4, v5
    v_mul_u32_u24 v6, 15360, v4
    v_add_u32 v17, v5, v6
    buffer_load_dwordx4 v[28:31], v19, s[20:23], s37 offen sc1
    buffer_load_dwordx4 v[32:35], v17, s[20:23], s39 offen sc1
    s_waitcnt vmcnt(11)
    s_barrier
    s_cmp_lt_u32 s28, 4
    s_cselect_b32 s10, 0x3ea52b5c, 1.0
    s_lshl_b32 s11, s25, 7
    s_add_u32 s11, s11, 147456
    v_lshl_add_u32 v6, v3, 2, s11
    s_lshl_b32 s11, s25, 8
    s_add_u32 s11, s11, 148480
    v_lshl_add_u32 v7, v3, 3, s11
    s_mul_i32 s11, s25, 160
    s_add_u32 s11, s11, 149504
    v_lshrrev_b32 v5, 1, v5
    v_add_u32 v5, s11, v5
    v_mov_b32 v26, 150528
    s_waitcnt vmcnt(2)
    s_barrier
    s_mov_b32 s11, 0x40000
    s_waitcnt vmcnt(0)
A_rk:
    v_cmp_ne_u64 vcc, s[98:99], v[30:31]
    s_mov_b64 s[52:53], vcc
    v_cmp_ne_u64 vcc, s[98:99], v[34:35]
    s_or_b64 s[52:53], s[52:53], vcc
    s_cbranch_scc0 A_rk_ok
    buffer_load_dwordx4 v[28:31], v19, s[20:23], s37 offen sc1
    buffer_load_dwordx4 v[32:35], v17, s[20:23], s39 offen sc1
    s_sub_u32 s11, s11, 1
    s_waitcnt vmcnt(0)
    s_cmp_lg_u32 s11, 0
    s_cbranch_scc1 A_rk
A_rk_ok:
    v_mov_b32 v36, v32
    v_mov_b32 v37, v33
    v_mul_f32 v28, s10, v28
    v_mul_f32 v29, s10, v29
    v_permlane32_swap_b32 v32, v36
    v_permlane32_swap_b32 v33, v37
    ds_write_b32 v6, v28
    ds_write_b32 v6, v29 offset:512
    v_add_f32 v32, v32, v36
    v_add_f32 v33, v33, v37
    ds_write_b64 v7, v[28:29]
    ds_write_b64 v26, v[30:31]
    ds_write_b64 v5, v[32:33]
    s_waitcnt lgkmcnt(0)
    s_barrier
    s_branch F_main
A_comp:
    s_mov_b32 s36, 36864
    s_mov_b32 s34, 0
    v_bfe_u32 v5, v2, 1, 3
    v_xor_b32 v5, v5, v4
    v_lshlrev_b32 v5, 4, v5
    v_lshl_add_u32 v5, v3, 7, v5
    s_lshl_b32 s10, s24, 12
    v_add_u32 v8, s10, v5
    v_xor_b32 v9, 32, v8
    v_xor_b32 v10, 64, v8
    v_xor_b32 v11, 96, v8
    v_bfe_u32 v5, v2, 2, 2
    v_lshl_add_u32 v6, v4, 3, v5
    v_mul_u32_u24 v6, 320, v6
    v_bfe_u32 v7, v2, 4, 1
    v_lshl_add_u32 v6, v7, 5, v6
    v_add_u32 v12, 16384, v6
    s_and_b32 s42, s28, 3
    s_lshl_b32 s43, s27, 2
    s_add_u32 s43, s43, s24
    s_waitcnt lgkmcnt(0)
    s_mov_b32 s20, s62
    s_mov_b32 s21, s63
    v_mov_b32 v20, 0
    v_mov_b32 v21, 0
    v_mov_b32 v22, 0
    v_mov_b32 v23, 0
    v_mov_b32 v44, 0
    v_mov_b32 v45, 0
    v_mov_b32 v46, 0
    v_mov_b32 v47, 0
    v_mov_b32 v48, 0
    v_mov_b32 v49, 0
    v_mov_b32 v50, 0
    v_mov_b32 v51, 0
    v_mov_b32 v52, 0
    v_mov_b32 v53, 0
    v_mov_b32 v54, 0
    v_mov_b32 v55, 0
    v_mov_b32 v56, 0
    v_mov_b32 v57, 0
    v_mov_b32 v58, 0
    v_mov_b32 v59, 0
    v_mov_b32 v60, 0
    v_mov_b32 v61, 0
    v_mov_b32 v62, 0
    v_mov_b32 v63, 0
    v_mov_b32 v64, 0
    v_mov_b32 v65, 0
    v_mov_b32 v66, 0
    v_mov_b32 v67, 0
    v_mov_b32 v68, 0
    v_mov_b32 v69, 0
    v_mov_b32 v70, 0
    v_mov_b32 v71, 0
    v_mov_b32 v72, 0
    v_mov_b32 v73, 0
    v_mov_b32 v74, 0
    v_mov_b32 v75, 0
    v_mov_b32 v76, 0
    v_mov_b32 v77, 0
    v_mov_b32 v78, 0
    v_mov_b32 v79, 0
    v_mov_b32 v80, 0
    v_mov_b32 v81, 0
    v_mov_b32 v82, 0
    v_mov_b32 v83, 0
    v_mov_b32 v84, 0
    v_mov_b32 v85, 0
    v_mov_b32 v86, 0
    v_mov_b32 v87, 0
    v_mov_b32 v88, 0
    v_mov_b32 v89, 0
    v_mov_b32 v90, 0
    v_mov_b32 v91, 0
    v_mov_b32 v92, 0
    v_mov_b32 v93, 0
    v_mov_b32 v94, 0
    v_mov_b32 v95, 0
    v_mov_b32 v96, 0
    v_mov_b32 v97, 0
    v_mov_b32 v98, 0
    v_mov_b32 v99, 0
    v_mov_b32 v100, 0
    v_mov_b32 v101, 0
    v_mov_b32 v102, 0
    v_mov_b32 v103, 0
    v_mov_b32 v104, 0
    v_mov_b32 v105, 0
    v_mov_b32 v106, 0
    v_mov_b32 v107, 0
    v_mov_b32 v108, 0
    v_mov_b32 v109, 0
    v_mov_b32 v110, 0
    v_mov_b32 v111, 0
    v_mov_b32 v112, 0
    v_mov_b32 v113, 0
    v_mov_b32 v114, 0
    v_mov_b32 v115, 0
    v_mov_b32 v116, 0
    v_mov_b32 v117, 0
    v_mov_b32 v118, 0
    v_mov_b32 v119, 0
    v_mov_b32 v120, 0
    v_mov_b32 v121, 0
    v_mov_b32 v122, 0
    v_mov_b32 v123, 0
    v_mov_b32 v124, 0
    v_mov_b32 v125, 0
    v_mov_b32 v126, 0
    v_mov_b32 v127, 0
    v_mov_b32 v128, 0
    v_mov_b32 v129, 0
    v_mov_b32 v130, 0
    v_mov_b32 v131, 0
    v_mov_b32 v132, 0
    v_mov_b32 v133, 0
    v_mov_b32 v134, 0
    v_mov_b32 v135, 0
    v_mov_b32 v136, 0
    v_mov_b32 v137, 0
    v_mov_b32 v138, 0
    v_mov_b32 v139, 0
    v_mov_b32 v140, 0
    v_mov_b32 v141, 0
    v_mov_b32 v142, 0
    v_mov_b32 v143, 0
    s_cmp_ge_u32 s28, 8
    s_cbranch_scc1 A_preV
    v_and_b32 v7, 1, v2
    v_lshl_add_u32 v12, v7, 4, v12
    v_bfe_u32 v7, v2, 1, 1
    v_lshl_add_u32 v12, v7, 3, v12
    s_cmp_lt_u32 s28, 4
    s_cselect_b32 s46, 1, 2
    s_mul_i32 s45, s46, 81920
    s_mul_i32 s46, s46, 1280
    s_cselect_b32 s47, 5242880, 0
    s_mul_i32 s43, s43, s46
    s_add_u32 s43, s43, s47
    s_lshl_b32 s10, s42, 3
    s_mul_i32 s10, s10, s45
    s_add_u32 s43, s43, s10
    v_lshlrev_b32 v144, 4, v3
    v_lshlrev_b32 v145, 3, v3
    v_lshl_add_u32 v146, v4, 9, v144
    s_sub_u32 s10, s45, 512
    v_mul_lo_u32 v5, v4, s10
    v_add_u32 v147, v5, v144
A_loopQ:
    s_barrier
    s_waitcnt lgkmcnt(8)
    v_mfma_f32_32x32x16_bf16 v[64:79], v[44:47], v[20:23], v[64:79]
    ds_read_b128 v[16:19], v8
    ds_read_b64_tr_b16 v[24:25], v12 offset:0
    ds_read_b64_tr_b16 v[26:27], v12 offset:1280
    s_waitcnt lgkmcnt(9)
    v_mfma_f32_32x32x16_bf16 v[80:95], v[48:51], v[20:23], v[80:95]
    ds_read_b64_tr_b16 v[28:29], v12 offset:64
    ds_read_b64_tr_b16 v[30:31], v12 offset:1344
    s_waitcnt lgkmcnt(9)
    v_mfma_f32_32x32x16_bf16 v[96:111], v[52:55], v[20:23], v[96:111]
    ds_read_b64_tr_b16 v[32:33], v12 offset:128
    ds_read_b64_tr_b16 v[34:35], v12 offset:1408
    s_waitcnt lgkmcnt(9)
    v_mfma_f32_32x32x16_bf16 v[112:127], v[56:59], v[20:23], v[112:127]
    ds_read_b64_tr_b16 v[36:37], v12 offset:192
    ds_read_b64_tr_b16 v[38:39], v12 offset:1472
    s_waitcnt lgkmcnt(9)
    v_mfma_f32_32x32x16_bf16 v[128:143], v[60:63], v[20:23], v[128:143]
    ds_read_b64_tr_b16 v[40:41], v12 offset:256
    ds_read_b64_tr_b16 v[42:43], v12 offset:1536
    s_waitcnt lgkmcnt(8)
    v_mfma_f32_32x32x16_bf16 v[64:79], v[24:27], v[16:19], v[64:79]
    ds_read_b128 v[20:23], v9
    ds_read_b64_tr_b16 v[44:45], v12 offset:5120
    ds_read_b64_tr_b16 v[46:47], v12 offset:6400
    s_waitcnt lgkmcnt(9)
    v_mfma_f32_32x32x16_bf16 v[80:95], v[28:31], v[16:19], v[80:95]
    ds_read_b64_tr_b16 v[48:49], v12 offset:5184
    ds_read_b64_tr_b16 v[50:51], v12 offset:6464
    s_waitcnt lgkmcnt(9)
    v_mfma_f32_32x32x16_bf16 v[96:111], v[32:35], v[16:19], v[96:111]
    ds_read_b64_tr_b16 v[52:53], v12 offset:5248
    ds_read_b64_tr_b16 v[54:55], v12 offset:6528
    s_waitcnt lgkmcnt(9)
    v_mfma_f32_32x32x16_bf16 v[112:127], v[36:39], v[16:19], v[112:127]
    ds_read_b64_tr_b16 v[56:57], v12 offset:5312
    ds_read_b64_tr_b16 v[58:59], v12 offset:6592
    s_waitcnt lgkmcnt(9)
    v_mfma_f32_32x32x16_bf16 v[128:143], v[40:43], v[16:19], v[128:143]
    ds_read_b64_tr_b16 v[60:61], v12 offset:5376
    ds_read_b64_tr_b16 v[62:63], v12 offset:6656
    s_waitcnt lgkmcnt(8)
    v_mfma_f32_32x32x16_bf16 v[64:79], v[44:47], v[20:23], v[64:79]
    ds_read_b128 v[16:19], v10
    ds_read_b64_tr_b16 v[24:25], v12 offset:10240
    ds_read_b64_tr_b16 v[26:27], v12 offset:11520
    s_waitcnt lgkmcnt(9)
    v_mfma_f32_32x32x16_bf16 v[80:95], v[48:51], v[20:23], v[80:95]
    ds_read_b64_tr_b16 v[28:29], v12 offset:10304
    ds_read_b64_tr_b16 v[30:31], v12 offset:11584
    s_waitcnt lgkmcnt(9)
    v_mfma_f32_32x32x16_bf16 v[96:111], v[52:55], v[20:23], v[96:111]
    ds_read_b64_tr_b16 v[32:33], v12 offset:10368
    ds_read_b64_tr_b16 v[34:35], v12 offset:11648
    s_waitcnt lgkmcnt(9)
    v_mfma_f32_32x32x16_bf16 v[112:127], v[56:59], v[20:23], v[112:127]
    ds_read_b64_tr_b16 v[36:37], v12 offset:10432
    ds_read_b64_tr_b16 v[38:39], v12 offset:11712
    s_waitcnt lgkmcnt(9)
    v_mfma_f32_32x32x16_bf16 v[128:143], v[60:63], v[20:23], v[128:143]
    ds_read_b64_tr_b16 v[40:41], v12 offset:10496
    ds_read_b64_tr_b16 v[42:43], v12 offset:11776
    s_add_u32 s34, s34, 1
    s_and_b32 s10, s34, 3
    s_cmp_eq_u32 s10, 0
    s_cselect_b32 s35, 0xfffe5000, s36
    s_waitcnt lgkmcnt(8)
    v_mfma_f32_32x32x16_bf16 v[64:79], v[24:27], v[16:19], v[64:79]
    ds_read_b128 v[20:23], v11
    ds_read_b64_tr_b16 v[44:45], v12 offset:15360
    ds_read_b64_tr_b16 v[46:47], v12 offset:16640
    s_waitcnt lgkmcnt(9)
    v_mfma_f32_32x32x16_bf16 v[80:95], v[28:31], v[16:19], v[80:95]
    ds_read_b64_tr_b16 v[48:49], v12 offset:15424
    ds_read_b64_tr_b16 v[50:51], v12 offset:16704
    v_add_u32 v8, s35, v8
    s_waitcnt lgkmcnt(9)
    v_mfma_f32_32x32x16_bf16 v[96:111], v[32:35], v[16:19], v[96:111]
    ds_read_b64_tr_b16 v[52:53], v12 offset:15488
    ds_read_b64_tr_b16 v[54:55], v12 offset:16768
    v_add_u32 v9, s35, v9
    s_waitcnt lgkmcnt(9)
    v_mfma_f32_32x32x16_bf16 v[112:127], v[36:39], v[16:19], v[112:127]
    ds_read_b64_tr_b16 v[56:57], v12 offset:15552
    ds_read_b64_tr_b16 v[58:59], v12 offset:16832
    v_add_u32 v10, s35, v10
    s_waitcnt lgkmcnt(9)
    v_mfma_f32_32x32x16_bf16 v[128:143], v[40:43], v[16:19], v[128:143]
    ds_read_b64_tr_b16 v[60:61], v12 offset:15616
    ds_read_b64_tr_b16 v[62:63], v12 offset:16896
    v_add_u32 v11, s35, v11
    v_add_u32 v12, s35, v12
    s_cmp_lt_u32 s34, 10
    s_cbranch_scc1 A_loopQ
    s_waitcnt lgkmcnt(8)
    v_mfma_f32_32x32x16_bf16 v[64:79], v[44:47], v[20:23], v[64:79]
    s_waitcnt lgkmcnt(6)
    v_mfma_f32_32x32x16_bf16 v[80:95], v[48:51], v[20:23], v[80:95]
    s_waitcnt lgkmcnt(4)
    v_mfma_f32_32x32x16_bf16 v[96:111], v[52:55], v[20:23], v[96:111]
    s_waitcnt lgkmcnt(2)
    v_mfma_f32_32x32x16_bf16 v[112:127], v[56:59], v[20:23], v[112:127]
    s_waitcnt lgkmcnt(0)
    v_mfma_f32_32x32x16_bf16 v[128:143], v[60:63], v[20:23], v[128:143]
    s_lshl_b32 s10, s24, 8
    s_add_u32 s10, s10, 148480
    v_lshl_add_u32 v5, v3, 3, s10
    v_lshlrev_b32 v6, 5, v4
    v_add_u32 v6, 149504, v6
    s_barrier
    ds_read_b64 v[14:15], v5
    ds_read_b128 v[152:155], v6 offset:0
    ds_read_b128 v[156:159], v6 offset:16
    ds_read_b128 v[160:163], v6 offset:64
    ds_read_b128 v[164:167], v6 offset:80
    ds_read_b128 v[168:171], v6 offset:128
    ds_read_b128 v[172:175], v6 offset:144
    ds_read_b128 v[176:179], v6 offset:192
    ds_read_b128 v[180:183], v6 offset:208
    ds_read_b128 v[184:187], v6 offset:256
    ds_read_b128 v[188:191], v6 offset:272
    ds_read_b128 v[192:195], v6 offset:320
    ds_read_b128 v[196:199], v6 offset:336
    s_waitcnt lgkmcnt(10)
    ds_read_b128 v[200:203], v6 offset:384
    ds_read_b128 v[204:207], v6 offset:400
    v_pk_mul_f32 v[152:153], v[14:15], v[152:153] op_sel:[1,0] op_sel_hi:[1,1]
    v_pk_mul_f32 v[154:155], v[14:15], v[154:155] op_sel:[1,0] op_sel_hi:[1,1]
    v_pk_mul_f32 v[156:157], v[14:15], v[156:157] op_sel:[1,0] op_sel_hi:[1,1]
    v_pk_mul_f32 v[158:159], v[14:15], v[158:159] op_sel:[1,0] op_sel_hi:[1,1]
    v_pk_fma_f32 v[64:65], v[64:65], v[14:15], v[152:153] op_sel_hi:[1,0,1]
    v_pk_fma_f32 v[66:67], v[66:67], v[14:15], v[154:155] op_sel_hi:[1,0,1]
    v_pk_fma_f32 v[68:69], v[68:69], v[14:15], v[156:157] op_sel_hi:[1,0,1]
    v_pk_fma_f32 v[70:71], v[70:71], v[14:15], v[158:159] op_sel_hi:[1,0,1]
    s_mul_i32 s10, s45, 0
    s_add_u32 s10, s10, s43
    v_cvt_pk_bf16_f32 v64, v64, v65
    v_cvt_pk_bf16_f32 v65, v66, v67
    v_cvt_pk_bf16_f32 v66, v68, v69
    v_cvt_pk_bf16_f32 v67, v70, v71
    buffer_store_dwordx4 v[64:67], v146, s[20:23], s10 offen sc1
    s_waitcnt lgkmcnt(10)
    ds_read_b128 v[208:211], v6 offset:448
    ds_read_b128 v[212:215], v6 offset:464
    v_pk_mul_f32 v[160:161], v[14:15], v[160:161] op_sel:[1,0] op_sel_hi:[1,1]
    v_pk_mul_f32 v[162:163], v[14:15], v[162:163] op_sel:[1,0] op_sel_hi:[1,1]
    v_pk_mul_f32 v[164:165], v[14:15], v[164:165] op_sel:[1,0] op_sel_hi:[1,1]
    v_pk_mul_f32 v[166:167], v[14:15], v[166:167] op_sel:[1,0] op_sel_hi:[1,1]
    v_pk_fma_f32 v[72:73], v[72:73], v[14:15], v[160:161] op_sel_hi:[1,0,1]
    v_pk_fma_f32 v[74:75], v[74:75], v[14:15], v[162:163] op_sel_hi:[1,0,1]
    v_pk_fma_f32 v[76:77], v[76:77], v[14:15], v[164:165] op_sel_hi:[1,0,1]
    v_pk_fma_f32 v[78:79], v[78:79], v[14:15], v[166:167] op_sel_hi:[1,0,1]
    s_mul_i32 s10, s45, 1
    s_add_u32 s10, s10, s43
    v_cvt_pk_bf16_f32 v72, v72, v73
    v_cvt_pk_bf16_f32 v73, v74, v75
    v_cvt_pk_bf16_f32 v74, v76, v77
    v_cvt_pk_bf16_f32 v75, v78, v79
    s_mov_b32 exec_lo, 0
    buffer_store_dwordx4 v[72:75], v144, s[20:23], s10 offen offset:0 sc1
    s_not_b64 exec, exec
    s_mul_i32 s10, s45, 0
    s_add_u32 s10, s10, s43
    buffer_store_dwordx2 v[72:73], v145, s[20:23], s10 offen offset:1024 sc1
    s_add_u32 s10, s10, s45
    buffer_store_dwordx2 v[74:75], v145, s[20:23], s10 offen offset:1024 sc1
    s_mov_b64 exec, -1
    s_waitcnt lgkmcnt(10)
    ds_read_b128 v[216:219], v6 offset:512
    ds_read_b128 v[220:223], v6 offset:528
    v_pk_mul_f32 v[168:169], v[14:15], v[168:169] op_sel:[1,0] op_sel_hi:[1,1]
    v_pk_mul_f32 v[170:171], v[14:15], v[170:171] op_sel:[1,0] op_sel_hi:[1,1]
    v_pk_mul_f32 v[172:173], v[14:15], v[172:173] op_sel:[1,0] op_sel_hi:[1,1]
    v_pk_mul_f32 v[174:175], v[14:15], v[174:175] op_sel:[1,0] op_sel_hi:[1,1]
    v_pk_fma_f32 v[80:81], v[80:81], v[14:15], v[168:169] op_sel_hi:[1,0,1]
    v_pk_fma_f32 v[82:83], v[82:83], v[14:15], v[170:171] op_sel_hi:[1,0,1]
    v_pk_fma_f32 v[84:85], v[84:85], v[14:15], v[172:173] op_sel_hi:[1,0,1]
    v_pk_fma_f32 v[86:87], v[86:87], v[14:15], v[174:175] op_sel_hi:[1,0,1]
    s_mul_i32 s10, s45, 1
    s_add_u32 s10, s10, s43
    v_cvt_pk_bf16_f32 v80, v80, v81
    v_cvt_pk_bf16_f32 v81, v82, v83
    v_cvt_pk_bf16_f32 v82, v84, v85
    v_cvt_pk_bf16_f32 v83, v86, v87
    buffer_store_dwordx4 v[80:83], v147, s[20:23], s10 offen offset:512 sc1
    s_waitcnt lgkmcnt(10)
    ds_read_b128 v[224:227], v6 offset:576
    ds_read_b128 v[228:231], v6 offset:592
    v_pk_mul_f32 v[176:177], v[14:15], v[176:177] op_sel:[1,0] op_sel_hi:[1,1]
    v_pk_mul_f32 v[178:179], v[14:15], v[178:179] op_sel:[1,0] op_sel_hi:[1,1]
    v_pk_mul_f32 v[180:181], v[14:15], v[180:181] op_sel:[1,0] op_sel_hi:[1,1]
    v_pk_mul_f32 v[182:183], v[14:15], v[182:183] op_sel:[1,0] op_sel_hi:[1,1]
    v_pk_fma_f32 v[88:89], v[88:89], v[14:15], v[176:177] op_sel_hi:[1,0,1]
    v_pk_fma_f32 v[90:91], v[90:91], v[14:15], v[178:179] op_sel_hi:[1,0,1]
    v_pk_fma_f32 v[92:93], v[92:93], v[14:15], v[180:181] op_sel_hi:[1,0,1]
    v_pk_fma_f32 v[94:95], v[94:95], v[14:15], v[182:183] op_sel_hi:[1,0,1]
    s_mul_i32 s10, s45, 2
    s_add_u32 s10, s10, s43
    v_cvt_pk_bf16_f32 v88, v88, v89
    v_cvt_pk_bf16_f32 v89, v90, v91
    v_cvt_pk_bf16_f32 v90, v92, v93
    v_cvt_pk_bf16_f32 v91, v94, v95
    s_mov_b32 exec_hi, 0
    buffer_store_dwordx4 v[88:91], v144, s[20:23], s10 offen offset:512 sc1
    s_not_b64 exec, exec
    s_mul_i32 s10, s45, 2
    s_add_u32 s10, s10, s43
    buffer_store_dwordx2 v[88:89], v145, s[20:23], s10 offen offset:1024 sc1
    s_add_u32 s10, s10, s45
    buffer_store_dwordx2 v[90:91], v145, s[20:23], s10 offen offset:1024 sc1
    s_mov_b64 exec, -1
    s_waitcnt lgkmcnt(10)
    v_pk_mul_f32 v[184:185], v[14:15], v[184:185] op_sel:[1,0] op_sel_hi:[1,1]
    v_pk_mul_f32 v[186:187], v[14:15], v[186:187] op_sel:[1,0] op_sel_hi:[1,1]
    v_pk_mul_f32 v[188:189], v[14:15], v[188:189] op_sel:[1,0] op_sel_hi:[1,1]
    v_pk_mul_f32 v[190:191], v[14:15], v[190:191] op_sel:[1,0] op_sel_hi:[1,1]
    v_pk_fma_f32 v[96:97], v[96:97], v[14:15], v[184:185] op_sel_hi:[1,0,1]
    v_pk_fma_f32 v[98:99], v[98:99], v[14:15], v[186:187] op_sel_hi:[1,0,1]
    v_pk_fma_f32 v[100:101], v[100:101], v[14:15], v[188:189] op_sel_hi:[1,0,1]
    v_pk_fma_f32 v[102:103], v[102:103], v[14:15], v[190:191] op_sel_hi:[1,0,1]
    s_mul_i32 s10, s45, 3
    s_add_u32 s10, s10, s43
    v_cvt_pk_bf16_f32 v96, v96, v97
    v_cvt_pk_bf16_f32 v97, v98, v99
    v_cvt_pk_bf16_f32 v98, v100, v101
    v_cvt_pk_bf16_f32 v99, v102, v103
    buffer_store_dwordx4 v[96:99], v146, s[20:23], s10 offen sc1
    s_waitcnt lgkmcnt(8)
    v_pk_mul_f32 v[192:193], v[14:15], v[192:193] op_sel:[1,0] op_sel_hi:[1,1]
    v_pk_mul_f32 v[194:195], v[14:15], v[194:195] op_sel:[1,0] op_sel_hi:[1,1]
    v_pk_mul_f32 v[196:197], v[14:15], v[196:197] op_sel:[1,0] op_sel_hi:[1,1]
    v_pk_mul_f32 v[198:199], v[14:15], v[198:199] op_sel:[1,0] op_sel_hi:[1,1]
    v_pk_fma_f32 v[104:105], v[104:105], v[14:15], v[192:193] op_sel_hi:[1,0,1]
    v_pk_fma_f32 v[106:107], v[106:107], v[14:15], v[194:195] op_sel_hi:[1,0,1]
    v_pk_fma_f32 v[108:109], v[108:109], v[14:15], v[196:197] op_sel_hi:[1,0,1]
    v_pk_fma_f32 v[110:111], v[110:111], v[14:15], v[198:199] op_sel_hi:[1,0,1]
    s_mul_i32 s10, s45, 4
    s_add_u32 s10, s10, s43
    v_cvt_pk_bf16_f32 v104, v104, v105
    v_cvt_pk_bf16_f32 v105, v106, v107
    v_cvt_pk_bf16_f32 v106, v108, v109
    v_cvt_pk_bf16_f32 v107, v110, v111
    buffer_store_dwordx4 v[104:107], v146, s[20:23], s10 offen sc1
    s_waitcnt lgkmcnt(6)
    v_pk_mul_f32 v[200:201], v[14:15], v[200:201] op_sel:[1,0] op_sel_hi:[1,1]
    v_pk_mul_f32 v[202:203], v[14:15], v[202:203] op_sel:[1,0] op_sel_hi:[1,1]
    v_pk_mul_f32 v[204:205], v[14:15], v[204:205] op_sel:[1,0] op_sel_hi:[1,1]
    v_pk_mul_f32 v[206:207], v[14:15], v[206:207] op_sel:[1,0] op_sel_hi:[1,1]
    v_pk_fma_f32 v[112:113], v[112:113], v[14:15], v[200:201] op_sel_hi:[1,0,1]
    v_pk_fma_f32 v[114:115], v[114:115], v[14:15], v[202:203] op_sel_hi:[1,0,1]
    v_pk_fma_f32 v[116:117], v[116:117], v[14:15], v[204:205] op_sel_hi:[1,0,1]
    v_pk_fma_f32 v[118:119], v[118:119], v[14:15], v[206:207] op_sel_hi:[1,0,1]
    s_mul_i32 s10, s45, 5
    s_add_u32 s10, s10, s43
    v_cvt_pk_bf16_f32 v112, v112, v113
    v_cvt_pk_bf16_f32 v113, v114, v115
    v_cvt_pk_bf16_f32 v114, v116, v117
    v_cvt_pk_bf16_f32 v115, v118, v119
    s_mov_b32 exec_lo, 0
    buffer_store_dwordx4 v[112:115], v144, s[20:23], s10 offen offset:0 sc1
    s_not_b64 exec, exec
    s_mul_i32 s10, s45, 4
    s_add_u32 s10, s10, s43
    buffer_store_dwordx2 v[112:113], v145, s[20:23], s10 offen offset:1024 sc1
    s_add_u32 s10, s10, s45
    buffer_store_dwordx2 v[114:115], v145, s[20:23], s10 offen offset:1024 sc1
    s_mov_b64 exec, -1
    s_waitcnt lgkmcnt(4)
    v_pk_mul_f32 v[208:209], v[14:15], v[208:209] op_sel:[1,0] op_sel_hi:[1,1]
    v_pk_mul_f32 v[210:211], v[14:15], v[210:211] op_sel:[1,0] op_sel_hi:[1,1]
    v_pk_mul_f32 v[212:213], v[14:15], v[212:213] op_sel:[1,0] op_sel_hi:[1,1]
    v_pk_mul_f32 v[214:215], v[14:15], v[214:215] op_sel:[1,0] op_sel_hi:[1,1]
    v_pk_fma_f32 v[120:121], v[120:121], v[14:15], v[208:209] op_sel_hi:[1,0,1]
    v_pk_fma_f32 v[122:123], v[122:123], v[14:15], v[210:211] op_sel_hi:[1,0,1]
    v_pk_fma_f32 v[124:125], v[124:125], v[14:15], v[212:213] op_sel_hi:[1,0,1]
    v_pk_fma_f32 v[126:127], v[126:127], v[14:15], v[214:215] op_sel_hi:[1,0,1]
    s_mul_i32 s10, s45, 5
    s_add_u32 s10, s10, s43
    v_cvt_pk_bf16_f32 v120, v120, v121
    v_cvt_pk_bf16_f32 v121, v122, v123
    v_cvt_pk_bf16_f32 v122, v124, v125
    v_cvt_pk_bf16_f32 v123, v126, v127
    buffer_store_dwordx4 v[120:123], v147, s[20:23], s10 offen offset:512 sc1
    s_waitcnt lgkmcnt(2)
    v_pk_mul_f32 v[216:217], v[14:15], v[216:217] op_sel:[1,0] op_sel_hi:[1,1]
    v_pk_mul_f32 v[218:219], v[14:15], v[218:219] op_sel:[1,0] op_sel_hi:[1,1]
    v_pk_mul_f32 v[220:221], v[14:15], v[220:221] op_sel:[1,0] op_sel_hi:[1,1]
    v_pk_mul_f32 v[222:223], v[14:15], v[222:223] op_sel:[1,0] op_sel_hi:[1,1]
    v_pk_fma_f32 v[128:129], v[128:129], v[14:15], v[216:217] op_sel_hi:[1,0,1]
    v_pk_fma_f32 v[130:131], v[130:131], v[14:15], v[218:219] op_sel_hi:[1,0,1]
    v_pk_fma_f32 v[132:133], v[132:133], v[14:15], v[220:221] op_sel_hi:[1,0,1]
    v_pk_fma_f32 v[134:135], v[134:135], v[14:15], v[222:223] op_sel_hi:[1,0,1]
    s_mul_i32 s10, s45, 6
    s_add_u32 s10, s10, s43
    v_cvt_pk_bf16_f32 v128, v128, v129
    v_cvt_pk_bf16_f32 v129, v130, v131
    v_cvt_pk_bf16_f32 v130, v132, v133
    v_cvt_pk_bf16_f32 v131, v134, v135
    s_mov_b32 exec_hi, 0
    buffer_store_dwordx4 v[128:131], v144, s[20:23], s10 offen offset:512 sc1
    s_not_b64 exec, exec
    s_mul_i32 s10, s45, 6
    s_add_u32 s10, s10, s43
    buffer_store_dwordx2 v[128:129], v145, s[20:23], s10 offen offset:1024 sc1
    s_add_u32 s10, s10, s45
    buffer_store_dwordx2 v[130:131], v145, s[20:23], s10 offen offset:1024 sc1
    s_mov_b64 exec, -1
    s_waitcnt lgkmcnt(0)
    v_pk_mul_f32 v[224:225], v[14:15], v[224:225] op_sel:[1,0] op_sel_hi:[1,1]
    v_pk_mul_f32 v[226:227], v[14:15], v[226:227] op_sel:[1,0] op_sel_hi:[1,1]
    v_pk_mul_f32 v[228:229], v[14:15], v[228:229] op_sel:[1,0] op_sel_hi:[1,1]
    v_pk_mul_f32 v[230:231], v[14:15], v[230:231] op_sel:[1,0] op_sel_hi:[1,1]
    v_pk_fma_f32 v[136:137], v[136:137], v[14:15], v[224:225] op_sel_hi:[1,0,1]
    v_pk_fma_f32 v[138:139], v[138:139], v[14:15], v[226:227] op_sel_hi:[1,0,1]
    v_pk_fma_f32 v[140:141], v[140:141], v[14:15], v[228:229] op_sel_hi:[1,0,1]
    v_pk_fma_f32 v[142:143], v[142:143], v[14:15], v[230:231] op_sel_hi:[1,0,1]
    s_mul_i32 s10, s45, 7
    s_add_u32 s10, s10, s43
    v_cvt_pk_bf16_f32 v136, v136, v137
    v_cvt_pk_bf16_f32 v137, v138, v139
    v_cvt_pk_bf16_f32 v138, v140, v141
    v_cvt_pk_bf16_f32 v139, v142, v143
    buffer_store_dwordx4 v[136:139], v146, s[20:23], s10 offen sc1
    s_branch A_cdone
A_preV:
    v_and_b32 v7, 3, v2
    v_lshl_add_u32 v12, v7, 3, v12
    s_mul_i32 s43, s43, 2560
    s_add_u32 s43, s43, 0
    s_mul_i32 s10, s42, 1310720
    s_add_u32 s43, s43, s10
    s_mov_b32 s45, 163840
    v_mul_u32_u24 v13, 320, v4
    v_add_u32 v13, 1280, v13
    v_add_u32 v5, 0, v3
    v_mul_u32_u24 v6, 205, v5
    v_lshrrev_b32 v6, 12, v6
    v_mul_u32_u24 v7, 20, v6
    v_sub_u32 v5, v5, v7
    v_mul_lo_u32 v6, v6, s45
    v_lshl_add_u32 v5, v5, 4, v13
    v_add_u32 v144, v5, v6
    v_add_u32 v5, 32, v3
    v_mul_u32_u24 v6, 205, v5
    v_lshrrev_b32 v6, 12, v6
    v_mul_u32_u24 v7, 20, v6
    v_sub_u32 v5, v5, v7
    v_mul_lo_u32 v6, v6, s45
    v_lshl_add_u32 v5, v5, 4, v13
    v_add_u32 v145, v5, v6
    v_add_u32 v5, 64, v3
    v_mul_u32_u24 v6, 205, v5
    v_lshrrev_b32 v6, 12, v6
    v_mul_u32_u24 v7, 20, v6
    v_sub_u32 v5, v5, v7
    v_mul_lo_u32 v6, v6, s45
    v_lshl_add_u32 v5, v5, 4, v13
    v_add_u32 v146, v5, v6
    v_add_u32 v5, 96, v3
    v_mul_u32_u24 v6, 205, v5
    v_lshrrev_b32 v6, 12, v6
    v_mul_u32_u24 v7, 20, v6
    v_sub_u32 v5, v5, v7
    v_mul_lo_u32 v6, v6, s45
    v_lshl_add_u32 v5, v5, 4, v13
    v_add_u32 v147, v5, v6
    v_add_u32 v5, 128, v3
    v_mul_u32_u24 v6, 205, v5
    v_lshrrev_b32 v6, 12, v6
    v_mul_u32_u24 v7, 20, v6
    v_sub_u32 v5, v5, v7
    v_mul_lo_u32 v6, v6, s45
    v_lshl_add_u32 v5, v5, 4, v13
    v_add_u32 v148, v5, v6
A_loopV:
    s_barrier
    s_waitcnt lgkmcnt(8)
    v_mfma_f32_32x32x16_bf16 v[64:79], v[20:23], v[44:47], v[64:79]
    ds_read_b128 v[16:19], v8
    ds_read_b64_tr_b16 v[24:25], v12 offset:0
    ds_read_b64_tr_b16 v[26:27], v12 offset:1280
    s_waitcnt lgkmcnt(9)
    v_mfma_f32_32x32x16_bf16 v[80:95], v[20:23], v[48:51], v[80:95]
    ds_read_b64_tr_b16 v[28:29], v12 offset:64
    ds_read_b64_tr_b16 v[30:31], v12 offset:1344
    s_waitcnt lgkmcnt(9)
    v_mfma_f32_32x32x16_bf16 v[96:111], v[20:23], v[52:55], v[96:111]
    ds_read_b64_tr_b16 v[32:33], v12 offset:128
    ds_read_b64_tr_b16 v[34:35], v12 offset:1408
    s_waitcnt lgkmcnt(9)
    v_mfma_f32_32x32x16_bf16 v[112:127], v[20:23], v[56:59], v[112:127]
    ds_read_b64_tr_b16 v[36:37], v12 offset:192
    ds_read_b64_tr_b16 v[38:39], v12 offset:1472
    s_waitcnt lgkmcnt(9)
    v_mfma_f32_32x32x16_bf16 v[128:143], v[20:23], v[60:63], v[128:143]
    ds_read_b64_tr_b16 v[40:41], v12 offset:256
    ds_read_b64_tr_b16 v[42:43], v12 offset:1536
    s_waitcnt lgkmcnt(8)
    v_mfma_f32_32x32x16_bf16 v[64:79], v[16:19], v[24:27], v[64:79]
    ds_read_b128 v[20:23], v9
    ds_read_b64_tr_b16 v[44:45], v12 offset:5120
    ds_read_b64_tr_b16 v[46:47], v12 offset:6400
    s_waitcnt lgkmcnt(9)
    v_mfma_f32_32x32x16_bf16 v[80:95], v[16:19], v[28:31], v[80:95]
    ds_read_b64_tr_b16 v[48:49], v12 offset:5184
    ds_read_b64_tr_b16 v[50:51], v12 offset:6464
    s_waitcnt lgkmcnt(9)
    v_mfma_f32_32x32x16_bf16 v[96:111], v[16:19], v[32:35], v[96:111]
    ds_read_b64_tr_b16 v[52:53], v12 offset:5248
    ds_read_b64_tr_b16 v[54:55], v12 offset:6528
    s_waitcnt lgkmcnt(9)
    v_mfma_f32_32x32x16_bf16 v[112:127], v[16:19], v[36:39], v[112:127]
    ds_read_b64_tr_b16 v[56:57], v12 offset:5312
    ds_read_b64_tr_b16 v[58:59], v12 offset:6592
    s_waitcnt lgkmcnt(9)
    v_mfma_f32_32x32x16_bf16 v[128:143], v[16:19], v[40:43], v[128:143]
    ds_read_b64_tr_b16 v[60:61], v12 offset:5376
    ds_read_b64_tr_b16 v[62:63], v12 offset:6656
    s_waitcnt lgkmcnt(8)
    v_mfma_f32_32x32x16_bf16 v[64:79], v[20:23], v[44:47], v[64:79]
    ds_read_b128 v[16:19], v10
    ds_read_b64_tr_b16 v[24:25], v12 offset:10240
    ds_read_b64_tr_b16 v[26:27], v12 offset:11520
    s_waitcnt lgkmcnt(9)
    v_mfma_f32_32x32x16_bf16 v[80:95], v[20:23], v[48:51], v[80:95]
    ds_read_b64_tr_b16 v[28:29], v12 offset:10304
    ds_read_b64_tr_b16 v[30:31], v12 offset:11584
    s_waitcnt lgkmcnt(9)
    v_mfma_f32_32x32x16_bf16 v[96:111], v[20:23], v[52:55], v[96:111]
    ds_read_b64_tr_b16 v[32:33], v12 offset:10368
    ds_read_b64_tr_b16 v[34:35], v12 offset:11648
    s_waitcnt lgkmcnt(9)
    v_mfma_f32_32x32x16_bf16 v[112:127], v[20:23], v[56:59], v[112:127]
    ds_read_b64_tr_b16 v[36:37], v12 offset:10432
    ds_read_b64_tr_b16 v[38:39], v12 offset:11712
    s_waitcnt lgkmcnt(9)
    v_mfma_f32_32x32x16_bf16 v[128:143], v[20:23], v[60:63], v[128:143]
    ds_read_b64_tr_b16 v[40:41], v12 offset:10496
    ds_read_b64_tr_b16 v[42:43], v12 offset:11776
    s_add_u32 s34, s34, 1
    s_and_b32 s10, s34, 3
    s_cmp_eq_u32 s10, 0
    s_cselect_b32 s35, 0xfffe5000, s36
    s_waitcnt lgkmcnt(8)
    v_mfma_f32_32x32x16_bf16 v[64:79], v[16:19], v[24:27], v[64:79]
    ds_read_b128 v[20:23], v11
    ds_read_b64_tr_b16 v[44:45], v12 offset:15360
    ds_read_b64_tr_b16 v[46:47], v12 offset:16640
    s_waitcnt lgkmcnt(9)
    v_mfma_f32_32x32x16_bf16 v[80:95], v[16:19], v[28:31], v[80:95]
    ds_read_b64_tr_b16 v[48:49], v12 offset:15424
    ds_read_b64_tr_b16 v[50:51], v12 offset:16704
    v_add_u32 v8, s35, v8
    s_waitcnt lgkmcnt(9)
    v_mfma_f32_32x32x16_bf16 v[96:111], v[16:19], v[32:35], v[96:111]
    ds_read_b64_tr_b16 v[52:53], v12 offset:15488
    ds_read_b64_tr_b16 v[54:55], v12 offset:16768
    v_add_u32 v9, s35, v9
    s_waitcnt lgkmcnt(9)
    v_mfma_f32_32x32x16_bf16 v[112:127], v[16:19], v[36:39], v[112:127]
    ds_read_b64_tr_b16 v[56:57], v12 offset:15552
    ds_read_b64_tr_b16 v[58:59], v12 offset:16832
    v_add_u32 v10, s35, v10
    s_waitcnt lgkmcnt(9)
    v_mfma_f32_32x32x16_bf16 v[128:143], v[16:19], v[40:43], v[128:143]
    ds_read_b64_tr_b16 v[60:61], v12 offset:15616
    ds_read_b64_tr_b16 v[62:63], v12 offset:16896
    v_add_u32 v11, s35, v11
    v_add_u32 v12, s35, v12
    s_cmp_lt_u32 s34, 10
    s_cbranch_scc1 A_loopV
    s_waitcnt lgkmcnt(8)
    v_mfma_f32_32x32x16_bf16 v[64:79], v[20:23], v[44:47], v[64:79]
    s_waitcnt lgkmcnt(6)
    v_mfma_f32_32x32x16_bf16 v[80:95], v[20:23], v[48:51], v[80:95]
    s_waitcnt lgkmcnt(4)
    v_mfma_f32_32x32x16_bf16 v[96:111], v[20:23], v[52:55], v[96:111]
    s_waitcnt lgkmcnt(2)
    v_mfma_f32_32x32x16_bf16 v[112:127], v[20:23], v[56:59], v[112:127]
    s_waitcnt lgkmcnt(0)
    v_mfma_f32_32x32x16_bf16 v[128:143], v[20:23], v[60:63], v[128:143]
    v_lshlrev_b32 v5, 2, v3
    v_add_u32 v5, 149504, v5
    s_lshl_b32 s10, s24, 7
    s_add_u32 s10, s10, 147456
    v_lshl_add_u32 v6, v4, 4, s10
    s_barrier
    ds_read_b32 v184, v5 offset:0
    ds_read_b32 v186, v5 offset:128
    ds_read_b32 v188, v5 offset:256
    ds_read_b32 v190, v5 offset:384
    ds_read_b32 v192, v5 offset:512
    ds_read_b128 v[152:155], v6 offset:0
    ds_read_b128 v[168:171], v6 offset:512
    ds_read_b128 v[156:159], v6 offset:32
    ds_read_b128 v[172:175], v6 offset:544
    ds_read_b128 v[160:163], v6 offset:64
    ds_read_b128 v[176:179], v6 offset:576
    ds_read_b128 v[164:167], v6 offset:96
    ds_read_b128 v[180:183], v6 offset:608
    s_waitcnt lgkmcnt(4)
    v_pk_mul_f32 v[16:17], v[168:169], v[184:185] op_sel_hi:[1,0]
    v_pk_mul_f32 v[18:19], v[170:171], v[184:185] op_sel_hi:[1,0]
    v_pk_mul_f32 v[20:21], v[172:173], v[184:185] op_sel_hi:[1,0]
    v_pk_mul_f32 v[22:23], v[174:175], v[184:185] op_sel_hi:[1,0]
    v_pk_fma_f32 v[64:65], v[64:65], v[152:153], v[16:17]
    v_pk_fma_f32 v[66:67], v[66:67], v[154:155], v[18:19]
    v_pk_fma_f32 v[68:69], v[68:69], v[156:157], v[20:21]
    v_pk_fma_f32 v[70:71], v[70:71], v[158:159], v[22:23]
    v_cvt_pk_bf16_f32 v64, v64, v65
    v_cvt_pk_bf16_f32 v65, v66, v67
    v_cvt_pk_bf16_f32 v66, v68, v69
    v_cvt_pk_bf16_f32 v67, v70, v71
    buffer_store_dwordx4 v[64:67], v144, s[20:23], s43 offen offset:0 sc1
    v_pk_mul_f32 v[24:25], v[168:169], v[186:187] op_sel_hi:[1,0]
    v_pk_mul_f32 v[26:27], v[170:171], v[186:187] op_sel_hi:[1,0]
    v_pk_mul_f32 v[28:29], v[172:173], v[186:187] op_sel_hi:[1,0]
    v_pk_mul_f32 v[30:31], v[174:175], v[186:187] op_sel_hi:[1,0]
    v_pk_fma_f32 v[80:81], v[80:81], v[152:153], v[24:25]
    v_pk_fma_f32 v[82:83], v[82:83], v[154:155], v[26:27]
    v_pk_fma_f32 v[84:85], v[84:85], v[156:157], v[28:29]
    v_pk_fma_f32 v[86:87], v[86:87], v[158:159], v[30:31]
    v_cvt_pk_bf16_f32 v80, v80, v81
    v_cvt_pk_bf16_f32 v81, v82, v83
    v_cvt_pk_bf16_f32 v82, v84, v85
    v_cvt_pk_bf16_f32 v83, v86, v87
    buffer_store_dwordx4 v[80:83], v145, s[20:23], s43 offen offset:0 sc1
    v_pk_mul_f32 v[16:17], v[168:169], v[188:189] op_sel_hi:[1,0]
    v_pk_mul_f32 v[18:19], v[170:171], v[188:189] op_sel_hi:[1,0]
    v_pk_mul_f32 v[20:21], v[172:173], v[188:189] op_sel_hi:[1,0]
    v_pk_mul_f32 v[22:23], v[174:175], v[188:189] op_sel_hi:[1,0]
    v_pk_fma_f32 v[96:97], v[96:97], v[152:153], v[16:17]
    v_pk_fma_f32 v[98:99], v[98:99], v[154:155], v[18:19]
    v_pk_fma_f32 v[100:101], v[100:101], v[156:157], v[20:21]
    v_pk_fma_f32 v[102:103], v[102:103], v[158:159], v[22:23]
    v_cvt_pk_bf16_f32 v96, v96, v97
    v_cvt_pk_bf16_f32 v97, v98, v99
    v_cvt_pk_bf16_f32 v98, v100, v101
    v_cvt_pk_bf16_f32 v99, v102, v103
    buffer_store_dwordx4 v[96:99], v146, s[20:23], s43 offen offset:0 sc1
    v_pk_mul_f32 v[24:25], v[168:169], v[190:191] op_sel_hi:[1,0]
    v_pk_mul_f32 v[26:27], v[170:171], v[190:191] op_sel_hi:[1,0]
    v_pk_mul_f32 v[28:29], v[172:173], v[190:191] op_sel_hi:[1,0]
    v_pk_mul_f32 v[30:31], v[174:175], v[190:191] op_sel_hi:[1,0]
    v_pk_fma_f32 v[112:113], v[112:113], v[152:153], v[24:25]
    v_pk_fma_f32 v[114:115], v[114:115], v[154:155], v[26:27]
    v_pk_fma_f32 v[116:117], v[116:117], v[156:157], v[28:29]
    v_pk_fma_f32 v[118:119], v[118:119], v[158:159], v[30:31]
    v_cvt_pk_bf16_f32 v112, v112, v113
    v_cvt_pk_bf16_f32 v113, v114, v115
    v_cvt_pk_bf16_f32 v114, v116, v117
    v_cvt_pk_bf16_f32 v115, v118, v119
    buffer_store_dwordx4 v[112:115], v147, s[20:23], s43 offen offset:0 sc1
    v_pk_mul_f32 v[16:17], v[168:169], v[192:193] op_sel_hi:[1,0]
    v_pk_mul_f32 v[18:19], v[170:171], v[192:193] op_sel_hi:[1,0]
    v_pk_mul_f32 v[20:21], v[172:173], v[192:193] op_sel_hi:[1,0]
    v_pk_mul_f32 v[22:23], v[174:175], v[192:193] op_sel_hi:[1,0]
    v_pk_fma_f32 v[128:129], v[128:129], v[152:153], v[16:17]
    v_pk_fma_f32 v[130:131], v[130:131], v[154:155], v[18:19]
    v_pk_fma_f32 v[132:133], v[132:133], v[156:157], v[20:21]
    v_pk_fma_f32 v[134:135], v[134:135], v[158:159], v[22:23]
    v_cvt_pk_bf16_f32 v128, v128, v129
    v_cvt_pk_bf16_f32 v129, v130, v131
    v_cvt_pk_bf16_f32 v130, v132, v133
    v_cvt_pk_bf16_f32 v131, v134, v135
    buffer_store_dwordx4 v[128:131], v148, s[20:23], s43 offen offset:0 sc1
    s_waitcnt lgkmcnt(0)
    v_pk_mul_f32 v[16:17], v[176:177], v[184:185] op_sel_hi:[1,0]
    v_pk_mul_f32 v[18:19], v[178:179], v[184:185] op_sel_hi:[1,0]
    v_pk_mul_f32 v[20:21], v[180:181], v[184:185] op_sel_hi:[1,0]
    v_pk_mul_f32 v[22:23], v[182:183], v[184:185] op_sel_hi:[1,0]
    v_pk_fma_f32 v[72:73], v[72:73], v[160:161], v[16:17]
    v_pk_fma_f32 v[74:75], v[74:75], v[162:163], v[18:19]
    v_pk_fma_f32 v[76:77], v[76:77], v[164:165], v[20:21]
    v_pk_fma_f32 v[78:79], v[78:79], v[166:167], v[22:23]
    v_cvt_pk_bf16_f32 v72, v72, v73
    v_cvt_pk_bf16_f32 v73, v74, v75
    v_cvt_pk_bf16_f32 v74, v76, v77
    v_cvt_pk_bf16_f32 v75, v78, v79
    buffer_store_dwordx4 v[72:75], v144, s[20:23], s43 offen offset:640 sc1
    v_pk_mul_f32 v[24:25], v[176:177], v[186:187] op_sel_hi:[1,0]
    v_pk_mul_f32 v[26:27], v[178:179], v[186:187] op_sel_hi:[1,0]
    v_pk_mul_f32 v[28:29], v[180:181], v[186:187] op_sel_hi:[1,0]
    v_pk_mul_f32 v[30:31], v[182:183], v[186:187] op_sel_hi:[1,0]
    v_pk_fma_f32 v[88:89], v[88:89], v[160:161], v[24:25]
    v_pk_fma_f32 v[90:91], v[90:91], v[162:163], v[26:27]
    v_pk_fma_f32 v[92:93], v[92:93], v[164:165], v[28:29]
    v_pk_fma_f32 v[94:95], v[94:95], v[166:167], v[30:31]
    v_cvt_pk_bf16_f32 v88, v88, v89
    v_cvt_pk_bf16_f32 v89, v90, v91
    v_cvt_pk_bf16_f32 v90, v92, v93
    v_cvt_pk_bf16_f32 v91, v94, v95
    buffer_store_dwordx4 v[88:91], v145, s[20:23], s43 offen offset:640 sc1
    v_pk_mul_f32 v[16:17], v[176:177], v[188:189] op_sel_hi:[1,0]
    v_pk_mul_f32 v[18:19], v[178:179], v[188:189] op_sel_hi:[1,0]
    v_pk_mul_f32 v[20:21], v[180:181], v[188:189] op_sel_hi:[1,0]
    v_pk_mul_f32 v[22:23], v[182:183], v[188:189] op_sel_hi:[1,0]
    v_pk_fma_f32 v[104:105], v[104:105], v[160:161], v[16:17]
    v_pk_fma_f32 v[106:107], v[106:107], v[162:163], v[18:19]
    v_pk_fma_f32 v[108:109], v[108:109], v[164:165], v[20:21]
    v_pk_fma_f32 v[110:111], v[110:111], v[166:167], v[22:23]
    v_cvt_pk_bf16_f32 v104, v104, v105
    v_cvt_pk_bf16_f32 v105, v106, v107
    v_cvt_pk_bf16_f32 v106, v108, v109
    v_cvt_pk_bf16_f32 v107, v110, v111
    buffer_store_dwordx4 v[104:107], v146, s[20:23], s43 offen offset:640 sc1
    v_pk_mul_f32 v[24:25], v[176:177], v[190:191] op_sel_hi:[1,0]
    v_pk_mul_f32 v[26:27], v[178:179], v[190:191] op_sel_hi:[1,0]
    v_pk_mul_f32 v[28:29], v[180:181], v[190:191] op_sel_hi:[1,0]
    v_pk_mul_f32 v[30:31], v[182:183], v[190:191] op_sel_hi:[1,0]
    v_pk_fma_f32 v[120:121], v[120:121], v[160:161], v[24:25]
    v_pk_fma_f32 v[122:123], v[122:123], v[162:163], v[26:27]
    v_pk_fma_f32 v[124:125], v[124:125], v[164:165], v[28:29]
    v_pk_fma_f32 v[126:127], v[126:127], v[166:167], v[30:31]
    v_cvt_pk_bf16_f32 v120, v120, v121
    v_cvt_pk_bf16_f32 v121, v122, v123
    v_cvt_pk_bf16_f32 v122, v124, v125
    v_cvt_pk_bf16_f32 v123, v126, v127
    buffer_store_dwordx4 v[120:123], v147, s[20:23], s43 offen offset:640 sc1
    v_pk_mul_f32 v[16:17], v[176:177], v[192:193] op_sel_hi:[1,0]
    v_pk_mul_f32 v[18:19], v[178:179], v[192:193] op_sel_hi:[1,0]
    v_pk_mul_f32 v[20:21], v[180:181], v[192:193] op_sel_hi:[1,0]
    v_pk_mul_f32 v[22:23], v[182:183], v[192:193] op_sel_hi:[1,0]
    v_pk_fma_f32 v[136:137], v[136:137], v[160:161], v[16:17]
    v_pk_fma_f32 v[138:139], v[138:139], v[162:163], v[18:19]
    v_pk_fma_f32 v[140:141], v[140:141], v[164:165], v[20:21]
    v_pk_fma_f32 v[142:143], v[142:143], v[166:167], v[22:23]
    v_cvt_pk_bf16_f32 v136, v136, v137
    v_cvt_pk_bf16_f32 v137, v138, v139
    v_cvt_pk_bf16_f32 v138, v140, v141
    v_cvt_pk_bf16_f32 v139, v142, v143
    buffer_store_dwordx4 v[136:139], v148, s[20:23], s43 offen offset:640 sc1
A_cdone:
    v_mov_b32 v7, 150528
    ds_read_b64 v[8:9], v7
    s_lshl_b32 s10, s28, 4
    s_add_u32 s10, s10, s27
    s_lshl_b32 s10, s10, 4
    s_add_u32 s10, s10, s24
    s_lshl_b32 s10, s10, 3
    s_add_u32 s10, s10, 16924672
    v_mov_b32 v6, 0
    s_waitcnt lgkmcnt(0)
    v_readfirstlane_b32 s98, v8
    v_readfirstlane_b32 s99, v9
    s_waitcnt vmcnt(0)
    s_mov_b64 exec, 1
    buffer_store_dwordx2 v[8:9], v6, s[20:23], s10 offen sc1
    s_mov_b64 exec, -1
    s_branch F_main
A_pack:
    s_load_dwordx4 s[44:47], s[0:1], 32
    s_load_dwordx2 s[48:49], s[0:1], 48
    s_load_dwordx2 s[50:51], s[0:1], 16
    s_sub_u32 s26, s2, 192
    v_lshrrev_b32 v8, 3, v2
    v_and_b32 v9, 7, v2
    v_lshlrev_b32 v9, 4, v9
    v_mul_u32_u24 v10, 3840, v8
    v_add_u32 v10, v10, v9
    s_lshr_b32 s10, s26, 1
    s_lshl_b32 s29, s10, 7
    s_and_b32 s11, s26, 1
    s_mul_i32 s11, s11, 320
    s_mul_i32 s30, s24, 40
    s_add_u32 s11, s11, s30
    s_mul_i32 s11, s11, 3840
    s_add_u32 s29, s29, s11
    s_cmp_ge_u32 s26, 60
    s_cselect_b32 s29, 0x40000000, s29
    s_waitcnt lgkmcnt(0)
    s_mov_b32 s12, s4
    s_mov_b32 s13, s5
    s_mov_b32 s16, s6
    s_mov_b32 s17, s7
    s_mov_b32 s20, s62
    s_mov_b32 s21, s63
    buffer_load_dwordx4 v[44:47], v10, s[16:19], s29 offen
    s_add_u32 s29, s29, 30720
    buffer_load_dwordx4 v[48:51], v10, s[16:19], s29 offen
    s_add_u32 s29, s29, 30720
    buffer_load_dwordx4 v[52:55], v10, s[16:19], s29 offen
    s_add_u32 s29, s29, 30720
    buffer_load_dwordx4 v[56:59], v10, s[16:19], s29 offen
    s_add_u32 s29, s29, 30720
    buffer_load_dwordx4 v[60:63], v10, s[16:19], s29 offen
    s_add_u32 s29, s29, 30720
    s_mov_b32 s56, s60
    s_mov_b32 s57, s61
    s_mov_b32 s58, 256
    s_mov_b32 s59, 0x20000
    v_mov_b32 v18, 0
    s_cmp_lt_u32 s24, 4
    s_cbranch_scc1 A_p0
    s_lshl_b32 s36, s2, 2
    s_add_u32 s36, s36, s25
    s_mul_i32 s37, s36, 2560
    v_mul_u32_u24 v5, 1280, v4
    v_lshl_add_u32 v5, v3, 4, v5
    v_cmp_gt_u32 vcc, 16, v3
    v_mov_b32 v6, 0x40000000
    buffer_load_dwordx4 v[32:35], v5, s[12:15], s37 offen
    v_cndmask_b32 v6, v6, v5, vcc
    buffer_load_dwordx4 v[36:39], v5, s[12:15], s37 offen offset:512
    buffer_load_dwordx4 v[40:43], v6, s[12:15], s37 offen offset:1024
A_p0:
    buffer_load_dwordx2 v[24:25], v18, s[56:59], 0 offen sc1
    v_mul_u32_u24 v11, 3072, v8
    v_add_u32 v11, v11, v9
    v_mul_u32_u24 v12, 1280, v8
    v_add_u32 v12, v12, v9
    v_lshrrev_b32 v13, 2, v8
    v_mul_u32_u24 v13, 40, v13
    v_and_b32 v14, 3, v8
    v_add_u32 v13, v13, v14
    v_add_u32 v13, 16, v13
    v_mul_u32_u24 v13, 1280, v13
    v_add_u32 v13, v13, v9
    s_lshl_b32 s40, s24, 6
    s_add_u32 s40, s40, s26
    s_lshl_b32 s41, s24, 14
    s_mov_b32 s64, s40
    s_mov_b32 s65, s41
    s_mov_b32 s55, 0x20000
    v_bfe_u32 v5, v2, 2, 2
    v_bfe_u32 v7, v2, 4, 1
    v_and_b32 v8, 3, v2
    v_lshl_add_u32 v14, v4, 3, v5
    v_lshlrev_b32 v14, 7, v14
    v_lshl_add_u32 v14, v7, 11, v14
    v_lshl_add_u32 v14, v8, 3, v14
    v_lshl_add_u32 v15, v7, 2, v5
    v_lshl_add_u32 v15, v4, 4, v15
    v_lshlrev_b32 v15, 7, v15
    v_lshl_add_u32 v15, v8, 3, v15
    v_lshlrev_b32 v1, 4, v2
    s_branch A_pm
A_p1:
    s_mov_b32 m0, s41
    s_cmp_lt_u32 s40, 960
    s_cbranch_scc0 A_p2
    s_mul_i32 s10, s40, 2731
    s_lshr_b32 s10, s10, 16
    s_mul_i32 s11, s10, 24
    s_sub_u32 s11, s40, s11
    s_mul_i32 s10, s10, 49152
    s_lshl_b32 s11, s11, 7
    s_add_u32 s10, s10, s11
    s_add_u32 s11, s10, 23552
    s_mov_b32 s52, s44
    s_mov_b32 s53, s45
    s_mov_b32 s54, 1966080
    buffer_load_dwordx4 v11, s[52:55], s10 offen lds
    buffer_load_dwordx4 v11, s[52:55], s11 offen offset:1024 lds
    s_add_u32 m0, s41, 2048
    s_mov_b32 s52, s46
    s_mov_b32 s53, s47
    buffer_load_dwordx4 v11, s[52:55], s10 offen lds
    buffer_load_dwordx4 v11, s[52:55], s11 offen offset:1024 lds
    s_branch A_p5
A_p2:
    s_sub_u32 s42, s40, 960
    s_mul_i32 s10, s42, 6554
    s_lshr_b32 s10, s10, 16
    s_mul_i32 s11, s10, 10
    s_sub_u32 s11, s42, s11
    s_lshl_b32 s11, s11, 7
    s_cmp_lt_u32 s10, 48
    s_cbranch_scc0 A_p3
    s_mul_i32 s10, s10, 40960
    s_add_u32 s10, s10, s11
    s_mov_b32 s52, s48
    s_mov_b32 s53, s49
    s_mov_b32 s54, 1966080
    s_mov_b32 s42, 18432
    s_branch A_p4
A_p3:
    s_mov_b32 s52, s50
    s_mov_b32 s53, s51
    s_mov_b32 s54, 819200
    s_cmp_lt_u32 s10, 64
    s_cbranch_scc0 A_p6
    s_sub_u32 s10, s10, 48
    s_mul_i32 s10, s10, 51200
    s_add_u32 s10, s10, s11
    s_mov_b32 s42, 23552
A_p4:
    s_add_u32 s11, s10, 9216
    buffer_load_dwordx4 v12, s[52:55], s10 offen lds
    buffer_load_dwordx4 v12, s[52:55], s11 offen offset:1024 lds
    s_add_u32 s10, s10, s42
    s_add_u32 s11, s11, s42
    buffer_load_dwordx4 v12, s[52:55], s10 offen offset:2048 lds
    buffer_load_dwordx4 v12, s[52:55], s11 offen offset:3072 lds
    s_branch A_p5
A_p6:
    s_sub_u32 s10, s10, 64
    s_mul_i32 s10, s10, 204800
    s_add_u32 s10, s10, s11
    s_add_u32 s11, s10, 24576
    buffer_load_dwordx4 v13, s[52:55], s10 offen lds
    buffer_load_dwordx4 v13, s[52:55], s11 offen offset:1024 lds
    s_add_u32 s10, s10, 100352
    s_add_u32 s11, s11, 100352
    buffer_load_dwordx4 v13, s[52:55], s10 offen offset:2048 lds
    buffer_load_dwordx4 v13, s[52:55], s11 offen offset:3072 lds
A_p5:
    s_add_u32 s40, s40, 512
    s_add_u32 s41, s41, 4096
    s_setpc_b64 s[34:35]
A_q1:
    s_cmp_lt_u32 s64, 960
    s_cbranch_scc0 A_q2
    s_mul_i32 s10, s64, 2731
    s_lshr_b32 s10, s10, 16
    s_mul_i32 s11, s10, 24
    s_sub_u32 s42, s64, s11
    s_mul_i32 s43, s10, 3072
    s_add_u32 s43, s43, 19873792
    s_mov_b32 s66, 3
    s_mov_b32 s67, 342
    s_mov_b32 s68, 122880
    v_add_u32 v5, s65, v14
    v_add_u32 v6, 512, v5
    s_branch A_q4
A_q2:
    s_sub_u32 s42, s64, 960
    s_mul_i32 s10, s42, 6554
    s_lshr_b32 s10, s10, 16
    s_mul_i32 s11, s10, 10
    s_sub_u32 s42, s42, s11
    s_mul_i32 s43, s10, 5120
    s_mov_b32 s66, 5
    s_mov_b32 s67, 205
    s_mov_b32 s68, 245760
    s_add_u32 s43, s43, 17088512
    s_cmp_lt_u32 s10, 48
    s_cbranch_scc1 A_q3
    s_mov_b32 s68, 102400
    s_add_u32 s43, s43, 1720320
A_q3:
    v_add_u32 v5, s65, v15
    v_add_u32 v6, 1024, v5
A_q4:
    s_lshl_b32 s42, s42, 2
    ds_read_b64_tr_b16 v[128:129], v5 offset:0
    ds_read_b64_tr_b16 v[130:131], v6 offset:0
    ds_read_b64_tr_b16 v[132:133], v5 offset:32
    ds_read_b64_tr_b16 v[134:135], v6 offset:32
    ds_read_b64_tr_b16 v[136:137], v5 offset:64
    ds_read_b64_tr_b16 v[138:139], v6 offset:64
    ds_read_b64_tr_b16 v[140:141], v5 offset:96
    ds_read_b64_tr_b16 v[142:143], v6 offset:96
    s_add_u32 s10, s42, 0
    s_mul_i32 s11, s10, s67
    s_lshr_b32 s11, s11, 10
    s_mul_i32 s29, s11, s66
    s_sub_u32 s10, s10, s29
    s_lshl_b32 s10, s10, 10
    s_mul_i32 s11, s11, s68
    s_add_u32 s10, s10, s11
    s_add_u32 s10, s10, s43
    s_waitcnt lgkmcnt(6)
    buffer_store_dwordx4 v[128:131], v1, s[20:23], s10 offen sc1
    s_add_u32 s10, s42, 1
    s_mul_i32 s11, s10, s67
    s_lshr_b32 s11, s11, 10
    s_mul_i32 s29, s11, s66
    s_sub_u32 s10, s10, s29
    s_lshl_b32 s10, s10, 10
    s_mul_i32 s11, s11, s68
    s_add_u32 s10, s10, s11
    s_add_u32 s10, s10, s43
    s_waitcnt lgkmcnt(4)
    buffer_store_dwordx4 v[132:135], v1, s[20:23], s10 offen sc1
    s_add_u32 s10, s42, 2
    s_mul_i32 s11, s10, s67
    s_lshr_b32 s11, s11, 10
    s_mul_i32 s29, s11, s66
    s_sub_u32 s10, s10, s29
    s_lshl_b32 s10, s10, 10
    s_mul_i32 s11, s11, s68
    s_add_u32 s10, s10, s11
    s_add_u32 s10, s10, s43
    s_waitcnt lgkmcnt(2)
    buffer_store_dwordx4 v[136:139], v1, s[20:23], s10 offen sc1
    s_add_u32 s10, s42, 3
    s_mul_i32 s11, s10, s67
    s_lshr_b32 s11, s11, 10
    s_mul_i32 s29, s11, s66
    s_sub_u32 s10, s10, s29
    s_lshl_b32 s10, s10, 10
    s_mul_i32 s11, s11, s68
    s_add_u32 s10, s10, s11
    s_add_u32 s10, s10, s43
    s_waitcnt lgkmcnt(0)
    buffer_store_dwordx4 v[140:143], v1, s[20:23], s10 offen sc1
    s_add_u32 s64, s64, 512
    s_add_u32 s65, s65, 4096
    s_setpc_b64 s[34:35]
A_pm:
    s_waitcnt vmcnt(0)
    s_call_b64 s[34:35], A_p1
    s_waitcnt vmcnt(4)
    s_mov_b32 s11, 0x40000
A_tk2:
    v_cmp_gt_i32 vcc, 0, v25
    s_cbranch_vccnz A_tk2_ok
    buffer_load_dwordx2 v[24:25], v18, s[56:59], 0 offen sc1
    s_sub_u32 s11, s11, 1
    s_waitcnt vmcnt(0)
    s_cmp_lg_u32 s11, 0
    s_cbranch_scc1 A_tk2
A_tk2_ok:
    v_readfirstlane_b32 s98, v24
    v_readfirstlane_b32 s99, v25
    v_mov_b32 v64, 0
    v_mov_b32 v65, 0
    v_mov_b32 v66, 0
    v_mov_b32 v67, 0
    v_mov_b32 v68, 0
    v_mov_b32 v69, 0
    v_mov_b32 v70, 0
    v_mov_b32 v71, 0
    v_lshlrev_b32 v5, 16, v44
    v_and_b32 v6, 0xffff0000, v44
    v_add_f32 v64, v64, v5
    v_add_f32 v65, v65, v6
    v_lshlrev_b32 v5, 16, v45
    v_and_b32 v6, 0xffff0000, v45
    v_add_f32 v66, v66, v5
    v_add_f32 v67, v67, v6
    v_lshlrev_b32 v5, 16, v46
    v_and_b32 v6, 0xffff0000, v46
    v_add_f32 v68, v68, v5
    v_add_f32 v69, v69, v6
    v_lshlrev_b32 v5, 16, v47
    v_and_b32 v6, 0xffff0000, v47
    v_add_f32 v70, v70, v5
    v_add_f32 v71, v71, v6
    v_lshlrev_b32 v5, 16, v48
    v_and_b32 v6, 0xffff0000, v48
    v_add_f32 v64, v64, v5
    v_add_f32 v65, v65, v6
    v_lshlrev_b32 v5, 16, v49
    v_and_b32 v6, 0xffff0000, v49
    v_add_f32 v66, v66, v5
    v_add_f32 v67, v67, v6
    v_lshlrev_b32 v5, 16, v50
    v_and_b32 v6, 0xffff0000, v50
    v_add_f32 v68, v68, v5
    v_add_f32 v69, v69, v6
    v_lshlrev_b32 v5, 16, v51
    v_and_b32 v6, 0xffff0000, v51
    v_add_f32 v70, v70, v5
    v_add_f32 v71, v71, v6
    v_lshlrev_b32 v5, 16, v52
    v_and_b32 v6, 0xffff0000, v52
    v_add_f32 v64, v64, v5
    v_add_f32 v65, v65, v6
    v_lshlrev_b32 v5, 16, v53
    v_and_b32 v6, 0xffff0000, v53
    v_add_f32 v66, v66, v5
    v_add_f32 v67, v67, v6
    v_lshlrev_b32 v5, 16, v54
    v_and_b32 v6, 0xffff0000, v54
    v_add_f32 v68, v68, v5
    v_add_f32 v69, v69, v6
    v_lshlrev_b32 v5, 16, v55
    v_and_b32 v6, 0xffff0000, v55
    v_add_f32 v70, v70, v5
    v_add_f32 v71, v71, v6
    v_lshlrev_b32 v5, 16, v56
    v_and_b32 v6, 0xffff0000, v56
    v_add_f32 v64, v64, v5
    v_add_f32 v65, v65, v6
    v_lshlrev_b32 v5, 16, v57
    v_and_b32 v6, 0xffff0000, v57
    v_add_f32 v66, v66, v5
    v_add_f32 v67, v67, v6
    v_lshlrev_b32 v5, 16, v58
    v_and_b32 v6, 0xffff0000, v58
    v_add_f32 v68, v68, v5
    v_add_f32 v69, v69, v6
    v_lshlrev_b32 v5, 16, v59
    v_and_b32 v6, 0xffff0000, v59
    v_add_f32 v70, v70, v5
    v_add_f32 v71, v71, v6
    v_lshlrev_b32 v5, 16, v60
    v_and_b32 v6, 0xffff0000, v60
    v_add_f32 v64, v64, v5
    v_add_f32 v65, v65, v6
    v_lshlrev_b32 v5, 16, v61
    v_and_b32 v6, 0xffff0000, v61
    v_add_f32 v66, v66, v5
    v_add_f32 v67, v67, v6
    v_lshlrev_b32 v5, 16, v62
    v_and_b32 v6, 0xffff0000, v62
    v_add_f32 v68, v68, v5
    v_add_f32 v69, v69, v6
    v_lshlrev_b32 v5, 16, v63
    v_and_b32 v6, 0xffff0000, v63
    v_add_f32 v70, v70, v5
    v_add_f32 v71, v71, v6
    s_nop 1
    v_add_f32_dpp v64, v64, v64 row_ror:8 row_mask:0xf bank_mask:0xf
    v_add_f32_dpp v65, v65, v65 row_ror:8 row_mask:0xf bank_mask:0xf
    v_add_f32_dpp v66, v66, v66 row_ror:8 row_mask:0xf bank_mask:0xf
    v_add_f32_dpp v67, v67, v67 row_ror:8 row_mask:0xf bank_mask:0xf
    v_add_f32_dpp v68, v68, v68 row_ror:8 row_mask:0xf bank_mask:0xf
    v_add_f32_dpp v69, v69, v69 row_ror:8 row_mask:0xf bank_mask:0xf
    v_add_f32_dpp v70, v70, v70 row_ror:8 row_mask:0xf bank_mask:0xf
    v_add_f32_dpp v71, v71, v71 row_ror:8 row_mask:0xf bank_mask:0xf
    v_mov_b32 v72, v64
    v_mov_b32 v73, v65
    v_mov_b32 v74, v66
    v_mov_b32 v75, v67
    v_mov_b32 v76, v68
    v_mov_b32 v77, v69
    v_mov_b32 v78, v70
    v_mov_b32 v79, v71
    s_nop 1
    v_permlane16_swap_b32 v64, v72
    v_permlane16_swap_b32 v65, v73
    v_permlane16_swap_b32 v66, v74
    v_permlane16_swap_b32 v67, v75
    v_permlane16_swap_b32 v68, v76
    v_permlane16_swap_b32 v69, v77
    v_permlane16_swap_b32 v70, v78
    v_permlane16_swap_b32 v71, v79
    s_nop 1
    v_add_f32 v64, v64, v72
    v_add_f32 v65, v65, v73
    v_add_f32 v66, v66, v74
    v_add_f32 v67, v67, v75
    v_add_f32 v68, v68, v76
    v_add_f32 v69, v69, v77
    v_add_f32 v70, v70, v78
    v_add_f32 v71, v71, v79
    v_mov_b32 v72, v64
    v_mov_b32 v73, v65
    v_mov_b32 v74, v66
    v_mov_b32 v75, v67
    v_mov_b32 v76, v68
    v_mov_b32 v77, v69
    v_mov_b32 v78, v70
    v_mov_b32 v79, v71
    s_nop 1
    v_permlane32_swap_b32 v64, v72
    v_permlane32_swap_b32 v65, v73
    v_permlane32_swap_b32 v66, v74
    v_permlane32_swap_b32 v67, v75
    v_permlane32_swap_b32 v68, v76
    v_permlane32_swap_b32 v69, v77
    v_permlane32_swap_b32 v70, v78
    v_permlane32_swap_b32 v71, v79
    s_nop 1
    v_add_f32 v64, v64, v72
    v_add_f32 v65, v65, v73
    v_add_f32 v66, v66, v74
    v_add_f32 v67, v67, v75
    v_add_f32 v68, v68, v76
    v_add_f32 v69, v69, v77
    v_add_f32 v70, v70, v78
    v_add_f32 v71, v71, v79
    s_lshl_b32 s10, s24, 8
    s_add_u32 s10, s10, 131072
    v_lshl_add_u32 v5, v9, 1, s10
    ds_write_b128 v5, v[64:67]
    ds_write_b128 v5, v[68:71] offset:16
    s_cmp_lt_u32 s24, 4
    s_cbranch_scc1 A_p8
    s_mov_b32 s38, 0x3f803f80
    v_mov_b32 v20, 0
    v_mov_b32 v21, 0
    v_dot2c_f32_bf16 v20, s38, v32
    v_dot2c_f32_bf16 v21, v32, v32
    v_dot2c_f32_bf16 v20, s38, v33
    v_dot2c_f32_bf16 v21, v33, v33
    v_dot2c_f32_bf16 v20, s38, v34
    v_dot2c_f32_bf16 v21, v34, v34
    v_dot2c_f32_bf16 v20, s38, v35
    v_dot2c_f32_bf16 v21, v35, v35
    v_dot2c_f32_bf16 v20, s38, v36
    v_dot2c_f32_bf16 v21, v36, v36
    v_dot2c_f32_bf16 v20, s38, v37
    v_dot2c_f32_bf16 v21, v37, v37
    v_dot2c_f32_bf16 v20, s38, v38
    v_dot2c_f32_bf16 v21, v38, v38
    v_dot2c_f32_bf16 v20, s38, v39
    v_dot2c_f32_bf16 v21, v39, v39
    v_dot2c_f32_bf16 v20, s38, v40
    v_dot2c_f32_bf16 v21, v40, v40
    v_dot2c_f32_bf16 v20, s38, v41
    v_dot2c_f32_bf16 v21, v41, v41
    v_dot2c_f32_bf16 v20, s38, v42
    v_dot2c_f32_bf16 v21, v42, v42
    v_dot2c_f32_bf16 v20, s38, v43
    v_dot2c_f32_bf16 v21, v43, v43
    s_nop 3
    v_add_f32_dpp v20, v20, v20 quad_perm:[1,0,3,2] row_mask:0xf bank_mask:0xf
    v_add_f32_dpp v21, v21, v21 quad_perm:[1,0,3,2] row_mask:0xf bank_mask:0xf
    s_nop 1
    v_add_f32_dpp v20, v20, v20 quad_perm:[2,3,0,1] row_mask:0xf bank_mask:0xf
    v_add_f32_dpp v21, v21, v21 quad_perm:[2,3,0,1] row_mask:0xf bank_mask:0xf
    s_nop 1
    v_add_f32_dpp v20, v20, v20 row_half_mirror row_mask:0xf bank_mask:0xf
    v_add_f32_dpp v21, v21, v21 row_half_mirror row_mask:0xf bank_mask:0xf
    s_nop 1
    v_add_f32_dpp v20, v20, v20 row_mirror row_mask:0xf bank_mask:0xf
    v_add_f32_dpp v21, v21, v21 row_mirror row_mask:0xf bank_mask:0xf
    s_nop 1
    v_mov_b32 v22, v20
    v_mov_b32 v23, v21
    s_nop 1
    v_permlane16_swap_b32 v20, v22
    v_permlane16_swap_b32 v21, v23
    s_nop 1
    v_add_f32 v20, v20, v22
    v_add_f32 v21, v21, v23
    v_mul_f32 v20, 0x3acccccd, v20
    v_mul_f32 v21, 0x3acccccd, v21
    v_fma_f32 v21, -v20, v20, v21
    v_max_f32 v21, 0, v21
    v_add_f32 v21, 0x3727c5ac, v21
    v_rsq_f32 v22, v21
    s_lshl_b32 s36, s36, 5
    s_add_u32 s36, s36, 17022976
    v_lshlrev_b32 v5, 4, v4
    v_mul_f32 v23, v20, v22
    v_sub_f32 v23, 0, v23
    s_mov_b32 exec_lo, 1
    s_mov_b32 exec_hi, 1
    buffer_store_dwordx4 v[22:25], v5, s[20:23], s36 offen sc1
    s_mov_b64 exec, -1
A_p8:
    s_waitcnt lgkmcnt(0)
    s_barrier
    s_cmp_lg_u32 s24, 0
    s_cbranch_scc1 A_p7
    s_cmp_ge_u32 s26, 60
    s_cbranch_scc1 A_p7
    v_lshlrev_b32 v5, 3, v3
    v_add_u32 v5, 131072, v5
    ds_read_b64 v[64:65], v5 offset:0
    ds_read_b64 v[66:67], v5 offset:256
    ds_read_b64 v[68:69], v5 offset:512
    ds_read_b64 v[70:71], v5 offset:768
    ds_read_b64 v[72:73], v5 offset:1024
    ds_read_b64 v[74:75], v5 offset:1280
    ds_read_b64 v[76:77], v5 offset:1536
    ds_read_b64 v[78:79], v5 offset:1792
    s_lshr_b32 s10, s26, 1
    s_lshl_b32 s10, s10, 9
    s_and_b32 s11, s26, 1
    s_mul_i32 s11, s11, 15360
    s_add_u32 s10, s10, s11
    s_add_u32 s10, s10, 17055744
    v_lshlrev_b32 v5, 4, v3
    s_waitcnt lgkmcnt(0)
    v_pk_add_f32 v[64:65], v[64:65], v[72:73]
    v_pk_add_f32 v[66:67], v[66:67], v[74:75]
    v_pk_add_f32 v[68:69], v[68:69], v[76:77]
    v_pk_add_f32 v[70:71], v[70:71], v[78:79]
    v_pk_add_f32 v[64:65], v[64:65], v[68:69]
    v_pk_add_f32 v[66:67], v[66:67], v[70:71]
    v_pk_add_f32 v[22:23], v[64:65], v[66:67]
    s_mov_b32 exec_hi, 0
    buffer_store_dwordx4 v[22:25], v5, s[20:23], s10 offen sc1
    s_mov_b32 exec_hi, -1
A_p7:
    s_call_b64 s[34:35], A_p1
    s_call_b64 s[34:35], A_p1
    s_cmp_ge_u32 s40, 1640
    s_cbranch_scc1 A_p9
    s_call_b64 s[34:35], A_p1
    s_waitcnt vmcnt(12)
    s_call_b64 s[34:35], A_q1
A_p9:
    s_waitcnt vmcnt(8)
    s_call_b64 s[34:35], A_q1
    s_waitcnt vmcnt(8)
    s_call_b64 s[34:35], A_q1
    s_waitcnt vmcnt(8)
    s_call_b64 s[34:35], A_q1
    s_getreg_b32 s10, hwreg(HW_REG_XCC_ID)
    s_and_b32 s10, s10, 15
    s_add_u32 s10, s10, 1
    v_mov_b32 v26, s10
    s_lshl_b32 s10, s2, 7
    s_add_u32 s10, s10, 16957440
    s_waitcnt vmcnt(0)
    s_barrier
    s_cmp_lg_u32 s24, 0
    s_cbranch_scc1 A_pe
    s_mov_b64 exec, 1
    buffer_store_dwordx4 v[24:27], v18, s[20:23], s10 offen sc1
    s_mov_b64 exec, -1
A_pe:
F_main:
    s_load_dwordx2 s[6:7], s[0:1], 56
    s_mov_b32 s8, s62
    s_mov_b32 s9, s63
    s_and_b32 s25, s2, 7
    s_lshr_b32 s26, s2, 3
    s_and_b32 s10, s26, 3
    s_lshl_b32 s38, s25, 2
    s_add_u32 s38, s38, s10
    s_lshr_b32 s39, s26, 2
    s_lshr_b32 s64, s38, 3
    s_lshl_b32 s64, s64, 11
    s_add_u32 s64, s64, 16924672
    v_lshrrev_b32 v5, 2, v2
    v_lshlrev_b32 v5, 7, v5
    v_and_b32 v6, 3, v2
    v_lshl_add_u32 v14, v6, 3, v5
    v_lshlrev_b32 v125, 4, v2
    s_mul_i32 s29, s38, 163840
    s_add_u32 s37, s29, 163840
    s_mul_i32 s34, s39, 20480
    s_add_u32 s34, s34, s29
    s_cmp_lt_u32 s24, 4
    s_cbranch_scc1 F_m1
    v_and_b32 v15, 8, v14
    v_bfe_u32 v7, v2, 1, 2
    v_min_u32 v7, 2, v7
    v_lshl_add_u32 v15, v7, 13, v15
    s_sub_u32 s10, s24, 4
    s_lshl_b32 s11, s39, 8
    s_add_u32 s31, s64, s11
    s_lshr_b32 s11, s10, 1
    s_lshl_b32 s11, s11, 7
    s_add_u32 s31, s31, s11
    s_and_b32 s11, s10, 1
    s_lshl_b32 s11, s11, 4
    s_add_u32 s31, s31, s11
    s_lshl_b32 s28, s38, 3
    s_add_u32 s28, s28, s39
    s_lshl_b32 s28, s28, 2
    s_add_u32 s28, s28, s10
    s_mul_i32 s28, s28, 2560
    s_add_u32 s28, s28, 5242880
    s_mov_b32 s11, 0x40000
F_s0_poll:
    s_sleep 10
    buffer_load_dwordx2 v[6:7], v15, s[20:23], s31 offen offset:0 sc1
    s_sub_u32 s11, s11, 1
    s_cmp_eq_u32 s11, 0
    s_cbranch_scc1 F_s0_got
    s_waitcnt vmcnt(0)
    v_cmp_ne_u64 vcc, s[98:99], v[6:7]
    s_cbranch_vccnz F_s0_poll
F_s0_got:
    s_mul_i32 s11, s10, 2560
    s_add_u32 m0, s11, 151552
    s_mul_i32 s11, s10, 5120
    buffer_load_dwordx4 v125, s[20:23], s28 offen sc1 lds
    buffer_load_dwordx4 v125, s[20:23], s28 offen offset:1024 sc1 lds
    s_mov_b32 exec_hi, 0
    buffer_load_dwordx4 v125, s[20:23], s28 offen offset:2048 sc1 lds
    s_mov_b32 exec_hi, -1
    s_mov_b32 m0, s11
    s_add_u32 s11, s11, s34
    buffer_load_dwordx4 v125, s[20:23], s11 offen sc1 lds
    buffer_load_dwordx4 v125, s[20:23], s11 offen offset:1024 sc1 lds
    buffer_load_dwordx4 v125, s[20:23], s11 offen offset:2048 sc1 lds
    buffer_load_dwordx4 v125, s[20:23], s11 offen offset:3072 sc1 lds
    s_add_u32 m0, m0, 4096
    s_add_u32 s11, s11, 4096
    buffer_load_dwordx4 v125, s[20:23], s11 offen sc1 lds
F_m1:
    v_lshlrev_b32 v41, 3, v3
    v_add_u32 v41, 1024, v41
    s_lshl_b32 s30, s24, 10
    s_add_u32 s30, s30, 20480
    s_add_u32 s34, s34, s30
    s_sub_u32 s10, s34, 163840
    s_cmp_ge_u32 s34, s37
    s_cselect_b32 s34, s10, s34
    s_waitcnt lgkmcnt(0)
    s_mov_b32 s12, s4
    s_mov_b32 s13, s5
    s_mov_b32 s14, 0x280000
    s_mov_b32 s15, 0x20000
    s_mov_b32 s40, s6
    s_mov_b32 s41, s7
    s_mov_b32 s42, 0x280000
    s_mov_b32 s43, 0x20000
    s_getreg_b32 s55, hwreg(HW_REG_XCC_ID)
    v_lshlrev_b32 v40, 4, v2
    s_mul_i32 s52, s25, 1130496
    s_add_u32 s52, s52, 7864320
    s_lshl_b32 s53, s25, 11
    s_add_u32 s53, s53, 16908288
    s_and_b32 s55, s55, 15
    s_add_u32 s55, s55, 1
    v_mul_u32_u24 v5, 20, v4
    v_add_u32 v5, v5, v3
    v_lshlrev_b32 v5, 4, v5
    v_add_u32 v42, 1280, v5
    s_mov_b32 s32, 0x000fffff
    s_mov_b32 s33, 0x000fffff
    v_lshlrev_b32 v124, 3, v3
    v_lshlrev_b32 v121, 7, v2
    s_lshr_b32 s56, s26, 3
    s_and_b32 s57, s26, 7
    s_add_u32 s58, s24, s57
    s_and_b32 s58, s58, 3
    s_lshr_b32 s59, s24, 2
    s_lshl_b32 s10, s56, 2
    s_add_u32 s66, s10, s58
    v_add_u32 v5, 0, v0
    v_mul_u32_u24 v6, 6554, v5
    v_lshrrev_b32 v6, 16, v6
    v_mul_u32_u24 v7, 10, v6
    v_sub_u32 v5, v5, v7
    v_mul_u32_u24 v6, 1280, v6
    v_lshl_add_u32 v112, v5, 4, v6
    v_add_u32 v5, 512, v0
    v_mul_u32_u24 v6, 6554, v5
    v_lshrrev_b32 v6, 16, v6
    v_mul_u32_u24 v7, 10, v6
    v_sub_u32 v5, v5, v7
    v_mul_u32_u24 v6, 1280, v6
    v_lshl_add_u32 v113, v5, 4, v6
    s_mul_i32 s65, s57, 245760
    s_add_u32 s65, s65, 17088512
    s_mul_i32 s35, s26, 122880
    s_add_u32 s35, s35, 19873792
    s_cmp_eq_u32 s59, 0
    s_cselect_b32 s35, s35, s65
    s_mul_i32 s10, s24, 30720
    s_add_u32 s35, s35, s10
    s_lshl_b32 s67, s24, 10
    s_mul_i32 s68, s57, 102400
    s_add_u32 s68, s68, s67
    s_add_u32 s68, s68, 19054592
    s_lshl_b32 s11, s25, 2
    s_add_u32 s11, s11, s56
    s_mul_i32 s69, s11, 81920
    s_mul_i32 s10, s57, 160
    s_add_u32 s69, s69, s10
    s_mul_i32 s36, s26, 25088
    s_mul_i32 s10, s24, 3200
    s_add_u32 s36, s36, s10
    s_add_u32 s36, s36, 327680
    s_add_u32 s36, s36, s52
    s_mov_b32 s50, 16957440
    s_mov_b32 s51, 16982016
    v_and_b32 v5, 27, v2
    v_cmp_eq_u32 vcc, 24, v5
    v_mov_b32 v6, 0x3f803f80
    s_nop 1
    v_cndmask_b32 v24, 0, v6, vcc
    v_cndmask_b32 v25, 0, v6, vcc
    v_cndmask_b32 v26, 0, v6, vcc
    v_cndmask_b32 v27, 0, v6, vcc
    v_cndmask_b32 v28, 0, v6, vcc
    v_cndmask_b32 v29, 0, v6, vcc
    v_cndmask_b32 v30, 0, v6, vcc
    v_cndmask_b32 v31, 0, v6, vcc
    v_mov_b32 v96, 0
    v_mov_b32 v97, 0
    v_mov_b32 v98, 0
    v_mov_b32 v99, 0
    v_mov_b32 v100, 0
    v_mov_b32 v101, 0
    v_mov_b32 v102, 0
    v_mov_b32 v103, 0
    v_mov_b32 v104, 0
    v_mov_b32 v105, 0
    v_mov_b32 v106, 0
    v_mov_b32 v107, 0
    v_mov_b32 v108, 0
    v_mov_b32 v109, 0
    v_mov_b32 v110, 0
    v_mov_b32 v111, 0
    v_mov_b32 v36, 0
    v_mov_b32 v37, 0
    v_mov_b32 v38, 0
    v_mov_b32 v39, 0
    s_mul_i32 s10, s24, 1280
    s_add_u32 s10, s10, 151552
    v_add_u32 v5, s10, v40
    v_add_u32 v6, s10, v41
    v_mov_b32 v12, 0
    v_mov_b32 v13, 0
    s_add_u32 s64, s64, 8192
    s_cmp_lt_u32 s24, 4
    s_cbranch_scc1 F_m3
    s_waitcnt vmcnt(0)
F_m3:
    s_barrier
    ds_read_b128 v[8:11], v5
    s_mov_b32 exec_hi, 0
    ds_read_b64 v[12:13], v6
    s_mov_b32 exec_hi, -1
    ds_read_b128 v[16:19], v40
    ds_read_b64 v[20:21], v41
    s_add_u32 s28, s64, 8192
    buffer_load_dwordx2 v[114:115], v14, s[20:23], s64 offen sc1
    buffer_load_dwordx2 v[116:117], v14, s[20:23], s28 offen sc1
    s_waitcnt lgkmcnt(0)
    v_mfma_f32_32x32x16_bf16 v[64:79], v[16:19], v[8:11], 0
    v_mfma_f32_32x32x8_bf16 v[64:79], v[20:21], v[12:13], v[64:79]
    ds_read_b128 v[16:19], v40 offset:2560
    ds_read_b64 v[20:21], v41 offset:2560
    s_nop 6
    s_nop 2
    v_max3_f32 v5, v64, v65, v66
    v_max3_f32 v6, v67, v68, v69
    v_max3_f32 v5, v5, v70, v71
    v_max3_f32 v6, v6, v72, v73
    v_max3_f32 v5, v5, v74, v75
    v_max3_f32 v6, v6, v76, v77
    v_max3_f32 v5, v5, v78, v79
    v_max_f32 v5, v5, v6
    v_mov_b32 v6, v5
    s_nop 1
    v_permlane32_swap_b32 v5, v6
    s_nop 1
    v_max_f32 v5, v5, v6
    v_sub_f32 v48, 0, v5
    v_sub_f32 v49, 0, v5
    v_sub_f32 v50, 0, v5
    v_sub_f32 v51, 0, v5
    v_sub_f32 v52, 0, v5
    v_sub_f32 v53, 0, v5
    v_sub_f32 v54, 0, v5
    v_sub_f32 v55, 0, v5
    v_sub_f32 v56, 0, v5
    v_sub_f32 v57, 0, v5
    v_sub_f32 v58, 0, v5
    v_sub_f32 v59, 0, v5
    v_sub_f32 v60, 0, v5
    v_sub_f32 v61, 0, v5
    v_sub_f32 v62, 0, v5
    v_sub_f32 v63, 0, v5
    v_sub_f32 v64, v64, v5
    v_sub_f32 v65, v65, v5
    v_sub_f32 v66, v66, v5
    v_sub_f32 v67, v67, v5
    v_sub_f32 v68, v68, v5
    v_sub_f32 v69, v69, v5
    v_sub_f32 v70, v70, v5
    v_sub_f32 v71, v71, v5
    v_sub_f32 v72, v72, v5
    v_sub_f32 v73, v73, v5
    v_sub_f32 v74, v74, v5
    v_sub_f32 v75, v75, v5
    v_sub_f32 v76, v76, v5
    v_sub_f32 v77, v77, v5
    v_sub_f32 v78, v78, v5
    v_sub_f32 v79, v79, v5
    s_setprio 3
    v_exp_f32 v64, v64
    v_exp_f32 v65, v65
    v_mfma_f32_32x32x16_bf16 v[96:111], v[28:31], v[36:39], v[96:111]
    s_mov_b64 exec, s[32:33]
    ds_read_b128 v[24:27], v42 offset:0
    ds_read_b128 v[28:31], v42 offset:640
    s_mov_b64 exec, -1
    v_exp_f32 v66, v66
    v_exp_f32 v67, v67
    v_exp_f32 v68, v68
    v_exp_f32 v69, v69
    v_exp_f32 v70, v70
    s_waitcnt lgkmcnt(2)
    v_mfma_f32_32x32x16_bf16 v[80:95], v[16:19], v[8:11], v[48:63]
    v_exp_f32 v71, v71
    v_cvt_pk_bf16_f32 v32, v64, v65
    v_cvt_pk_bf16_f32 v33, v66, v67
    v_cvt_pk_bf16_f32 v34, v68, v69
    v_cvt_pk_bf16_f32 v35, v70, v71
    v_exp_f32 v72, v72
    v_exp_f32 v73, v73
    v_mfma_f32_32x32x8_bf16 v[80:95], v[20:21], v[12:13], v[80:95]
    ds_read_b128 v[16:19], v40 offset:5120
    ds_read_b64 v[20:21], v41 offset:5120
    v_exp_f32 v74, v74
    v_exp_f32 v75, v75
    v_exp_f32 v76, v76
    v_exp_f32 v77, v77
    v_exp_f32 v78, v78
    s_waitcnt lgkmcnt(2)
    v_mfma_f32_32x32x16_bf16 v[96:111], v[24:27], v[32:35], v[96:111]
    v_exp_f32 v79, v79
    v_cvt_pk_bf16_f32 v36, v72, v73
    v_cvt_pk_bf16_f32 v37, v74, v75
    v_cvt_pk_bf16_f32 v38, v76, v77
    v_cvt_pk_bf16_f32 v39, v78, v79
    s_setprio 2
    v_exp_f32 v80, v80
    v_exp_f32 v81, v81
    v_mfma_f32_32x32x16_bf16 v[96:111], v[28:31], v[36:39], v[96:111]
    s_mov_b64 exec, s[32:33]
    ds_read_b128 v[24:27], v42 offset:2560
    ds_read_b128 v[28:31], v42 offset:3200
    s_mov_b64 exec, -1
    v_exp_f32 v82, v82
    v_exp_f32 v83, v83
    v_exp_f32 v84, v84
    v_exp_f32 v85, v85
    v_exp_f32 v86, v86
    s_waitcnt lgkmcnt(2)
    v_mfma_f32_32x32x16_bf16 v[64:79], v[16:19], v[8:11], v[48:63]
    v_exp_f32 v87, v87
    v_cvt_pk_bf16_f32 v32, v80, v81
    v_cvt_pk_bf16_f32 v33, v82, v83
    v_cvt_pk_bf16_f32 v34, v84, v85
    v_cvt_pk_bf16_f32 v35, v86, v87
    v_exp_f32 v88, v88
    v_exp_f32 v89, v89
    v_mfma_f32_32x32x8_bf16 v[64:79], v[20:21], v[12:13], v[64:79]
    ds_read_b128 v[16:19], v40 offset:7680
    ds_read_b64 v[20:21], v41 offset:7680
    s_mov_b32 s11, 0x40000
    s_waitcnt vmcnt(0)
F_kc:
    v_cmp_ne_u64 vcc, s[98:99], v[114:115]
    s_mov_b64 s[16:17], vcc
    v_cmp_ne_u64 vcc, s[98:99], v[116:117]
    s_or_b64 s[16:17], s[16:17], vcc
    s_cbranch_scc0 F_ko
    buffer_load_dwordx2 v[114:115], v14, s[20:23], s64 offen sc1
    buffer_load_dwordx2 v[116:117], v14, s[20:23], s28 offen sc1
    s_sub_u32 s11, s11, 1
    s_waitcnt vmcnt(0)
    s_cmp_lg_u32 s11, 0
    s_cbranch_scc1 F_kc
F_ko:
    s_mov_b32 m0, s30
    s_add_u32 s30, s30, 8192
    buffer_load_dwordx4 v125, s[20:23], s34 offen sc1 lds
    s_add_u32 s34, s34, 8192
    s_sub_u32 s10, s34, 163840
    s_cmp_ge_u32 s34, s37
    s_cselect_b32 s34, s10, s34
    v_exp_f32 v90, v90
    v_exp_f32 v91, v91
    v_exp_f32 v92, v92
    v_exp_f32 v93, v93
    v_exp_f32 v94, v94
    s_waitcnt lgkmcnt(2)
    v_mfma_f32_32x32x16_bf16 v[96:111], v[24:27], v[32:35], v[96:111]
    v_exp_f32 v95, v95
    v_cvt_pk_bf16_f32 v36, v88, v89
    v_cvt_pk_bf16_f32 v37, v90, v91
    v_cvt_pk_bf16_f32 v38, v92, v93
    v_cvt_pk_bf16_f32 v39, v94, v95
    s_setprio 1
    v_exp_f32 v64, v64
    v_exp_f32 v65, v65
    v_mfma_f32_32x32x16_bf16 v[96:111], v[28:31], v[36:39], v[96:111]
    s_mov_b64 exec, s[32:33]
    ds_read_b128 v[24:27], v42 offset:5120
    ds_read_b128 v[28:31], v42 offset:5760
    s_mov_b64 exec, -1
    s_mov_b32 m0, s30
    s_add_u32 s30, s30, 8192
    buffer_load_dwordx4 v125, s[20:23], s34 offen sc1 lds
    s_add_u32 s34, s34, 8192
    s_sub_u32 s10, s34, 163840
    s_cmp_ge_u32 s34, s37
    s_cselect_b32 s34, s10, s34
    v_exp_f32 v66, v66
    v_exp_f32 v67, v67
    v_exp_f32 v68, v68
    v_exp_f32 v69, v69
    v_exp_f32 v70, v70
    s_waitcnt lgkmcnt(2)
    v_mfma_f32_32x32x16_bf16 v[80:95], v[16:19], v[8:11], v[48:63]
    v_exp_f32 v71, v71
    v_cvt_pk_bf16_f32 v32, v64, v65
    v_cvt_pk_bf16_f32 v33, v66, v67
    v_cvt_pk_bf16_f32 v34, v68, v69
    v_cvt_pk_bf16_f32 v35, v70, v71
    v_exp_f32 v72, v72
    v_exp_f32 v73, v73
    v_mfma_f32_32x32x8_bf16 v[80:95], v[20:21], v[12:13], v[80:95]
    ds_read_b128 v[16:19], v40 offset:10240
    ds_read_b64 v[20:21], v41 offset:10240
    s_cmp_lg_u32 s24, 0
    s_cbranch_scc1 F_nofp
    s_cmp_ge_u32 s2, 192
    s_cbranch_scc1 F_nofp
    s_lshl_b32 s10, s2, 7
    v_mov_b32 v116, s98
    v_mov_b32 v117, s99
    v_mov_b32 v118, s55
    v_mov_b32 v119, s10
    s_mov_b64 exec, 1
    buffer_store_dwordx4 v[116:119], v119, s[20:23], s50 offen sc1
    s_mov_b64 exec, -1
F_nofp:
    v_exp_f32 v74, v74
    v_exp_f32 v75, v75
    v_exp_f32 v76, v76
    v_exp_f32 v77, v77
    v_exp_f32 v78, v78
    s_waitcnt lgkmcnt(2)
    v_mfma_f32_32x32x16_bf16 v[96:111], v[24:27], v[32:35], v[96:111]
    v_exp_f32 v79, v79
    v_cvt_pk_bf16_f32 v36, v72, v73
    v_cvt_pk_bf16_f32 v37, v74, v75
    v_cvt_pk_bf16_f32 v38, v76, v77
    v_cvt_pk_bf16_f32 v39, v78, v79
    s_setprio 0
    v_exp_f32 v80, v80
    v_exp_f32 v81, v81
    v_mfma_f32_32x32x16_bf16 v[96:111], v[28:31], v[36:39], v[96:111]
    s_mov_b64 exec, s[32:33]
    ds_read_b128 v[24:27], v42 offset:7680
    ds_read_b128 v[28:31], v42 offset:8320
    s_mov_b64 exec, -1
    v_exp_f32 v82, v82
    v_exp_f32 v83, v83
    v_exp_f32 v84, v84
    v_exp_f32 v85, v85
    v_exp_f32 v86, v86
    s_waitcnt lgkmcnt(2)
    v_mfma_f32_32x32x16_bf16 v[64:79], v[16:19], v[8:11], v[48:63]
    v_exp_f32 v87, v87
    v_cvt_pk_bf16_f32 v32, v80, v81
    v_cvt_pk_bf16_f32 v33, v82, v83
    v_cvt_pk_bf16_f32 v34, v84, v85
    v_cvt_pk_bf16_f32 v35, v86, v87
    v_exp_f32 v88, v88
    v_exp_f32 v89, v89
    v_mfma_f32_32x32x8_bf16 v[64:79], v[20:21], v[12:13], v[64:79]
    ds_read_b128 v[16:19], v40 offset:12800
    ds_read_b64 v[20:21], v41 offset:12800
    s_mov_b32 m0, s30
    s_add_u32 s30, s30, 8192
    buffer_load_dwordx4 v125, s[20:23], s34 offen sc1 lds
    s_add_u32 s34, s34, 8192
    s_sub_u32 s10, s34, 163840
    s_cmp_ge_u32 s34, s37
    s_cselect_b32 s34, s10, s34
    v_exp_f32 v90, v90
    v_exp_f32 v91, v91
    v_exp_f32 v92, v92
    v_exp_f32 v93, v93
    v_exp_f32 v94, v94
    s_waitcnt lgkmcnt(2)
    v_mfma_f32_32x32x16_bf16 v[96:111], v[24:27], v[32:35], v[96:111]
    v_exp_f32 v95, v95
    v_cvt_pk_bf16_f32 v36, v88, v89
    v_cvt_pk_bf16_f32 v37, v90, v91
    v_cvt_pk_bf16_f32 v38, v92, v93
    v_cvt_pk_bf16_f32 v39, v94, v95
    s_setprio 3
    v_exp_f32 v64, v64
    v_exp_f32 v65, v65
    v_mfma_f32_32x32x16_bf16 v[96:111], v[28:31], v[36:39], v[96:111]
    s_mov_b64 exec, s[32:33]
    ds_read_b128 v[24:27], v42 offset:10240
    ds_read_b128 v[28:31], v42 offset:10880
    s_mov_b64 exec, -1
    v_exp_f32 v66, v66
    v_exp_f32 v67, v67
    v_exp_f32 v68, v68
    v_exp_f32 v69, v69
    v_exp_f32 v70, v70
    s_waitcnt lgkmcnt(2)
    v_mfma_f32_32x32x16_bf16 v[80:95], v[16:19], v[8:11], v[48:63]
    v_exp_f32 v71, v71
    v_cvt_pk_bf16_f32 v32, v64, v65
    v_cvt_pk_bf16_f32 v33, v66, v67
    v_cvt_pk_bf16_f32 v34, v68, v69
    v_cvt_pk_bf16_f32 v35, v70, v71
    v_exp_f32 v72, v72
    v_exp_f32 v73, v73
    v_mfma_f32_32x32x8_bf16 v[80:95], v[20:21], v[12:13], v[80:95]
    ds_read_b128 v[16:19], v40 offset:15360
    ds_read_b64 v[20:21], v41 offset:15360
    s_mov_b32 m0, s30
    s_add_u32 s30, s30, 8192
    buffer_load_dwordx4 v125, s[20:23], s34 offen sc1 lds
    s_add_u32 s34, s34, 8192
    s_sub_u32 s10, s34, 163840
    s_cmp_ge_u32 s34, s37
    s_cselect_b32 s34, s10, s34
    v_exp_f32 v74, v74
    v_exp_f32 v75, v75
    v_exp_f32 v76, v76
    v_exp_f32 v77, v77
    v_exp_f32 v78, v78
    s_waitcnt lgkmcnt(2)
    v_mfma_f32_32x32x16_bf16 v[96:111], v[24:27], v[32:35], v[96:111]
    v_exp_f32 v79, v79
    v_cvt_pk_bf16_f32 v36, v72, v73
    v_cvt_pk_bf16_f32 v37, v74, v75
    v_cvt_pk_bf16_f32 v38, v76, v77
    v_cvt_pk_bf16_f32 v39, v78, v79
    s_setprio 2
    v_exp_f32 v80, v80
    v_exp_f32 v81, v81
    v_mfma_f32_32x32x16_bf16 v[96:111], v[28:31], v[36:39], v[96:111]
    s_mov_b64 exec, s[32:33]
    ds_read_b128 v[24:27], v42 offset:12800
    ds_read_b128 v[28:31], v42 offset:13440
    s_mov_b64 exec, -1
    v_exp_f32 v82, v82
    v_exp_f32 v83, v83
    v_exp_f32 v84, v84
    v_exp_f32 v85, v85
    v_exp_f32 v86, v86
    s_waitcnt lgkmcnt(2)
    v_mfma_f32_32x32x16_bf16 v[64:79], v[16:19], v[8:11], v[48:63]
    v_exp_f32 v87, v87
    v_cvt_pk_bf16_f32 v32, v80, v81
    v_cvt_pk_bf16_f32 v33, v82, v83
    v_cvt_pk_bf16_f32 v34, v84, v85
    v_cvt_pk_bf16_f32 v35, v86, v87
    v_exp_f32 v88, v88
    v_exp_f32 v89, v89
    v_mfma_f32_32x32x8_bf16 v[64:79], v[20:21], v[12:13], v[64:79]
    ds_read_b128 v[16:19], v40 offset:17920
    ds_read_b64 v[20:21], v41 offset:17920
    buffer_load_dwordx2 v[114:115], v121, s[20:23], s51 offen sc1
    v_exp_f32 v90, v90
    v_exp_f32 v91, v91
    v_exp_f32 v92, v92
    v_exp_f32 v93, v93
    v_exp_f32 v94, v94
    s_waitcnt lgkmcnt(2)
    v_mfma_f32_32x32x16_bf16 v[96:111], v[24:27], v[32:35], v[96:111]
    v_exp_f32 v95, v95
    v_cvt_pk_bf16_f32 v36, v88, v89
    v_cvt_pk_bf16_f32 v37, v90, v91
    v_cvt_pk_bf16_f32 v38, v92, v93
    v_cvt_pk_bf16_f32 v39, v94, v95
    s_waitcnt vmcnt(3)
    s_barrier
    s_setprio 1
    v_exp_f32 v64, v64
    v_exp_f32 v65, v65
    v_mfma_f32_32x32x16_bf16 v[96:111], v[28:31], v[36:39], v[96:111]
    s_mov_b64 exec, s[32:33]
    ds_read_b128 v[24:27], v42 offset:15360
    ds_read_b128 v[28:31], v42 offset:16000
    s_mov_b64 exec, -1
    v_exp_f32 v66, v66
    v_exp_f32 v67, v67
    v_exp_f32 v68, v68
    v_exp_f32 v69, v69
    v_exp_f32 v70, v70
    s_waitcnt lgkmcnt(2)
    v_mfma_f32_32x32x16_bf16 v[80:95], v[16:19], v[8:11], v[48:63]
    v_exp_f32 v71, v71
    v_cvt_pk_bf16_f32 v32, v64, v65
    v_cvt_pk_bf16_f32 v33, v66, v67
    v_cvt_pk_bf16_f32 v34, v68, v69
    v_cvt_pk_bf16_f32 v35, v70, v71
    v_exp_f32 v72, v72
    v_exp_f32 v73, v73
    v_mfma_f32_32x32x8_bf16 v[80:95], v[20:21], v[12:13], v[80:95]
    ds_read_b128 v[16:19], v40 offset:20480
    ds_read_b64 v[20:21], v41 offset:20480
    s_mov_b32 m0, s30
    s_add_u32 s30, s30, 8192
    buffer_load_dwordx4 v125, s[20:23], s34 offen sc1 lds
    s_add_u32 s34, s34, 8192
    s_sub_u32 s10, s34, 163840
    s_cmp_ge_u32 s34, s37
    s_cselect_b32 s34, s10, s34
    v_exp_f32 v74, v74
    v_exp_f32 v75, v75
    v_exp_f32 v76, v76
    v_exp_f32 v77, v77
    v_exp_f32 v78, v78
    s_waitcnt lgkmcnt(2)
    v_mfma_f32_32x32x16_bf16 v[96:111], v[24:27], v[32:35], v[96:111]
    v_exp_f32 v79, v79
    v_cvt_pk_bf16_f32 v36, v72, v73
    v_cvt_pk_bf16_f32 v37, v74, v75
    v_cvt_pk_bf16_f32 v38, v76, v77
    v_cvt_pk_bf16_f32 v39, v78, v79
    s_setprio 0
    v_exp_f32 v80, v80
    v_exp_f32 v81, v81
    v_mfma_f32_32x32x16_bf16 v[96:111], v[28:31], v[36:39], v[96:111]
    s_mov_b64 exec, s[32:33]
    ds_read_b128 v[24:27], v42 offset:17920
    ds_read_b128 v[28:31], v42 offset:18560
    s_mov_b64 exec, -1
    v_exp_f32 v82, v82
    v_exp_f32 v83, v83
    v_exp_f32 v84, v84
    v_exp_f32 v85, v85
    v_exp_f32 v86, v86
    s_waitcnt lgkmcnt(2)
    v_mfma_f32_32x32x16_bf16 v[64:79], v[16:19], v[8:11], v[48:63]
    v_exp_f32 v87, v87
    v_cvt_pk_bf16_f32 v32, v80, v81
    v_cvt_pk_bf16_f32 v33, v82, v83
    v_cvt_pk_bf16_f32 v34, v84, v85
    v_cvt_pk_bf16_f32 v35, v86, v87
    v_exp_f32 v88, v88
    v_exp_f32 v89, v89
    v_mfma_f32_32x32x8_bf16 v[64:79], v[20:21], v[12:13], v[64:79]
    ds_read_b128 v[16:19], v40 offset:23040
    ds_read_b64 v[20:21], v41 offset:23040
    v_exp_f32 v90, v90
    v_exp_f32 v91, v91
    v_exp_f32 v92, v92
    v_exp_f32 v93, v93
    v_exp_f32 v94, v94
    s_waitcnt lgkmcnt(2)
    v_mfma_f32_32x32x16_bf16 v[96:111], v[24:27], v[32:35], v[96:111]
    v_exp_f32 v95, v95
    v_cvt_pk_bf16_f32 v36, v88, v89
    v_cvt_pk_bf16_f32 v37, v90, v91
    v_cvt_pk_bf16_f32 v38, v92, v93
    v_cvt_pk_bf16_f32 v39, v94, v95
    s_setprio 3
    v_exp_f32 v64, v64
    v_exp_f32 v65, v65
    v_mfma_f32_32x32x16_bf16 v[96:111], v[28:31], v[36:39], v[96:111]
    s_mov_b64 exec, s[32:33]
    ds_read_b128 v[24:27], v42 offset:20480
    ds_read_b128 v[28:31], v42 offset:21120
    s_mov_b64 exec, -1
    v_exp_f32 v66, v66
    v_exp_f32 v67, v67
    v_exp_f32 v68, v68
    v_exp_f32 v69, v69
    v_exp_f32 v70, v70
    s_waitcnt lgkmcnt(2)
    v_mfma_f32_32x32x16_bf16 v[80:95], v[16:19], v[8:11], v[48:63]
    v_exp_f32 v71, v71
    v_cvt_pk_bf16_f32 v32, v64, v65
    v_cvt_pk_bf16_f32 v33, v66, v67
    v_cvt_pk_bf16_f32 v34, v68, v69
    v_cvt_pk_bf16_f32 v35, v70, v71
    v_exp_f32 v72, v72
    v_exp_f32 v73, v73
    v_mfma_f32_32x32x8_bf16 v[80:95], v[20:21], v[12:13], v[80:95]
    ds_read_b128 v[16:19], v40 offset:25600
    ds_read_b64 v[20:21], v41 offset:25600
    s_mov_b32 m0, s30
    s_add_u32 s30, s30, 8192
    buffer_load_dwordx4 v125, s[20:23], s34 offen sc1 lds
    s_add_u32 s34, s34, 8192
    s_sub_u32 s10, s34, 163840
    s_cmp_ge_u32 s34, s37
    s_cselect_b32 s34, s10, s34
    v_exp_f32 v74, v74
    v_exp_f32 v75, v75
    v_exp_f32 v76, v76
    v_exp_f32 v77, v77
    v_exp_f32 v78, v78
    s_waitcnt lgkmcnt(2)
    v_mfma_f32_32x32x16_bf16 v[96:111], v[24:27], v[32:35], v[96:111]
    v_exp_f32 v79, v79
    v_cvt_pk_bf16_f32 v36, v72, v73
    v_cvt_pk_bf16_f32 v37, v74, v75
    v_cvt_pk_bf16_f32 v38, v76, v77
    v_cvt_pk_bf16_f32 v39, v78, v79
    s_setprio 2
    v_exp_f32 v80, v80
    v_exp_f32 v81, v81
    v_mfma_f32_32x32x16_bf16 v[96:111], v[28:31], v[36:39], v[96:111]
    s_mov_b64 exec, s[32:33]
    ds_read_b128 v[24:27], v42 offset:23040
    ds_read_b128 v[28:31], v42 offset:23680
    s_mov_b64 exec, -1
    v_exp_f32 v82, v82
    v_exp_f32 v83, v83
    v_exp_f32 v84, v84
    v_exp_f32 v85, v85
    v_exp_f32 v86, v86
    s_waitcnt lgkmcnt(2)
    v_mfma_f32_32x32x16_bf16 v[64:79], v[16:19], v[8:11], v[48:63]
    v_exp_f32 v87, v87
    v_cvt_pk_bf16_f32 v32, v80, v81
    v_cvt_pk_bf16_f32 v33, v82, v83
    v_cvt_pk_bf16_f32 v34, v84, v85
    v_cvt_pk_bf16_f32 v35, v86, v87
    v_exp_f32 v88, v88
    v_exp_f32 v89, v89
    v_mfma_f32_32x32x8_bf16 v[64:79], v[20:21], v[12:13], v[64:79]
    ds_read_b128 v[16:19], v40 offset:28160
    ds_read_b64 v[20:21], v41 offset:28160
    s_mov_b32 s11, 0x40000
    s_waitcnt vmcnt(2)
F_fpc:
    v_cmp_ne_u64 vcc, s[98:99], v[114:115]
    s_cbranch_vccz F_fpo
    buffer_load_dwordx2 v[114:115], v121, s[20:23], s51 offen sc1
    s_sub_u32 s11, s11, 1
    s_waitcnt vmcnt(0)
    s_cmp_lg_u32 s11, 0
    s_cbranch_scc1 F_fpc
F_fpo:
    v_exp_f32 v90, v90
    v_exp_f32 v91, v91
    v_exp_f32 v92, v92
    v_exp_f32 v93, v93
    v_exp_f32 v94, v94
    s_waitcnt lgkmcnt(2)
    v_mfma_f32_32x32x16_bf16 v[96:111], v[24:27], v[32:35], v[96:111]
    v_exp_f32 v95, v95
    v_cvt_pk_bf16_f32 v36, v88, v89
    v_cvt_pk_bf16_f32 v37, v90, v91
    v_cvt_pk_bf16_f32 v38, v92, v93
    v_cvt_pk_bf16_f32 v39, v94, v95
    s_setprio 1
    v_exp_f32 v64, v64
    v_exp_f32 v65, v65
    v_mfma_f32_32x32x16_bf16 v[96:111], v[28:31], v[36:39], v[96:111]
    s_mov_b64 exec, s[32:33]
    ds_read_b128 v[24:27], v42 offset:25600
    ds_read_b128 v[28:31], v42 offset:26240
    s_mov_b64 exec, -1
    buffer_load_dwordx4 v[128:131], v125, s[20:23], s35 offen offset:0 sc1
    v_exp_f32 v66, v66
    v_exp_f32 v67, v67
    v_exp_f32 v68, v68
    v_exp_f32 v69, v69
    v_exp_f32 v70, v70
    s_waitcnt lgkmcnt(2)
    v_mfma_f32_32x32x16_bf16 v[80:95], v[16:19], v[8:11], v[48:63]
    v_exp_f32 v71, v71
    v_cvt_pk_bf16_f32 v32, v64, v65
    v_cvt_pk_bf16_f32 v33, v66, v67
    v_cvt_pk_bf16_f32 v34, v68, v69
    v_cvt_pk_bf16_f32 v35, v70, v71
    v_exp_f32 v72, v72
    v_exp_f32 v73, v73
    v_mfma_f32_32x32x8_bf16 v[80:95], v[20:21], v[12:13], v[80:95]
    ds_read_b128 v[16:19], v40 offset:30720
    ds_read_b64 v[20:21], v41 offset:30720
    s_mov_b32 m0, s30
    s_add_u32 s30, s30, 8192
    buffer_load_dwordx4 v125, s[20:23], s34 offen sc1 lds
    s_add_u32 s34, s34, 8192
    s_sub_u32 s10, s34, 163840
    s_cmp_ge_u32 s34, s37
    s_cselect_b32 s34, s10, s34
    v_exp_f32 v74, v74
    v_exp_f32 v75, v75
    v_exp_f32 v76, v76
    v_exp_f32 v77, v77
    v_exp_f32 v78, v78
    s_waitcnt lgkmcnt(2)
    v_mfma_f32_32x32x16_bf16 v[96:111], v[24:27], v[32:35], v[96:111]
    v_exp_f32 v79, v79
    v_cvt_pk_bf16_f32 v36, v72, v73
    v_cvt_pk_bf16_f32 v37, v74, v75
    v_cvt_pk_bf16_f32 v38, v76, v77
    v_cvt_pk_bf16_f32 v39, v78, v79
    s_setprio 0
    v_exp_f32 v80, v80
    v_exp_f32 v81, v81
    v_mfma_f32_32x32x16_bf16 v[96:111], v[28:31], v[36:39], v[96:111]
    s_mov_b64 exec, s[32:33]
    ds_read_b128 v[24:27], v42 offset:28160
    ds_read_b128 v[28:31], v42 offset:28800
    s_mov_b64 exec, -1
    v_exp_f32 v82, v82
    v_exp_f32 v83, v83
    v_exp_f32 v84, v84
    v_exp_f32 v85, v85
    v_exp_f32 v86, v86
    s_waitcnt lgkmcnt(2)
    v_mfma_f32_32x32x16_bf16 v[64:79], v[16:19], v[8:11], v[48:63]
    v_exp_f32 v87, v87
    v_cvt_pk_bf16_f32 v32, v80, v81
    v_cvt_pk_bf16_f32 v33, v82, v83
    v_cvt_pk_bf16_f32 v34, v84, v85
    v_cvt_pk_bf16_f32 v35, v86, v87
    v_exp_f32 v88, v88
    v_exp_f32 v89, v89
    v_mfma_f32_32x32x8_bf16 v[64:79], v[20:21], v[12:13], v[64:79]
    ds_read_b128 v[16:19], v40 offset:33280
    ds_read_b64 v[20:21], v41 offset:33280
    v_exp_f32 v90, v90
    v_exp_f32 v91, v91
    v_exp_f32 v92, v92
    v_exp_f32 v93, v93
    v_exp_f32 v94, v94
    s_waitcnt lgkmcnt(2)
    v_mfma_f32_32x32x16_bf16 v[96:111], v[24:27], v[32:35], v[96:111]
    v_exp_f32 v95, v95
    v_cvt_pk_bf16_f32 v36, v88, v89
    v_cvt_pk_bf16_f32 v37, v90, v91
    v_cvt_pk_bf16_f32 v38, v92, v93
    v_cvt_pk_bf16_f32 v39, v94, v95
    s_waitcnt vmcnt(2)
    s_barrier
    s_setprio 3
    v_exp_f32 v64, v64
    v_exp_f32 v65, v65
    v_mfma_f32_32x32x16_bf16 v[96:111], v[28:31], v[36:39], v[96:111]
    s_mov_b64 exec, s[32:33]
    ds_read_b128 v[24:27], v42 offset:30720
    ds_read_b128 v[28:31], v42 offset:31360
    s_mov_b64 exec, -1
    buffer_load_dwordx4 v[132:135], v125, s[20:23], s35 offen offset:1024 sc1
    v_exp_f32 v66, v66
    v_exp_f32 v67, v67
    v_exp_f32 v68, v68
    v_exp_f32 v69, v69
    v_exp_f32 v70, v70
    s_waitcnt lgkmcnt(2)
    v_mfma_f32_32x32x16_bf16 v[80:95], v[16:19], v[8:11], v[48:63]
    v_exp_f32 v71, v71
    v_cvt_pk_bf16_f32 v32, v64, v65
    v_cvt_pk_bf16_f32 v33, v66, v67
    v_cvt_pk_bf16_f32 v34, v68, v69
    v_cvt_pk_bf16_f32 v35, v70, v71
    v_exp_f32 v72, v72
    v_exp_f32 v73, v73
    v_mfma_f32_32x32x8_bf16 v[80:95], v[20:21], v[12:13], v[80:95]
    ds_read_b128 v[16:19], v40 offset:35840
    ds_read_b64 v[20:21], v41 offset:35840
    s_mov_b32 m0, s30
    s_add_u32 s30, s30, 8192
    buffer_load_dwordx4 v125, s[20:23], s34 offen sc1 lds
    s_add_u32 s34, s34, 8192
    s_sub_u32 s10, s34, 163840
    s_cmp_ge_u32 s34, s37
    s_cselect_b32 s34, s10, s34
    v_exp_f32 v74, v74
    v_exp_f32 v75, v75
    v_exp_f32 v76, v76
    v_exp_f32 v77, v77
    v_exp_f32 v78, v78
    s_waitcnt lgkmcnt(2)
    v_mfma_f32_32x32x16_bf16 v[96:111], v[24:27], v[32:35], v[96:111]
    v_exp_f32 v79, v79
    v_cvt_pk_bf16_f32 v36, v72, v73
    v_cvt_pk_bf16_f32 v37, v74, v75
    v_cvt_pk_bf16_f32 v38, v76, v77
    v_cvt_pk_bf16_f32 v39, v78, v79
    s_setprio 2
    v_exp_f32 v80, v80
    v_exp_f32 v81, v81
    v_mfma_f32_32x32x16_bf16 v[96:111], v[28:31], v[36:39], v[96:111]
    s_mov_b64 exec, s[32:33]
    ds_read_b128 v[24:27], v42 offset:33280
    ds_read_b128 v[28:31], v42 offset:33920
    s_mov_b64 exec, -1
    v_exp_f32 v82, v82
    v_exp_f32 v83, v83
    v_exp_f32 v84, v84
    v_exp_f32 v85, v85
    v_exp_f32 v86, v86
    s_waitcnt lgkmcnt(2)
    v_mfma_f32_32x32x16_bf16 v[64:79], v[16:19], v[8:11], v[48:63]
    v_exp_f32 v87, v87
    v_cvt_pk_bf16_f32 v32, v80, v81
    v_cvt_pk_bf16_f32 v33, v82, v83
    v_cvt_pk_bf16_f32 v34, v84, v85
    v_cvt_pk_bf16_f32 v35, v86, v87
    v_exp_f32 v88, v88
    v_exp_f32 v89, v89
    v_mfma_f32_32x32x8_bf16 v[64:79], v[20:21], v[12:13], v[64:79]
    ds_read_b128 v[16:19], v40 offset:38400
    ds_read_b64 v[20:21], v41 offset:38400
    v_exp_f32 v90, v90
    v_exp_f32 v91, v91
    v_exp_f32 v92, v92
    v_exp_f32 v93, v93
    v_exp_f32 v94, v94
    s_waitcnt lgkmcnt(2)
    v_mfma_f32_32x32x16_bf16 v[96:111], v[24:27], v[32:35], v[96:111]
    v_exp_f32 v95, v95
    v_cvt_pk_bf16_f32 v36, v88, v89
    v_cvt_pk_bf16_f32 v37, v90, v91
    v_cvt_pk_bf16_f32 v38, v92, v93
    v_cvt_pk_bf16_f32 v39, v94, v95
    s_setprio 1
    v_exp_f32 v64, v64
    v_exp_f32 v65, v65
    v_mfma_f32_32x32x16_bf16 v[96:111], v[28:31], v[36:39], v[96:111]
    s_mov_b64 exec, s[32:33]
    ds_read_b128 v[24:27], v42 offset:35840
    ds_read_b128 v[28:31], v42 offset:36480
    s_mov_b64 exec, -1
    buffer_load_dwordx4 v[136:139], v125, s[20:23], s35 offen offset:2048 sc1
    v_exp_f32 v66, v66
    v_exp_f32 v67, v67
    v_exp_f32 v68, v68
    v_exp_f32 v69, v69
    v_exp_f32 v70, v70
    s_waitcnt lgkmcnt(2)
    v_mfma_f32_32x32x16_bf16 v[80:95], v[16:19], v[8:11], v[48:63]
    v_exp_f32 v71, v71
    v_cvt_pk_bf16_f32 v32, v64, v65
    v_cvt_pk_bf16_f32 v33, v66, v67
    v_cvt_pk_bf16_f32 v34, v68, v69
    v_cvt_pk_bf16_f32 v35, v70, v71
    v_exp_f32 v72, v72
    v_exp_f32 v73, v73
    v_mfma_f32_32x32x8_bf16 v[80:95], v[20:21], v[12:13], v[80:95]
    ds_read_b128 v[16:19], v40 offset:40960
    ds_read_b64 v[20:21], v41 offset:40960
    s_mov_b32 m0, s30
    s_add_u32 s30, s30, 8192
    buffer_load_dwordx4 v125, s[20:23], s34 offen sc1 lds
    s_add_u32 s34, s34, 8192
    s_sub_u32 s10, s34, 163840
    s_cmp_ge_u32 s34, s37
    s_cselect_b32 s34, s10, s34
    v_exp_f32 v74, v74
    v_exp_f32 v75, v75
    v_exp_f32 v76, v76
    v_exp_f32 v77, v77
    v_exp_f32 v78, v78
    s_waitcnt lgkmcnt(2)
    v_mfma_f32_32x32x16_bf16 v[96:111], v[24:27], v[32:35], v[96:111]
    v_exp_f32 v79, v79
    v_cvt_pk_bf16_f32 v36, v72, v73
    v_cvt_pk_bf16_f32 v37, v74, v75
    v_cvt_pk_bf16_f32 v38, v76, v77
    v_cvt_pk_bf16_f32 v39, v78, v79
    s_setprio 0
    v_exp_f32 v80, v80
    v_exp_f32 v81, v81
    v_mfma_f32_32x32x16_bf16 v[96:111], v[28:31], v[36:39], v[96:111]
    s_mov_b64 exec, s[32:33]
    ds_read_b128 v[24:27], v42 offset:38400
    ds_read_b128 v[28:31], v42 offset:39040
    s_mov_b64 exec, -1
    v_exp_f32 v82, v82
    v_exp_f32 v83, v83
    v_exp_f32 v84, v84
    v_exp_f32 v85, v85
    v_exp_f32 v86, v86
    s_waitcnt lgkmcnt(2)
    v_mfma_f32_32x32x16_bf16 v[64:79], v[16:19], v[8:11], v[48:63]
    v_exp_f32 v87, v87
    v_cvt_pk_bf16_f32 v32, v80, v81
    v_cvt_pk_bf16_f32 v33, v82, v83
    v_cvt_pk_bf16_f32 v34, v84, v85
    v_cvt_pk_bf16_f32 v35, v86, v87
    v_exp_f32 v88, v88
    v_exp_f32 v89, v89
    v_mfma_f32_32x32x8_bf16 v[64:79], v[20:21], v[12:13], v[64:79]
    ds_read_b128 v[16:19], v40 offset:43520
    ds_read_b64 v[20:21], v41 offset:43520
    v_exp_f32 v90, v90
    v_exp_f32 v91, v91
    v_exp_f32 v92, v92
    v_exp_f32 v93, v93
    v_exp_f32 v94, v94
    s_waitcnt lgkmcnt(2)
    v_mfma_f32_32x32x16_bf16 v[96:111], v[24:27], v[32:35], v[96:111]
    v_exp_f32 v95, v95
    v_cvt_pk_bf16_f32 v36, v88, v89
    v_cvt_pk_bf16_f32 v37, v90, v91
    v_cvt_pk_bf16_f32 v38, v92, v93
    v_cvt_pk_bf16_f32 v39, v94, v95
    s_setprio 3
    v_exp_f32 v64, v64
    v_exp_f32 v65, v65
    v_mfma_f32_32x32x16_bf16 v[96:111], v[28:31], v[36:39], v[96:111]
    s_mov_b64 exec, s[32:33]
    ds_read_b128 v[24:27], v42 offset:40960
    ds_read_b128 v[28:31], v42 offset:41600
    s_mov_b64 exec, -1
    buffer_load_dwordx4 v[140:143], v125, s[20:23], s35 offen offset:3072 sc1
    s_add_u32 s35, s35, 4096
    v_exp_f32 v66, v66
    v_exp_f32 v67, v67
    v_exp_f32 v68, v68
    v_exp_f32 v69, v69
    v_exp_f32 v70, v70
    s_waitcnt lgkmcnt(2)
    v_mfma_f32_32x32x16_bf16 v[80:95], v[16:19], v[8:11], v[48:63]
    v_exp_f32 v71, v71
    v_cvt_pk_bf16_f32 v32, v64, v65
    v_cvt_pk_bf16_f32 v33, v66, v67
    v_cvt_pk_bf16_f32 v34, v68, v69
    v_cvt_pk_bf16_f32 v35, v70, v71
    v_exp_f32 v72, v72
    v_exp_f32 v73, v73
    v_mfma_f32_32x32x8_bf16 v[80:95], v[20:21], v[12:13], v[80:95]
    ds_read_b128 v[16:19], v40 offset:46080
    ds_read_b64 v[20:21], v41 offset:46080
    s_mov_b32 m0, s30
    s_add_u32 s30, s30, 8192
    buffer_load_dwordx4 v125, s[20:23], s34 offen sc1 lds
    s_add_u32 s34, s34, 8192
    s_sub_u32 s10, s34, 163840
    s_cmp_ge_u32 s34, s37
    s_cselect_b32 s34, s10, s34
    v_exp_f32 v74, v74
    v_exp_f32 v75, v75
    v_exp_f32 v76, v76
    v_exp_f32 v77, v77
    v_exp_f32 v78, v78
    s_waitcnt lgkmcnt(2)
    v_mfma_f32_32x32x16_bf16 v[96:111], v[24:27], v[32:35], v[96:111]
    v_exp_f32 v79, v79
    v_cvt_pk_bf16_f32 v36, v72, v73
    v_cvt_pk_bf16_f32 v37, v74, v75
    v_cvt_pk_bf16_f32 v38, v76, v77
    v_cvt_pk_bf16_f32 v39, v78, v79
    s_setprio 2
    v_exp_f32 v80, v80
    v_exp_f32 v81, v81
    v_mfma_f32_32x32x16_bf16 v[96:111], v[28:31], v[36:39], v[96:111]
    s_mov_b64 exec, s[32:33]
    ds_read_b128 v[24:27], v42 offset:43520
    ds_read_b128 v[28:31], v42 offset:44160
    s_mov_b64 exec, -1
    v_exp_f32 v82, v82
    v_exp_f32 v83, v83
    v_exp_f32 v84, v84
    v_exp_f32 v85, v85
    v_exp_f32 v86, v86
    s_waitcnt lgkmcnt(2)
    v_mfma_f32_32x32x16_bf16 v[64:79], v[16:19], v[8:11], v[48:63]
    v_exp_f32 v87, v87
    v_cvt_pk_bf16_f32 v32, v80, v81
    v_cvt_pk_bf16_f32 v33, v82, v83
    v_cvt_pk_bf16_f32 v34, v84, v85
    v_cvt_pk_bf16_f32 v35, v86, v87
    v_exp_f32 v88, v88
    v_exp_f32 v89, v89
    v_mfma_f32_32x32x8_bf16 v[64:79], v[20:21], v[12:13], v[64:79]
    ds_read_b128 v[16:19], v40 offset:48640
    ds_read_b64 v[20:21], v41 offset:48640
    v_exp_f32 v90, v90
    v_exp_f32 v91, v91
    v_exp_f32 v92, v92
    v_exp_f32 v93, v93
    v_exp_f32 v94, v94
    s_waitcnt lgkmcnt(2)
    v_mfma_f32_32x32x16_bf16 v[96:111], v[24:27], v[32:35], v[96:111]
    v_exp_f32 v95, v95
    v_cvt_pk_bf16_f32 v36, v88, v89
    v_cvt_pk_bf16_f32 v37, v90, v91
    v_cvt_pk_bf16_f32 v38, v92, v93
    v_cvt_pk_bf16_f32 v39, v94, v95
    s_setprio 1
    v_exp_f32 v64, v64
    v_exp_f32 v65, v65
    v_mfma_f32_32x32x16_bf16 v[96:111], v[28:31], v[36:39], v[96:111]
    s_mov_b64 exec, s[32:33]
    ds_read_b128 v[24:27], v42 offset:46080
    ds_read_b128 v[28:31], v42 offset:46720
    s_mov_b64 exec, -1
    buffer_load_dwordx4 v[144:147], v125, s[20:23], s35 offen offset:0 sc1
    v_exp_f32 v66, v66
    v_exp_f32 v67, v67
    v_exp_f32 v68, v68
    v_exp_f32 v69, v69
    v_exp_f32 v70, v70
    s_waitcnt lgkmcnt(2)
    v_mfma_f32_32x32x16_bf16 v[80:95], v[16:19], v[8:11], v[48:63]
    v_exp_f32 v71, v71
    v_cvt_pk_bf16_f32 v32, v64, v65
    v_cvt_pk_bf16_f32 v33, v66, v67
    v_cvt_pk_bf16_f32 v34, v68, v69
    v_cvt_pk_bf16_f32 v35, v70, v71
    v_exp_f32 v72, v72
    v_exp_f32 v73, v73
    v_mfma_f32_32x32x8_bf16 v[80:95], v[20:21], v[12:13], v[80:95]
    ds_read_b128 v[16:19], v40 offset:51200
    ds_read_b64 v[20:21], v41 offset:51200
    s_mov_b32 m0, s30
    s_add_u32 s30, s30, 8192
    buffer_load_dwordx4 v125, s[20:23], s34 offen sc1 lds
    s_add_u32 s34, s34, 8192
    s_sub_u32 s10, s34, 163840
    s_cmp_ge_u32 s34, s37
    s_cselect_b32 s34, s10, s34
    v_exp_f32 v74, v74
    v_exp_f32 v75, v75
    v_exp_f32 v76, v76
    v_exp_f32 v77, v77
    v_exp_f32 v78, v78
    s_waitcnt lgkmcnt(2)
    v_mfma_f32_32x32x16_bf16 v[96:111], v[24:27], v[32:35], v[96:111]
    v_exp_f32 v79, v79
    v_cvt_pk_bf16_f32 v36, v72, v73
    v_cvt_pk_bf16_f32 v37, v74, v75
    v_cvt_pk_bf16_f32 v38, v76, v77
    v_cvt_pk_bf16_f32 v39, v78, v79
    s_setprio 0
    v_exp_f32 v80, v80
    v_exp_f32 v81, v81
    v_mfma_f32_32x32x16_bf16 v[96:111], v[28:31], v[36:39], v[96:111]
    s_mov_b64 exec, s[32:33]
    ds_read_b128 v[24:27], v42 offset:48640
    ds_read_b128 v[28:31], v42 offset:49280
    s_mov_b64 exec, -1
    v_exp_f32 v82, v82
    v_exp_f32 v83, v83
    v_exp_f32 v84, v84
    v_exp_f32 v85, v85
    v_exp_f32 v86, v86
    s_waitcnt lgkmcnt(2)
    v_mfma_f32_32x32x16_bf16 v[64:79], v[16:19], v[8:11], v[48:63]
    v_exp_f32 v87, v87
    v_cvt_pk_bf16_f32 v32, v80, v81
    v_cvt_pk_bf16_f32 v33, v82, v83
    v_cvt_pk_bf16_f32 v34, v84, v85
    v_cvt_pk_bf16_f32 v35, v86, v87
    v_exp_f32 v88, v88
    v_exp_f32 v89, v89
    v_mfma_f32_32x32x8_bf16 v[64:79], v[20:21], v[12:13], v[64:79]
    ds_read_b128 v[16:19], v40 offset:53760
    ds_read_b64 v[20:21], v41 offset:53760
    v_exp_f32 v90, v90
    v_exp_f32 v91, v91
    v_exp_f32 v92, v92
    v_exp_f32 v93, v93
    v_exp_f32 v94, v94
    s_waitcnt lgkmcnt(2)
    v_mfma_f32_32x32x16_bf16 v[96:111], v[24:27], v[32:35], v[96:111]
    v_exp_f32 v95, v95
    v_cvt_pk_bf16_f32 v36, v88, v89
    v_cvt_pk_bf16_f32 v37, v90, v91
    v_cvt_pk_bf16_f32 v38, v92, v93
    v_cvt_pk_bf16_f32 v39, v94, v95
    s_setprio 3
    v_exp_f32 v64, v64
    v_exp_f32 v65, v65
    v_mfma_f32_32x32x16_bf16 v[96:111], v[28:31], v[36:39], v[96:111]
    s_mov_b64 exec, s[32:33]
    ds_read_b128 v[24:27], v42 offset:51200
    ds_read_b128 v[28:31], v42 offset:51840
    s_mov_b64 exec, -1
    buffer_load_dwordx4 v[148:151], v125, s[20:23], s35 offen offset:1024 sc1
    v_exp_f32 v66, v66
    v_exp_f32 v67, v67
    v_exp_f32 v68, v68
    v_exp_f32 v69, v69
    v_exp_f32 v70, v70
    s_waitcnt lgkmcnt(2)
    v_mfma_f32_32x32x16_bf16 v[80:95], v[16:19], v[8:11], v[48:63]
    v_exp_f32 v71, v71
    v_cvt_pk_bf16_f32 v32, v64, v65
    v_cvt_pk_bf16_f32 v33, v66, v67
    v_cvt_pk_bf16_f32 v34, v68, v69
    v_cvt_pk_bf16_f32 v35, v70, v71
    v_exp_f32 v72, v72
    v_exp_f32 v73, v73
    v_mfma_f32_32x32x8_bf16 v[80:95], v[20:21], v[12:13], v[80:95]
    ds_read_b128 v[16:19], v40 offset:56320
    ds_read_b64 v[20:21], v41 offset:56320
    s_mov_b32 m0, s30
    s_add_u32 s30, s30, 8192
    buffer_load_dwordx4 v125, s[20:23], s34 offen sc1 lds
    s_add_u32 s34, s34, 8192
    s_sub_u32 s10, s34, 163840
    s_cmp_ge_u32 s34, s37
    s_cselect_b32 s34, s10, s34
    v_exp_f32 v74, v74
    v_exp_f32 v75, v75
    v_exp_f32 v76, v76
    v_exp_f32 v77, v77
    v_exp_f32 v78, v78
    s_waitcnt lgkmcnt(2)
    v_mfma_f32_32x32x16_bf16 v[96:111], v[24:27], v[32:35], v[96:111]
    v_exp_f32 v79, v79
    v_cvt_pk_bf16_f32 v36, v72, v73
    v_cvt_pk_bf16_f32 v37, v74, v75
    v_cvt_pk_bf16_f32 v38, v76, v77
    v_cvt_pk_bf16_f32 v39, v78, v79
    s_setprio 2
    v_exp_f32 v80, v80
    v_exp_f32 v81, v81
    v_mfma_f32_32x32x16_bf16 v[96:111], v[28:31], v[36:39], v[96:111]
    s_mov_b64 exec, s[32:33]
    ds_read_b128 v[24:27], v42 offset:53760
    ds_read_b128 v[28:31], v42 offset:54400
    s_mov_b64 exec, -1
    v_exp_f32 v82, v82
    v_exp_f32 v83, v83
    v_exp_f32 v84, v84
    v_exp_f32 v85, v85
    v_exp_f32 v86, v86
    s_waitcnt lgkmcnt(2)
    v_mfma_f32_32x32x16_bf16 v[64:79], v[16:19], v[8:11], v[48:63]
    v_exp_f32 v87, v87
    v_cvt_pk_bf16_f32 v32, v80, v81
    v_cvt_pk_bf16_f32 v33, v82, v83
    v_cvt_pk_bf16_f32 v34, v84, v85
    v_cvt_pk_bf16_f32 v35, v86, v87
    v_exp_f32 v88, v88
    v_exp_f32 v89, v89
    v_mfma_f32_32x32x8_bf16 v[64:79], v[20:21], v[12:13], v[64:79]
    ds_read_b128 v[16:19], v40 offset:58880
    ds_read_b64 v[20:21], v41 offset:58880
    v_exp_f32 v90, v90
    v_exp_f32 v91, v91
    v_exp_f32 v92, v92
    v_exp_f32 v93, v93
    v_exp_f32 v94, v94
    s_waitcnt lgkmcnt(2)
    v_mfma_f32_32x32x16_bf16 v[96:111], v[24:27], v[32:35], v[96:111]
    v_exp_f32 v95, v95
    v_cvt_pk_bf16_f32 v36, v88, v89
    v_cvt_pk_bf16_f32 v37, v90, v91
    v_cvt_pk_bf16_f32 v38, v92, v93
    v_cvt_pk_bf16_f32 v39, v94, v95
    s_setprio 1
    v_exp_f32 v64, v64
    v_exp_f32 v65, v65
    v_mfma_f32_32x32x16_bf16 v[96:111], v[28:31], v[36:39], v[96:111]
    s_mov_b64 exec, s[32:33]
    ds_read_b128 v[24:27], v42 offset:56320
    ds_read_b128 v[28:31], v42 offset:56960
    s_mov_b64 exec, -1
    buffer_load_dwordx4 v[152:155], v125, s[20:23], s35 offen offset:2048 sc1
    v_exp_f32 v66, v66
    v_exp_f32 v67, v67
    v_exp_f32 v68, v68
    v_exp_f32 v69, v69
    v_exp_f32 v70, v70
    s_waitcnt lgkmcnt(2)
    v_mfma_f32_32x32x16_bf16 v[80:95], v[16:19], v[8:11], v[48:63]
    v_exp_f32 v71, v71
    v_cvt_pk_bf16_f32 v32, v64, v65
    v_cvt_pk_bf16_f32 v33, v66, v67
    v_cvt_pk_bf16_f32 v34, v68, v69
    v_cvt_pk_bf16_f32 v35, v70, v71
    v_exp_f32 v72, v72
    v_exp_f32 v73, v73
    v_mfma_f32_32x32x8_bf16 v[80:95], v[20:21], v[12:13], v[80:95]
    ds_read_b128 v[16:19], v40 offset:61440
    ds_read_b64 v[20:21], v41 offset:61440
    s_mov_b32 m0, s30
    s_add_u32 s30, s30, 8192
    buffer_load_dwordx4 v125, s[20:23], s34 offen sc1 lds
    s_add_u32 s34, s34, 8192
    s_sub_u32 s10, s34, 163840
    s_cmp_ge_u32 s34, s37
    s_cselect_b32 s34, s10, s34
    v_exp_f32 v74, v74
    v_exp_f32 v75, v75
    v_exp_f32 v76, v76
    v_exp_f32 v77, v77
    v_exp_f32 v78, v78
    s_waitcnt lgkmcnt(2)
    v_mfma_f32_32x32x16_bf16 v[96:111], v[24:27], v[32:35], v[96:111]
    v_exp_f32 v79, v79
    v_cvt_pk_bf16_f32 v36, v72, v73
    v_cvt_pk_bf16_f32 v37, v74, v75
    v_cvt_pk_bf16_f32 v38, v76, v77
    v_cvt_pk_bf16_f32 v39, v78, v79
    s_setprio 0
    v_exp_f32 v80, v80
    v_exp_f32 v81, v81
    v_mfma_f32_32x32x16_bf16 v[96:111], v[28:31], v[36:39], v[96:111]
    s_mov_b64 exec, s[32:33]
    ds_read_b128 v[24:27], v42 offset:58880
    ds_read_b128 v[28:31], v42 offset:59520
    s_mov_b64 exec, -1
    v_exp_f32 v82, v82
    v_exp_f32 v83, v83
    v_exp_f32 v84, v84
    v_exp_f32 v85, v85
    v_exp_f32 v86, v86
    s_waitcnt lgkmcnt(2)
    v_mfma_f32_32x32x16_bf16 v[64:79], v[16:19], v[8:11], v[48:63]
    v_exp_f32 v87, v87
    v_cvt_pk_bf16_f32 v32, v80, v81
    v_cvt_pk_bf16_f32 v33, v82, v83
    v_cvt_pk_bf16_f32 v34, v84, v85
    v_cvt_pk_bf16_f32 v35, v86, v87
    v_exp_f32 v88, v88
    v_exp_f32 v89, v89
    v_mfma_f32_32x32x8_bf16 v[64:79], v[20:21], v[12:13], v[64:79]
    ds_read_b128 v[16:19], v40 offset:64000
    ds_read_b64 v[20:21], v41 offset:64000
    v_exp_f32 v90, v90
    v_exp_f32 v91, v91
    v_exp_f32 v92, v92
    v_exp_f32 v93, v93
    v_exp_f32 v94, v94
    s_waitcnt lgkmcnt(2)
    v_mfma_f32_32x32x16_bf16 v[96:111], v[24:27], v[32:35], v[96:111]
    v_exp_f32 v95, v95
    v_cvt_pk_bf16_f32 v36, v88, v89
    v_cvt_pk_bf16_f32 v37, v90, v91
    v_cvt_pk_bf16_f32 v38, v92, v93
    v_cvt_pk_bf16_f32 v39, v94, v95
    s_waitcnt vmcnt(2)
    s_barrier
    s_setprio 3
    v_add_u32 v40, 66560, v40
    v_add_u32 v41, 66560, v41
    v_exp_f32 v64, v64
    v_exp_f32 v65, v65
    v_mfma_f32_32x32x16_bf16 v[96:111], v[28:31], v[36:39], v[96:111]
    s_mov_b64 exec, s[32:33]
    ds_read_b128 v[24:27], v42 offset:61440
    ds_read_b128 v[28:31], v42 offset:62080
    s_mov_b64 exec, -1
    buffer_load_dwordx4 v[156:159], v125, s[20:23], s35 offen offset:3072 sc1
    s_add_u32 s35, s35, 4096
    v_exp_f32 v66, v66
    v_exp_f32 v67, v67
    v_exp_f32 v68, v68
    v_exp_f32 v69, v69
    v_exp_f32 v70, v70
    s_waitcnt lgkmcnt(2)
    v_mfma_f32_32x32x16_bf16 v[80:95], v[16:19], v[8:11], v[48:63]
    v_exp_f32 v71, v71
    v_cvt_pk_bf16_f32 v32, v64, v65
    v_cvt_pk_bf16_f32 v33, v66, v67
    v_cvt_pk_bf16_f32 v34, v68, v69
    v_cvt_pk_bf16_f32 v35, v70, v71
    v_exp_f32 v72, v72
    v_exp_f32 v73, v73
    v_mfma_f32_32x32x8_bf16 v[80:95], v[20:21], v[12:13], v[80:95]
    ds_read_b128 v[16:19], v40 offset:0
    ds_read_b64 v[20:21], v41 offset:0
    s_mov_b32 m0, s30
    s_add_u32 s30, s30, 8192
    buffer_load_dwordx4 v125, s[20:23], s34 offen sc1 lds
    s_add_u32 s34, s34, 8192
    s_sub_u32 s10, s34, 163840
    s_cmp_ge_u32 s34, s37
    s_cselect_b32 s34, s10, s34
    v_exp_f32 v74, v74
    v_exp_f32 v75, v75
    v_exp_f32 v76, v76
    v_exp_f32 v77, v77
    v_exp_f32 v78, v78
    s_waitcnt lgkmcnt(2)
    v_mfma_f32_32x32x16_bf16 v[96:111], v[24:27], v[32:35], v[96:111]
    v_exp_f32 v79, v79
    v_cvt_pk_bf16_f32 v36, v72, v73
    v_cvt_pk_bf16_f32 v37, v74, v75
    v_cvt_pk_bf16_f32 v38, v76, v77
    v_cvt_pk_bf16_f32 v39, v78, v79
    s_setprio 2
    v_exp_f32 v80, v80
    v_exp_f32 v81, v81
    v_mfma_f32_32x32x16_bf16 v[96:111], v[28:31], v[36:39], v[96:111]
    s_mov_b64 exec, s[32:33]
    ds_read_b128 v[24:27], v42 offset:64000
    ds_read_b128 v[28:31], v42 offset:64640
    s_mov_b64 exec, -1
    v_exp_f32 v82, v82
    v_exp_f32 v83, v83
    v_exp_f32 v84, v84
    v_exp_f32 v85, v85
    v_exp_f32 v86, v86
    s_waitcnt lgkmcnt(2)
    v_mfma_f32_32x32x16_bf16 v[64:79], v[16:19], v[8:11], v[48:63]
    v_exp_f32 v87, v87
    v_cvt_pk_bf16_f32 v32, v80, v81
    v_cvt_pk_bf16_f32 v33, v82, v83
    v_cvt_pk_bf16_f32 v34, v84, v85
    v_cvt_pk_bf16_f32 v35, v86, v87
    v_exp_f32 v88, v88
    v_exp_f32 v89, v89
    v_mfma_f32_32x32x8_bf16 v[64:79], v[20:21], v[12:13], v[64:79]
    ds_read_b128 v[16:19], v40 offset:2560
    ds_read_b64 v[20:21], v41 offset:2560
    v_exp_f32 v90, v90
    v_exp_f32 v91, v91
    v_exp_f32 v92, v92
    v_exp_f32 v93, v93
    v_exp_f32 v94, v94
    s_waitcnt lgkmcnt(2)
    v_mfma_f32_32x32x16_bf16 v[96:111], v[24:27], v[32:35], v[96:111]
    v_exp_f32 v95, v95
    v_cvt_pk_bf16_f32 v36, v88, v89
    v_cvt_pk_bf16_f32 v37, v90, v91
    v_cvt_pk_bf16_f32 v38, v92, v93
    v_cvt_pk_bf16_f32 v39, v94, v95
    s_setprio 1
    v_add_u32 v42, 66560, v42
    v_exp_f32 v64, v64
    v_exp_f32 v65, v65
    v_mfma_f32_32x32x16_bf16 v[96:111], v[28:31], v[36:39], v[96:111]
    s_mov_b64 exec, s[32:33]
    ds_read_b128 v[24:27], v42 offset:0
    ds_read_b128 v[28:31], v42 offset:640
    s_mov_b64 exec, -1
    buffer_load_dwordx4 v[160:163], v125, s[20:23], s35 offen offset:0 sc1
    v_exp_f32 v66, v66
    v_exp_f32 v67, v67
    v_exp_f32 v68, v68
    v_exp_f32 v69, v69
    v_exp_f32 v70, v70
    s_waitcnt lgkmcnt(2)
    v_mfma_f32_32x32x16_bf16 v[80:95], v[16:19], v[8:11], v[48:63]
    v_exp_f32 v71, v71
    v_cvt_pk_bf16_f32 v32, v64, v65
    v_cvt_pk_bf16_f32 v33, v66, v67
    v_cvt_pk_bf16_f32 v34, v68, v69
    v_cvt_pk_bf16_f32 v35, v70, v71
    v_exp_f32 v72, v72
    v_exp_f32 v73, v73
    v_mfma_f32_32x32x8_bf16 v[80:95], v[20:21], v[12:13], v[80:95]
    ds_read_b128 v[16:19], v40 offset:5120
    ds_read_b64 v[20:21], v41 offset:5120
    s_mov_b32 m0, s30
    s_add_u32 s30, s30, 8192
    buffer_load_dwordx4 v125, s[20:23], s34 offen sc1 lds
    s_add_u32 s34, s34, 8192
    s_sub_u32 s10, s34, 163840
    s_cmp_ge_u32 s34, s37
    s_cselect_b32 s34, s10, s34
    v_exp_f32 v74, v74
    v_exp_f32 v75, v75
    v_exp_f32 v76, v76
    v_exp_f32 v77, v77
    v_exp_f32 v78, v78
    s_waitcnt lgkmcnt(2)
    v_mfma_f32_32x32x16_bf16 v[96:111], v[24:27], v[32:35], v[96:111]
    v_exp_f32 v79, v79
    v_cvt_pk_bf16_f32 v36, v72, v73
    v_cvt_pk_bf16_f32 v37, v74, v75
    v_cvt_pk_bf16_f32 v38, v76, v77
    v_cvt_pk_bf16_f32 v39, v78, v79
    s_setprio 0
    v_exp_f32 v80, v80
    v_exp_f32 v81, v81
    v_mfma_f32_32x32x16_bf16 v[96:111], v[28:31], v[36:39], v[96:111]
    s_mov_b64 exec, s[32:33]
    ds_read_b128 v[24:27], v42 offset:2560
    ds_read_b128 v[28:31], v42 offset:3200
    s_mov_b64 exec, -1
    v_exp_f32 v82, v82
    v_exp_f32 v83, v83
    v_exp_f32 v84, v84
    v_exp_f32 v85, v85
    v_exp_f32 v86, v86
    s_waitcnt lgkmcnt(2)
    v_mfma_f32_32x32x16_bf16 v[64:79], v[16:19], v[8:11], v[48:63]
    v_exp_f32 v87, v87
    v_cvt_pk_bf16_f32 v32, v80, v81
    v_cvt_pk_bf16_f32 v33, v82, v83
    v_cvt_pk_bf16_f32 v34, v84, v85
    v_cvt_pk_bf16_f32 v35, v86, v87
    v_exp_f32 v88, v88
    v_exp_f32 v89, v89
    v_mfma_f32_32x32x8_bf16 v[64:79], v[20:21], v[12:13], v[64:79]
    ds_read_b128 v[16:19], v40 offset:7680
    ds_read_b64 v[20:21], v41 offset:7680
    v_exp_f32 v90, v90
    v_exp_f32 v91, v91
    v_exp_f32 v92, v92
    v_exp_f32 v93, v93
    v_exp_f32 v94, v94
    s_waitcnt lgkmcnt(2)
    v_mfma_f32_32x32x16_bf16 v[96:111], v[24:27], v[32:35], v[96:111]
    v_exp_f32 v95, v95
    v_cvt_pk_bf16_f32 v36, v88, v89
    v_cvt_pk_bf16_f32 v37, v90, v91
    v_cvt_pk_bf16_f32 v38, v92, v93
    v_cvt_pk_bf16_f32 v39, v94, v95
    s_setprio 3
    v_exp_f32 v64, v64
    v_exp_f32 v65, v65
    v_mfma_f32_32x32x16_bf16 v[96:111], v[28:31], v[36:39], v[96:111]
    s_mov_b64 exec, s[32:33]
    ds_read_b128 v[24:27], v42 offset:5120
    ds_read_b128 v[28:31], v42 offset:5760
    s_mov_b64 exec, -1
    buffer_load_dwordx4 v[164:167], v125, s[20:23], s35 offen offset:1024 sc1
    v_exp_f32 v66, v66
    v_exp_f32 v67, v67
    v_exp_f32 v68, v68
    v_exp_f32 v69, v69
    v_exp_f32 v70, v70
    s_waitcnt lgkmcnt(2)
    v_mfma_f32_32x32x16_bf16 v[80:95], v[16:19], v[8:11], v[48:63]
    v_exp_f32 v71, v71
    v_cvt_pk_bf16_f32 v32, v64, v65
    v_cvt_pk_bf16_f32 v33, v66, v67
    v_cvt_pk_bf16_f32 v34, v68, v69
    v_cvt_pk_bf16_f32 v35, v70, v71
    v_exp_f32 v72, v72
    v_exp_f32 v73, v73
    v_mfma_f32_32x32x8_bf16 v[80:95], v[20:21], v[12:13], v[80:95]
    ds_read_b128 v[16:19], v40 offset:10240
    ds_read_b64 v[20:21], v41 offset:10240
    s_mov_b32 m0, s30
    s_add_u32 s30, s30, 8192
    buffer_load_dwordx4 v125, s[20:23], s34 offen sc1 lds
    s_add_u32 s34, s34, 8192
    s_sub_u32 s10, s34, 163840
    s_cmp_ge_u32 s34, s37
    s_cselect_b32 s34, s10, s34
    v_exp_f32 v74, v74
    v_exp_f32 v75, v75
    v_exp_f32 v76, v76
    v_exp_f32 v77, v77
    v_exp_f32 v78, v78
    s_waitcnt lgkmcnt(2)
    v_mfma_f32_32x32x16_bf16 v[96:111], v[24:27], v[32:35], v[96:111]
    v_exp_f32 v79, v79
    v_cvt_pk_bf16_f32 v36, v72, v73
    v_cvt_pk_bf16_f32 v37, v74, v75
    v_cvt_pk_bf16_f32 v38, v76, v77
    v_cvt_pk_bf16_f32 v39, v78, v79
    s_setprio 2
    v_exp_f32 v80, v80
    v_exp_f32 v81, v81
    v_mfma_f32_32x32x16_bf16 v[96:111], v[28:31], v[36:39], v[96:111]
    s_mov_b64 exec, s[32:33]
    ds_read_b128 v[24:27], v42 offset:7680
    ds_read_b128 v[28:31], v42 offset:8320
    s_mov_b64 exec, -1
    v_exp_f32 v82, v82
    v_exp_f32 v83, v83
    v_exp_f32 v84, v84
    v_exp_f32 v85, v85
    v_exp_f32 v86, v86
    s_waitcnt lgkmcnt(2)
    v_mfma_f32_32x32x16_bf16 v[64:79], v[16:19], v[8:11], v[48:63]
    v_exp_f32 v87, v87
    v_cvt_pk_bf16_f32 v32, v80, v81
    v_cvt_pk_bf16_f32 v33, v82, v83
    v_cvt_pk_bf16_f32 v34, v84, v85
    v_cvt_pk_bf16_f32 v35, v86, v87
    v_exp_f32 v88, v88
    v_exp_f32 v89, v89
    v_mfma_f32_32x32x8_bf16 v[64:79], v[20:21], v[12:13], v[64:79]
    ds_read_b128 v[16:19], v40 offset:12800
    ds_read_b64 v[20:21], v41 offset:12800
    v_exp_f32 v90, v90
    v_exp_f32 v91, v91
    v_exp_f32 v92, v92
    v_exp_f32 v93, v93
    v_exp_f32 v94, v94
    s_waitcnt lgkmcnt(2)
    v_mfma_f32_32x32x16_bf16 v[96:111], v[24:27], v[32:35], v[96:111]
    v_exp_f32 v95, v95
    v_cvt_pk_bf16_f32 v36, v88, v89
    v_cvt_pk_bf16_f32 v37, v90, v91
    v_cvt_pk_bf16_f32 v38, v92, v93
    v_cvt_pk_bf16_f32 v39, v94, v95
    s_setprio 1
    v_exp_f32 v64, v64
    v_exp_f32 v65, v65
    v_mfma_f32_32x32x16_bf16 v[96:111], v[28:31], v[36:39], v[96:111]
    s_mov_b64 exec, s[32:33]
    ds_read_b128 v[24:27], v42 offset:10240
    ds_read_b128 v[28:31], v42 offset:10880
    s_mov_b64 exec, -1
    buffer_load_dwordx4 v[168:171], v125, s[20:23], s35 offen offset:2048 sc1
    v_exp_f32 v66, v66
    v_exp_f32 v67, v67
    v_exp_f32 v68, v68
    v_exp_f32 v69, v69
    v_exp_f32 v70, v70
    s_waitcnt lgkmcnt(2)
    v_mfma_f32_32x32x16_bf16 v[80:95], v[16:19], v[8:11], v[48:63]
    v_exp_f32 v71, v71
    v_cvt_pk_bf16_f32 v32, v64, v65
    v_cvt_pk_bf16_f32 v33, v66, v67
    v_cvt_pk_bf16_f32 v34, v68, v69
    v_cvt_pk_bf16_f32 v35, v70, v71
    v_exp_f32 v72, v72
    v_exp_f32 v73, v73
    v_mfma_f32_32x32x8_bf16 v[80:95], v[20:21], v[12:13], v[80:95]
    ds_read_b128 v[16:19], v40 offset:15360
    ds_read_b64 v[20:21], v41 offset:15360
    s_mov_b32 m0, s30
    s_add_u32 s30, s30, 8192
    buffer_load_dwordx4 v125, s[20:23], s34 offen sc1 lds
    s_add_u32 s34, s34, 8192
    s_sub_u32 s10, s34, 163840
    s_cmp_ge_u32 s34, s37
    s_cselect_b32 s34, s10, s34
    v_exp_f32 v74, v74
    v_exp_f32 v75, v75
    v_exp_f32 v76, v76
    v_exp_f32 v77, v77
    v_exp_f32 v78, v78
    s_waitcnt lgkmcnt(2)
    v_mfma_f32_32x32x16_bf16 v[96:111], v[24:27], v[32:35], v[96:111]
    v_exp_f32 v79, v79
    v_cvt_pk_bf16_f32 v36, v72, v73
    v_cvt_pk_bf16_f32 v37, v74, v75
    v_cvt_pk_bf16_f32 v38, v76, v77
    v_cvt_pk_bf16_f32 v39, v78, v79
    s_setprio 0
    v_exp_f32 v80, v80
    v_exp_f32 v81, v81
    v_mfma_f32_32x32x16_bf16 v[96:111], v[28:31], v[36:39], v[96:111]
    s_mov_b64 exec, s[32:33]
    ds_read_b128 v[24:27], v42 offset:12800
    ds_read_b128 v[28:31], v42 offset:13440
    s_mov_b64 exec, -1
    v_exp_f32 v82, v82
    v_exp_f32 v83, v83
    v_exp_f32 v84, v84
    v_exp_f32 v85, v85
    v_exp_f32 v86, v86
    s_waitcnt lgkmcnt(2)
    v_mfma_f32_32x32x16_bf16 v[64:79], v[16:19], v[8:11], v[48:63]
    v_exp_f32 v87, v87
    v_cvt_pk_bf16_f32 v32, v80, v81
    v_cvt_pk_bf16_f32 v33, v82, v83
    v_cvt_pk_bf16_f32 v34, v84, v85
    v_cvt_pk_bf16_f32 v35, v86, v87
    v_exp_f32 v88, v88
    v_exp_f32 v89, v89
    v_mfma_f32_32x32x8_bf16 v[64:79], v[20:21], v[12:13], v[64:79]
    ds_read_b128 v[16:19], v40 offset:17920
    ds_read_b64 v[20:21], v41 offset:17920
    v_exp_f32 v90, v90
    v_exp_f32 v91, v91
    v_exp_f32 v92, v92
    v_exp_f32 v93, v93
    v_exp_f32 v94, v94
    s_waitcnt lgkmcnt(2)
    v_mfma_f32_32x32x16_bf16 v[96:111], v[24:27], v[32:35], v[96:111]
    v_exp_f32 v95, v95
    v_cvt_pk_bf16_f32 v36, v88, v89
    v_cvt_pk_bf16_f32 v37, v90, v91
    v_cvt_pk_bf16_f32 v38, v92, v93
    v_cvt_pk_bf16_f32 v39, v94, v95
    s_setprio 3
    v_exp_f32 v64, v64
    v_exp_f32 v65, v65
    v_mfma_f32_32x32x16_bf16 v[96:111], v[28:31], v[36:39], v[96:111]
    s_mov_b64 exec, s[32:33]
    ds_read_b128 v[24:27], v42 offset:15360
    ds_read_b128 v[28:31], v42 offset:16000
    s_mov_b64 exec, -1
    buffer_load_dwordx4 v[172:175], v125, s[20:23], s35 offen offset:3072 sc1
    s_add_u32 s35, s35, 4096
    v_exp_f32 v66, v66
    v_exp_f32 v67, v67
    v_exp_f32 v68, v68
    v_exp_f32 v69, v69
    v_exp_f32 v70, v70
    s_waitcnt lgkmcnt(2)
    v_mfma_f32_32x32x16_bf16 v[80:95], v[16:19], v[8:11], v[48:63]
    v_exp_f32 v71, v71
    v_cvt_pk_bf16_f32 v32, v64, v65
    v_cvt_pk_bf16_f32 v33, v66, v67
    v_cvt_pk_bf16_f32 v34, v68, v69
    v_cvt_pk_bf16_f32 v35, v70, v71
    v_exp_f32 v72, v72
    v_exp_f32 v73, v73
    v_mfma_f32_32x32x8_bf16 v[80:95], v[20:21], v[12:13], v[80:95]
    ds_read_b128 v[16:19], v40 offset:20480
    ds_read_b64 v[20:21], v41 offset:20480
    s_cmp_ge_u32 s24, 4
    s_cbranch_scc1 F_kvl
    s_mov_b32 m0, s30
    s_add_u32 s30, s30, 8192
    buffer_load_dwordx4 v125, s[20:23], s34 offen sc1 lds
    s_add_u32 s34, s34, 8192
    s_sub_u32 s10, s34, 163840
    s_cmp_ge_u32 s34, s37
    s_cselect_b32 s34, s10, s34
F_kvl:
    v_exp_f32 v74, v74
    v_exp_f32 v75, v75
    v_exp_f32 v76, v76
    v_exp_f32 v77, v77
    v_exp_f32 v78, v78
    s_waitcnt lgkmcnt(2)
    v_mfma_f32_32x32x16_bf16 v[96:111], v[24:27], v[32:35], v[96:111]
    v_exp_f32 v79, v79
    v_cvt_pk_bf16_f32 v36, v72, v73
    v_cvt_pk_bf16_f32 v37, v74, v75
    v_cvt_pk_bf16_f32 v38, v76, v77
    v_cvt_pk_bf16_f32 v39, v78, v79
    s_setprio 2
    v_exp_f32 v80, v80
    v_exp_f32 v81, v81
    v_mfma_f32_32x32x16_bf16 v[96:111], v[28:31], v[36:39], v[96:111]
    s_mov_b64 exec, s[32:33]
    ds_read_b128 v[24:27], v42 offset:17920
    ds_read_b128 v[28:31], v42 offset:18560
    s_mov_b64 exec, -1
    v_exp_f32 v82, v82
    v_exp_f32 v83, v83
    v_exp_f32 v84, v84
    v_exp_f32 v85, v85
    v_exp_f32 v86, v86
    s_waitcnt lgkmcnt(2)
    v_mfma_f32_32x32x16_bf16 v[64:79], v[16:19], v[8:11], v[48:63]
    v_exp_f32 v87, v87
    v_cvt_pk_bf16_f32 v32, v80, v81
    v_cvt_pk_bf16_f32 v33, v82, v83
    v_cvt_pk_bf16_f32 v34, v84, v85
    v_cvt_pk_bf16_f32 v35, v86, v87
    v_exp_f32 v88, v88
    v_exp_f32 v89, v89
    v_mfma_f32_32x32x8_bf16 v[64:79], v[20:21], v[12:13], v[64:79]
    ds_read_b128 v[16:19], v40 offset:23040
    ds_read_b64 v[20:21], v41 offset:23040
    s_lshl_b32 s10, s56, 3
    s_add_u32 s10, s10, s24
    s_mul_i32 s10, s10, 3840
    s_add_u32 s10, s10, s65
    s_mov_b64 exec, 0x3fffffff
    buffer_load_dword v123, v121, s[20:23], s10 offen sc1
    s_mov_b64 exec, -1
    v_exp_f32 v90, v90
    v_exp_f32 v91, v91
    v_exp_f32 v92, v92
    v_exp_f32 v93, v93
    v_exp_f32 v94, v94
    s_waitcnt lgkmcnt(2)
    v_mfma_f32_32x32x16_bf16 v[96:111], v[24:27], v[32:35], v[96:111]
    v_exp_f32 v95, v95
    v_cvt_pk_bf16_f32 v36, v88, v89
    v_cvt_pk_bf16_f32 v37, v90, v91
    v_cvt_pk_bf16_f32 v38, v92, v93
    v_cvt_pk_bf16_f32 v39, v94, v95
    s_setprio 1
    v_exp_f32 v64, v64
    v_exp_f32 v65, v65
    v_mfma_f32_32x32x16_bf16 v[96:111], v[28:31], v[36:39], v[96:111]
    s_mov_b64 exec, s[32:33]
    ds_read_b128 v[24:27], v42 offset:20480
    ds_read_b128 v[28:31], v42 offset:21120
    s_mov_b64 exec, -1
    buffer_load_dwordx4 v[176:179], v125, s[20:23], s35 offen offset:0 sc1
    v_exp_f32 v66, v66
    v_exp_f32 v67, v67
    v_exp_f32 v68, v68
    v_exp_f32 v69, v69
    v_exp_f32 v70, v70
    s_waitcnt lgkmcnt(2)
    v_mfma_f32_32x32x16_bf16 v[80:95], v[16:19], v[8:11], v[48:63]
    v_exp_f32 v71, v71
    v_cvt_pk_bf16_f32 v32, v64, v65
    v_cvt_pk_bf16_f32 v33, v66, v67
    v_cvt_pk_bf16_f32 v34, v68, v69
    v_cvt_pk_bf16_f32 v35, v70, v71
    v_exp_f32 v72, v72
    v_exp_f32 v73, v73
    v_mfma_f32_32x32x8_bf16 v[80:95], v[20:21], v[12:13], v[80:95]
    ds_read_b128 v[16:19], v40 offset:25600
    ds_read_b64 v[20:21], v41 offset:25600
    v_exp_f32 v74, v74
    v_exp_f32 v75, v75
    v_exp_f32 v76, v76
    v_exp_f32 v77, v77
    v_exp_f32 v78, v78
    s_waitcnt lgkmcnt(2)
    v_mfma_f32_32x32x16_bf16 v[96:111], v[24:27], v[32:35], v[96:111]
    v_exp_f32 v79, v79
    v_cvt_pk_bf16_f32 v36, v72, v73
    v_cvt_pk_bf16_f32 v37, v74, v75
    v_cvt_pk_bf16_f32 v38, v76, v77
    v_cvt_pk_bf16_f32 v39, v78, v79
    s_setprio 0
    v_exp_f32 v80, v80
    v_exp_f32 v81, v81
    v_mfma_f32_32x32x16_bf16 v[96:111], v[28:31], v[36:39], v[96:111]
    s_mov_b64 exec, s[32:33]
    ds_read_b128 v[24:27], v42 offset:23040
    ds_read_b128 v[28:31], v42 offset:23680
    s_mov_b64 exec, -1
    v_exp_f32 v82, v82
    v_exp_f32 v83, v83
    v_exp_f32 v84, v84
    v_exp_f32 v85, v85
    v_exp_f32 v86, v86
    s_waitcnt lgkmcnt(2)
    v_mfma_f32_32x32x16_bf16 v[64:79], v[16:19], v[8:11], v[48:63]
    v_exp_f32 v87, v87
    v_cvt_pk_bf16_f32 v32, v80, v81
    v_cvt_pk_bf16_f32 v33, v82, v83
    v_cvt_pk_bf16_f32 v34, v84, v85
    v_cvt_pk_bf16_f32 v35, v86, v87
    v_exp_f32 v88, v88
    v_exp_f32 v89, v89
    v_mfma_f32_32x32x8_bf16 v[64:79], v[20:21], v[12:13], v[64:79]
    ds_read_b128 v[16:19], v40 offset:28160
    ds_read_b64 v[20:21], v41 offset:28160
    v_lshlrev_b32 v122, 10, v3
    s_lshl_b32 s51, s25, 7
    s_add_u32 s51, s51, 16957440
    buffer_load_dwordx4 v[116:119], v122, s[20:23], s51 offen sc1
    v_and_b32 v5, 0x780, v121
    buffer_load_dword v123, v5, s[20:23], s53 offen sc1
    v_exp_f32 v90, v90
    v_exp_f32 v91, v91
    v_exp_f32 v92, v92
    v_exp_f32 v93, v93
    v_exp_f32 v94, v94
    s_waitcnt lgkmcnt(2)
    v_mfma_f32_32x32x16_bf16 v[96:111], v[24:27], v[32:35], v[96:111]
    v_exp_f32 v95, v95
    v_cvt_pk_bf16_f32 v36, v88, v89
    v_cvt_pk_bf16_f32 v37, v90, v91
    v_cvt_pk_bf16_f32 v38, v92, v93
    v_cvt_pk_bf16_f32 v39, v94, v95
    s_setprio 3
    v_exp_f32 v64, v64
    v_exp_f32 v65, v65
    v_mfma_f32_32x32x16_bf16 v[96:111], v[28:31], v[36:39], v[96:111]
    s_mov_b64 exec, s[32:33]
    ds_read_b128 v[24:27], v42 offset:25600
    ds_read_b128 v[28:31], v42 offset:26240
    s_mov_b64 exec, -1
    buffer_load_dwordx4 v[180:183], v125, s[20:23], s35 offen offset:1024 sc1
    v_exp_f32 v66, v66
    v_exp_f32 v67, v67
    v_exp_f32 v68, v68
    v_exp_f32 v69, v69
    v_exp_f32 v70, v70
    s_waitcnt lgkmcnt(2)
    v_mfma_f32_32x32x16_bf16 v[80:95], v[16:19], v[8:11], v[48:63]
    v_exp_f32 v71, v71
    v_cvt_pk_bf16_f32 v32, v64, v65
    v_cvt_pk_bf16_f32 v33, v66, v67
    v_cvt_pk_bf16_f32 v34, v68, v69
    v_cvt_pk_bf16_f32 v35, v70, v71
    v_exp_f32 v72, v72
    v_exp_f32 v73, v73
    v_mfma_f32_32x32x8_bf16 v[80:95], v[20:21], v[12:13], v[80:95]
    ds_read_b128 v[16:19], v40 offset:30720
    ds_read_b64 v[20:21], v41 offset:30720
    v_exp_f32 v74, v74
    v_exp_f32 v75, v75
    v_exp_f32 v76, v76
    v_exp_f32 v77, v77
    v_exp_f32 v78, v78
    s_waitcnt lgkmcnt(2)
    v_mfma_f32_32x32x16_bf16 v[96:111], v[24:27], v[32:35], v[96:111]
    v_exp_f32 v79, v79
    v_cvt_pk_bf16_f32 v36, v72, v73
    v_cvt_pk_bf16_f32 v37, v74, v75
    v_cvt_pk_bf16_f32 v38, v76, v77
    v_cvt_pk_bf16_f32 v39, v78, v79
    s_setprio 2
    v_exp_f32 v80, v80
    v_exp_f32 v81, v81
    v_mfma_f32_32x32x16_bf16 v[96:111], v[28:31], v[36:39], v[96:111]
    s_mov_b64 exec, s[32:33]
    ds_read_b128 v[24:27], v42 offset:28160
    ds_read_b128 v[28:31], v42 offset:28800
    s_mov_b64 exec, -1
    v_exp_f32 v82, v82
    v_exp_f32 v83, v83
    v_exp_f32 v84, v84
    v_exp_f32 v85, v85
    v_exp_f32 v86, v86
    s_waitcnt lgkmcnt(2)
    v_mfma_f32_32x32x16_bf16 v[64:79], v[16:19], v[8:11], v[48:63]
    v_exp_f32 v87, v87
    v_cvt_pk_bf16_f32 v32, v80, v81
    v_cvt_pk_bf16_f32 v33, v82, v83
    v_cvt_pk_bf16_f32 v34, v84, v85
    v_cvt_pk_bf16_f32 v35, v86, v87
    v_exp_f32 v88, v88
    v_exp_f32 v89, v89
    v_mfma_f32_32x32x8_bf16 v[64:79], v[20:21], v[12:13], v[64:79]
    ds_read_b128 v[16:19], v40 offset:33280
    ds_read_b64 v[20:21], v41 offset:33280
    v_exp_f32 v90, v90
    v_exp_f32 v91, v91
    v_exp_f32 v92, v92
    v_exp_f32 v93, v93
    v_exp_f32 v94, v94
    s_waitcnt lgkmcnt(2)
    v_mfma_f32_32x32x16_bf16 v[96:111], v[24:27], v[32:35], v[96:111]
    v_exp_f32 v95, v95
    v_cvt_pk_bf16_f32 v36, v88, v89
    v_cvt_pk_bf16_f32 v37, v90, v91
    v_cvt_pk_bf16_f32 v38, v92, v93
    v_cvt_pk_bf16_f32 v39, v94, v95
    s_setprio 1
    v_exp_f32 v64, v64
    v_exp_f32 v65, v65
    v_mfma_f32_32x32x16_bf16 v[96:111], v[28:31], v[36:39], v[96:111]
    s_mov_b64 exec, s[32:33]
    ds_read_b128 v[24:27], v42 offset:30720
    ds_read_b128 v[28:31], v42 offset:31360
    s_mov_b64 exec, -1
    buffer_load_dwordx4 v[184:187], v125, s[20:23], s35 offen offset:2048 sc1
    v_exp_f32 v66, v66
    v_exp_f32 v67, v67
    v_exp_f32 v68, v68
    v_exp_f32 v69, v69
    v_exp_f32 v70, v70
    s_waitcnt lgkmcnt(2)
    v_mfma_f32_32x32x16_bf16 v[80:95], v[16:19], v[8:11], v[48:63]
    v_exp_f32 v71, v71
    v_cvt_pk_bf16_f32 v32, v64, v65
    v_cvt_pk_bf16_f32 v33, v66, v67
    v_cvt_pk_bf16_f32 v34, v68, v69
    v_cvt_pk_bf16_f32 v35, v70, v71
    v_exp_f32 v72, v72
    v_exp_f32 v73, v73
    v_mfma_f32_32x32x8_bf16 v[80:95], v[20:21], v[12:13], v[80:95]
    ds_read_b128 v[16:19], v40 offset:35840
    ds_read_b64 v[20:21], v41 offset:35840
    v_exp_f32 v74, v74
    v_exp_f32 v75, v75
    v_exp_f32 v76, v76
    v_exp_f32 v77, v77
    v_exp_f32 v78, v78
    s_waitcnt lgkmcnt(2)
    v_mfma_f32_32x32x16_bf16 v[96:111], v[24:27], v[32:35], v[96:111]
    v_exp_f32 v79, v79
    v_cvt_pk_bf16_f32 v36, v72, v73
    v_cvt_pk_bf16_f32 v37, v74, v75
    v_cvt_pk_bf16_f32 v38, v76, v77
    v_cvt_pk_bf16_f32 v39, v78, v79
    s_setprio 0
    v_exp_f32 v80, v80
    v_exp_f32 v81, v81
    v_mfma_f32_32x32x16_bf16 v[96:111], v[28:31], v[36:39], v[96:111]
    s_mov_b64 exec, s[32:33]
    ds_read_b128 v[24:27], v42 offset:33280
    ds_read_b128 v[28:31], v42 offset:33920
    s_mov_b64 exec, -1
    v_exp_f32 v82, v82
    v_exp_f32 v83, v83
    v_exp_f32 v84, v84
    v_exp_f32 v85, v85
    v_exp_f32 v86, v86
    s_waitcnt lgkmcnt(2)
    v_mfma_f32_32x32x16_bf16 v[64:79], v[16:19], v[8:11], v[48:63]
    v_exp_f32 v87, v87
    v_cvt_pk_bf16_f32 v32, v80, v81
    v_cvt_pk_bf16_f32 v33, v82, v83
    v_cvt_pk_bf16_f32 v34, v84, v85
    v_cvt_pk_bf16_f32 v35, v86, v87
    v_exp_f32 v88, v88
    v_exp_f32 v89, v89
    v_mfma_f32_32x32x8_bf16 v[64:79], v[20:21], v[12:13], v[64:79]
    ds_read_b128 v[16:19], v40 offset:38400
    ds_read_b64 v[20:21], v41 offset:38400
    v_exp_f32 v90, v90
    v_exp_f32 v91, v91
    v_exp_f32 v92, v92
    v_exp_f32 v93, v93
    v_exp_f32 v94, v94
    s_waitcnt lgkmcnt(2)
    v_mfma_f32_32x32x16_bf16 v[96:111], v[24:27], v[32:35], v[96:111]
    v_exp_f32 v95, v95
    v_cvt_pk_bf16_f32 v36, v88, v89
    v_cvt_pk_bf16_f32 v37, v90, v91
    v_cvt_pk_bf16_f32 v38, v92, v93
    v_cvt_pk_bf16_f32 v39, v94, v95
    s_setprio 3
    v_exp_f32 v64, v64
    v_exp_f32 v65, v65
    v_mfma_f32_32x32x16_bf16 v[96:111], v[28:31], v[36:39], v[96:111]
    s_mov_b64 exec, s[32:33]
    ds_read_b128 v[24:27], v42 offset:35840
    ds_read_b128 v[28:31], v42 offset:36480
    s_mov_b64 exec, -1
    buffer_load_dwordx4 v[188:191], v125, s[20:23], s35 offen offset:3072 sc1
    s_add_u32 s35, s35, 4096
    v_exp_f32 v66, v66
    v_exp_f32 v67, v67
    v_exp_f32 v68, v68
    v_exp_f32 v69, v69
    v_exp_f32 v70, v70
    s_waitcnt lgkmcnt(2)
    v_mfma_f32_32x32x16_bf16 v[80:95], v[16:19], v[8:11], v[48:63]
    v_exp_f32 v71, v71
    v_cvt_pk_bf16_f32 v32, v64, v65
    v_cvt_pk_bf16_f32 v33, v66, v67
    v_cvt_pk_bf16_f32 v34, v68, v69
    v_cvt_pk_bf16_f32 v35, v70, v71
    v_exp_f32 v72, v72
    v_exp_f32 v73, v73
    v_mfma_f32_32x32x8_bf16 v[80:95], v[20:21], v[12:13], v[80:95]
    ds_read_b128 v[16:19], v40 offset:40960
    ds_read_b64 v[20:21], v41 offset:40960
    v_exp_f32 v74, v74
    v_exp_f32 v75, v75
    v_exp_f32 v76, v76
    v_exp_f32 v77, v77
    v_exp_f32 v78, v78
    s_waitcnt lgkmcnt(2)
    v_mfma_f32_32x32x16_bf16 v[96:111], v[24:27], v[32:35], v[96:111]
    v_exp_f32 v79, v79
    v_cvt_pk_bf16_f32 v36, v72, v73
    v_cvt_pk_bf16_f32 v37, v74, v75
    v_cvt_pk_bf16_f32 v38, v76, v77
    v_cvt_pk_bf16_f32 v39, v78, v79
    s_setprio 2
    v_exp_f32 v80, v80
    v_exp_f32 v81, v81
    v_mfma_f32_32x32x16_bf16 v[96:111], v[28:31], v[36:39], v[96:111]
    s_mov_b64 exec, s[32:33]
    ds_read_b128 v[24:27], v42 offset:38400
    ds_read_b128 v[28:31], v42 offset:39040
    s_mov_b64 exec, -1
    buffer_load_dwordx4 v[192:195], v125, s[20:23], s35 offen offset:0 sc1
    v_exp_f32 v82, v82
    v_exp_f32 v83, v83
    v_exp_f32 v84, v84
    v_exp_f32 v85, v85
    v_exp_f32 v86, v86
    s_waitcnt lgkmcnt(2)
    v_mfma_f32_32x32x16_bf16 v[64:79], v[16:19], v[8:11], v[48:63]
    v_exp_f32 v87, v87
    v_cvt_pk_bf16_f32 v32, v80, v81
    v_cvt_pk_bf16_f32 v33, v82, v83
    v_cvt_pk_bf16_f32 v34, v84, v85
    v_cvt_pk_bf16_f32 v35, v86, v87
    v_exp_f32 v88, v88
    v_exp_f32 v89, v89
    v_mfma_f32_32x32x8_bf16 v[64:79], v[20:21], v[12:13], v[64:79]
    ds_read_b128 v[16:19], v40 offset:43520
    ds_read_b64 v[20:21], v41 offset:43520
    v_exp_f32 v90, v90
    v_exp_f32 v91, v91
    v_exp_f32 v92, v92
    v_exp_f32 v93, v93
    v_exp_f32 v94, v94
    s_waitcnt lgkmcnt(2)
    v_mfma_f32_32x32x16_bf16 v[96:111], v[24:27], v[32:35], v[96:111]
    v_exp_f32 v95, v95
    v_cvt_pk_bf16_f32 v36, v88, v89
    v_cvt_pk_bf16_f32 v37, v90, v91
    v_cvt_pk_bf16_f32 v38, v92, v93
    v_cvt_pk_bf16_f32 v39, v94, v95
    s_setprio 1
    v_exp_f32 v64, v64
    v_exp_f32 v65, v65
    v_mfma_f32_32x32x16_bf16 v[96:111], v[28:31], v[36:39], v[96:111]
    s_mov_b64 exec, s[32:33]
    ds_read_b128 v[24:27], v42 offset:40960
    ds_read_b128 v[28:31], v42 offset:41600
    s_mov_b64 exec, -1
    buffer_load_dwordx4 v[196:199], v125, s[20:23], s35 offen offset:1024 sc1
    v_exp_f32 v66, v66
    v_exp_f32 v67, v67
    v_exp_f32 v68, v68
    v_exp_f32 v69, v69
    v_exp_f32 v70, v70
    s_waitcnt lgkmcnt(2)
    v_mfma_f32_32x32x16_bf16 v[80:95], v[16:19], v[8:11], v[48:63]
    v_exp_f32 v71, v71
    v_cvt_pk_bf16_f32 v32, v64, v65
    v_cvt_pk_bf16_f32 v33, v66, v67
    v_cvt_pk_bf16_f32 v34, v68, v69
    v_cvt_pk_bf16_f32 v35, v70, v71
    v_exp_f32 v72, v72
    v_exp_f32 v73, v73
    v_mfma_f32_32x32x8_bf16 v[80:95], v[20:21], v[12:13], v[80:95]
    ds_read_b128 v[16:19], v40 offset:46080
    ds_read_b64 v[20:21], v41 offset:46080
    v_exp_f32 v74, v74
    v_exp_f32 v75, v75
    v_exp_f32 v76, v76
    v_exp_f32 v77, v77
    v_exp_f32 v78, v78
    s_waitcnt lgkmcnt(2)
    v_mfma_f32_32x32x16_bf16 v[96:111], v[24:27], v[32:35], v[96:111]
    v_exp_f32 v79, v79
    v_cvt_pk_bf16_f32 v36, v72, v73
    v_cvt_pk_bf16_f32 v37, v74, v75
    v_cvt_pk_bf16_f32 v38, v76, v77
    v_cvt_pk_bf16_f32 v39, v78, v79
    s_setprio 0
    v_exp_f32 v80, v80
    v_exp_f32 v81, v81
    v_mfma_f32_32x32x16_bf16 v[96:111], v[28:31], v[36:39], v[96:111]
    s_mov_b64 exec, s[32:33]
    ds_read_b128 v[24:27], v42 offset:43520
    ds_read_b128 v[28:31], v42 offset:44160
    s_mov_b64 exec, -1
    buffer_load_dwordx4 v[200:203], v125, s[20:23], s35 offen offset:2048 sc1
    v_exp_f32 v82, v82
    v_exp_f32 v83, v83
    v_exp_f32 v84, v84
    v_exp_f32 v85, v85
    v_exp_f32 v86, v86
    s_waitcnt lgkmcnt(2)
    v_mfma_f32_32x32x16_bf16 v[64:79], v[16:19], v[8:11], v[48:63]
    v_exp_f32 v87, v87
    v_cvt_pk_bf16_f32 v32, v80, v81
    v_cvt_pk_bf16_f32 v33, v82, v83
    v_cvt_pk_bf16_f32 v34, v84, v85
    v_cvt_pk_bf16_f32 v35, v86, v87
    v_exp_f32 v88, v88
    v_exp_f32 v89, v89
    v_mfma_f32_32x32x8_bf16 v[64:79], v[20:21], v[12:13], v[64:79]
    ds_read_b128 v[16:19], v40 offset:48640
    ds_read_b64 v[20:21], v41 offset:48640
    v_exp_f32 v90, v90
    v_exp_f32 v91, v91
    v_exp_f32 v92, v92
    v_exp_f32 v93, v93
    v_exp_f32 v94, v94
    s_waitcnt lgkmcnt(2)
    v_mfma_f32_32x32x16_bf16 v[96:111], v[24:27], v[32:35], v[96:111]
    v_exp_f32 v95, v95
    v_cvt_pk_bf16_f32 v36, v88, v89
    v_cvt_pk_bf16_f32 v37, v90, v91
    v_cvt_pk_bf16_f32 v38, v92, v93
    v_cvt_pk_bf16_f32 v39, v94, v95
    s_waitcnt vmcnt(10)
    s_barrier
    s_setprio 3
    v_exp_f32 v64, v64
    v_exp_f32 v65, v65
    v_mfma_f32_32x32x16_bf16 v[96:111], v[28:31], v[36:39], v[96:111]
    s_mov_b64 exec, s[32:33]
    ds_read_b128 v[24:27], v42 offset:46080
    ds_read_b128 v[28:31], v42 offset:46720
    s_mov_b64 exec, -1
    buffer_load_dwordx4 v[204:207], v125, s[20:23], s35 offen offset:3072 sc1
    s_add_u32 s35, s35, 4096
    v_exp_f32 v66, v66
    v_exp_f32 v67, v67
    v_exp_f32 v68, v68
    v_exp_f32 v69, v69
    v_exp_f32 v70, v70
    s_waitcnt lgkmcnt(2)
    v_mfma_f32_32x32x16_bf16 v[80:95], v[16:19], v[8:11], v[48:63]
    v_exp_f32 v71, v71
    v_cvt_pk_bf16_f32 v32, v64, v65
    v_cvt_pk_bf16_f32 v33, v66, v67
    v_cvt_pk_bf16_f32 v34, v68, v69
    v_cvt_pk_bf16_f32 v35, v70, v71
    v_exp_f32 v72, v72
    v_exp_f32 v73, v73
    v_mfma_f32_32x32x8_bf16 v[80:95], v[20:21], v[12:13], v[80:95]
    ds_read_b128 v[16:19], v40 offset:51200
    ds_read_b64 v[20:21], v41 offset:51200
    s_mov_b32 m0, s67
    s_add_u32 s67, s67, 8192
    buffer_load_dwordx4 v125, s[20:23], s68 offen sc1 lds
    s_add_u32 s68, s68, 8192
    v_exp_f32 v74, v74
    v_exp_f32 v75, v75
    v_exp_f32 v76, v76
    v_exp_f32 v77, v77
    v_exp_f32 v78, v78
    s_waitcnt lgkmcnt(2)
    v_mfma_f32_32x32x16_bf16 v[96:111], v[24:27], v[32:35], v[96:111]
    v_exp_f32 v79, v79
    v_cvt_pk_bf16_f32 v36, v72, v73
    v_cvt_pk_bf16_f32 v37, v74, v75
    v_cvt_pk_bf16_f32 v38, v76, v77
    v_cvt_pk_bf16_f32 v39, v78, v79
    s_setprio 2
    v_exp_f32 v80, v80
    v_exp_f32 v81, v81
    v_mfma_f32_32x32x16_bf16 v[96:111], v[28:31], v[36:39], v[96:111]
    s_mov_b64 exec, s[32:33]
    ds_read_b128 v[24:27], v42 offset:48640
    ds_read_b128 v[28:31], v42 offset:49280
    s_mov_b64 exec, -1
    buffer_load_dwordx4 v[208:211], v125, s[20:23], s35 offen offset:0 sc1
    v_exp_f32 v82, v82
    v_exp_f32 v83, v83
    v_exp_f32 v84, v84
    v_exp_f32 v85, v85
    v_exp_f32 v86, v86
    s_waitcnt lgkmcnt(2)
    v_mfma_f32_32x32x16_bf16 v[64:79], v[16:19], v[8:11], v[48:63]
    v_exp_f32 v87, v87
    v_cvt_pk_bf16_f32 v32, v80, v81
    v_cvt_pk_bf16_f32 v33, v82, v83
    v_cvt_pk_bf16_f32 v34, v84, v85
    v_cvt_pk_bf16_f32 v35, v86, v87
    v_exp_f32 v88, v88
    v_exp_f32 v89, v89
    v_mfma_f32_32x32x8_bf16 v[64:79], v[20:21], v[12:13], v[64:79]
    ds_read_b128 v[16:19], v40 offset:53760
    ds_read_b64 v[20:21], v41 offset:53760
    s_mov_b32 m0, s67
    s_add_u32 s67, s67, 8192
    buffer_load_dwordx4 v125, s[20:23], s68 offen sc1 lds
    s_add_u32 s68, s68, 8192
    v_exp_f32 v90, v90
    v_exp_f32 v91, v91
    v_exp_f32 v92, v92
    v_exp_f32 v93, v93
    v_exp_f32 v94, v94
    s_waitcnt lgkmcnt(2)
    v_mfma_f32_32x32x16_bf16 v[96:111], v[24:27], v[32:35], v[96:111]
    v_exp_f32 v95, v95
    v_cvt_pk_bf16_f32 v36, v88, v89
    v_cvt_pk_bf16_f32 v37, v90, v91
    v_cvt_pk_bf16_f32 v38, v92, v93
    v_cvt_pk_bf16_f32 v39, v94, v95
    s_setprio 1
    v_exp_f32 v64, v64
    v_exp_f32 v65, v65
    v_mfma_f32_32x32x16_bf16 v[96:111], v[28:31], v[36:39], v[96:111]
    s_mov_b64 exec, s[32:33]
    ds_read_b128 v[24:27], v42 offset:51200
    ds_read_b128 v[28:31], v42 offset:51840
    s_mov_b64 exec, -1
    buffer_load_dwordx4 v[212:215], v125, s[20:23], s35 offen offset:1024 sc1
    v_exp_f32 v66, v66
    v_exp_f32 v67, v67
    v_exp_f32 v68, v68
    v_exp_f32 v69, v69
    v_exp_f32 v70, v70
    s_waitcnt lgkmcnt(2)
    v_mfma_f32_32x32x16_bf16 v[80:95], v[16:19], v[8:11], v[48:63]
    v_exp_f32 v71, v71
    v_cvt_pk_bf16_f32 v32, v64, v65
    v_cvt_pk_bf16_f32 v33, v66, v67
    v_cvt_pk_bf16_f32 v34, v68, v69
    v_cvt_pk_bf16_f32 v35, v70, v71
    v_exp_f32 v72, v72
    v_exp_f32 v73, v73
    v_mfma_f32_32x32x8_bf16 v[80:95], v[20:21], v[12:13], v[80:95]
    ds_read_b128 v[16:19], v40 offset:56320
    ds_read_b64 v[20:21], v41 offset:56320
    s_mov_b32 m0, s67
    s_add_u32 s67, s67, 8192
    buffer_load_dwordx4 v125, s[20:23], s68 offen sc1 lds
    s_add_u32 s68, s68, 8192
    v_exp_f32 v74, v74
    v_exp_f32 v75, v75
    v_exp_f32 v76, v76
    v_exp_f32 v77, v77
    v_exp_f32 v78, v78
    s_waitcnt lgkmcnt(2)
    v_mfma_f32_32x32x16_bf16 v[96:111], v[24:27], v[32:35], v[96:111]
    v_exp_f32 v79, v79
    v_cvt_pk_bf16_f32 v36, v72, v73
    v_cvt_pk_bf16_f32 v37, v74, v75
    v_cvt_pk_bf16_f32 v38, v76, v77
    v_cvt_pk_bf16_f32 v39, v78, v79
    s_setprio 0
    v_exp_f32 v80, v80
    v_exp_f32 v81, v81
    v_mfma_f32_32x32x16_bf16 v[96:111], v[28:31], v[36:39], v[96:111]
    s_mov_b64 exec, s[32:33]
    ds_read_b128 v[24:27], v42 offset:53760
    ds_read_b128 v[28:31], v42 offset:54400
    s_mov_b64 exec, -1
    buffer_load_dwordx4 v[216:219], v125, s[20:23], s35 offen offset:2048 sc1
    v_exp_f32 v82, v82
    v_exp_f32 v83, v83
    v_exp_f32 v84, v84
    v_exp_f32 v85, v85
    v_exp_f32 v86, v86
    s_waitcnt lgkmcnt(2)
    v_mfma_f32_32x32x16_bf16 v[64:79], v[16:19], v[8:11], v[48:63]
    v_exp_f32 v87, v87
    v_cvt_pk_bf16_f32 v32, v80, v81
    v_cvt_pk_bf16_f32 v33, v82, v83
    v_cvt_pk_bf16_f32 v34, v84, v85
    v_cvt_pk_bf16_f32 v35, v86, v87
    v_exp_f32 v88, v88
    v_exp_f32 v89, v89
    v_mfma_f32_32x32x8_bf16 v[64:79], v[20:21], v[12:13], v[64:79]
    ds_read_b128 v[16:19], v40 offset:58880
    ds_read_b64 v[20:21], v41 offset:58880
    s_mov_b32 m0, s67
    s_add_u32 s67, s67, 8192
    buffer_load_dwordx4 v125, s[20:23], s68 offen sc1 lds
    s_add_u32 s68, s68, 8192
    v_exp_f32 v90, v90
    v_exp_f32 v91, v91
    v_exp_f32 v92, v92
    v_exp_f32 v93, v93
    v_exp_f32 v94, v94
    s_waitcnt lgkmcnt(2)
    v_mfma_f32_32x32x16_bf16 v[96:111], v[24:27], v[32:35], v[96:111]
    v_exp_f32 v95, v95
    v_cvt_pk_bf16_f32 v36, v88, v89
    v_cvt_pk_bf16_f32 v37, v90, v91
    v_cvt_pk_bf16_f32 v38, v92, v93
    v_cvt_pk_bf16_f32 v39, v94, v95
    s_setprio 3
    v_exp_f32 v64, v64
    v_exp_f32 v65, v65
    v_mfma_f32_32x32x16_bf16 v[96:111], v[28:31], v[36:39], v[96:111]
    s_mov_b64 exec, s[32:33]
    ds_read_b128 v[24:27], v42 offset:56320
    ds_read_b128 v[28:31], v42 offset:56960
    s_mov_b64 exec, -1
    buffer_load_dwordx4 v[220:223], v125, s[20:23], s35 offen offset:3072 sc1
    s_add_u32 s35, s35, 4096
    v_exp_f32 v66, v66
    v_exp_f32 v67, v67
    v_exp_f32 v68, v68
    v_exp_f32 v69, v69
    v_exp_f32 v70, v70
    s_waitcnt lgkmcnt(2)
    v_mfma_f32_32x32x16_bf16 v[80:95], v[16:19], v[8:11], v[48:63]
    v_exp_f32 v71, v71
    v_cvt_pk_bf16_f32 v32, v64, v65
    v_cvt_pk_bf16_f32 v33, v66, v67
    v_cvt_pk_bf16_f32 v34, v68, v69
    v_cvt_pk_bf16_f32 v35, v70, v71
    v_exp_f32 v72, v72
    v_exp_f32 v73, v73
    v_mfma_f32_32x32x8_bf16 v[80:95], v[20:21], v[12:13], v[80:95]
    ds_read_b128 v[16:19], v40 offset:61440
    ds_read_b64 v[20:21], v41 offset:61440
    s_mov_b32 m0, s67
    s_add_u32 s67, s67, 8192
    buffer_load_dwordx4 v125, s[20:23], s68 offen sc1 lds
    s_add_u32 s68, s68, 8192
    v_exp_f32 v74, v74
    v_exp_f32 v75, v75
    v_exp_f32 v76, v76
    v_exp_f32 v77, v77
    v_exp_f32 v78, v78
    s_waitcnt lgkmcnt(2)
    v_mfma_f32_32x32x16_bf16 v[96:111], v[24:27], v[32:35], v[96:111]
    v_exp_f32 v79, v79
    v_cvt_pk_bf16_f32 v36, v72, v73
    v_cvt_pk_bf16_f32 v37, v74, v75
    v_cvt_pk_bf16_f32 v38, v76, v77
    v_cvt_pk_bf16_f32 v39, v78, v79
    s_setprio 2
    v_exp_f32 v80, v80
    v_exp_f32 v81, v81
    v_mfma_f32_32x32x16_bf16 v[96:111], v[28:31], v[36:39], v[96:111]
    s_mov_b64 exec, s[32:33]
    ds_read_b128 v[24:27], v42 offset:58880
    ds_read_b128 v[28:31], v42 offset:59520
    s_mov_b64 exec, -1
    buffer_load_dwordx4 v[224:227], v125, s[20:23], s35 offen offset:0 sc1
    v_exp_f32 v82, v82
    v_exp_f32 v83, v83
    v_exp_f32 v84, v84
    v_exp_f32 v85, v85
    v_exp_f32 v86, v86
    s_waitcnt lgkmcnt(2)
    v_mfma_f32_32x32x16_bf16 v[64:79], v[16:19], v[8:11], v[48:63]
    v_exp_f32 v87, v87
    v_cvt_pk_bf16_f32 v32, v80, v81
    v_cvt_pk_bf16_f32 v33, v82, v83
    v_cvt_pk_bf16_f32 v34, v84, v85
    v_cvt_pk_bf16_f32 v35, v86, v87
    v_exp_f32 v88, v88
    v_exp_f32 v89, v89
    v_mfma_f32_32x32x8_bf16 v[64:79], v[20:21], v[12:13], v[64:79]
    ds_read_b128 v[16:19], v40 offset:64000
    ds_read_b64 v[20:21], v41 offset:64000
    s_mov_b32 m0, s67
    s_add_u32 s67, s67, 8192
    buffer_load_dwordx4 v125, s[20:23], s68 offen sc1 lds
    s_add_u32 s68, s68, 8192
    v_exp_f32 v90, v90
    v_exp_f32 v91, v91
    v_exp_f32 v92, v92
    v_exp_f32 v93, v93
    v_exp_f32 v94, v94
    s_waitcnt lgkmcnt(2)
    v_mfma_f32_32x32x16_bf16 v[96:111], v[24:27], v[32:35], v[96:111]
    v_exp_f32 v95, v95
    v_cvt_pk_bf16_f32 v36, v88, v89
    v_cvt_pk_bf16_f32 v37, v90, v91
    v_cvt_pk_bf16_f32 v38, v92, v93
    v_cvt_pk_bf16_f32 v39, v94, v95
    s_setprio 1
    v_add_u32 v40, 66560, v40
    v_add_u32 v41, 66560, v41
    v_exp_f32 v64, v64
    v_exp_f32 v65, v65
    v_mfma_f32_32x32x16_bf16 v[96:111], v[28:31], v[36:39], v[96:111]
    s_mov_b64 exec, s[32:33]
    ds_read_b128 v[24:27], v42 offset:61440
    ds_read_b128 v[28:31], v42 offset:62080
    s_mov_b64 exec, -1
    buffer_load_dwordx4 v[228:231], v125, s[20:23], s35 offen offset:1024 sc1
    v_exp_f32 v66, v66
    v_exp_f32 v67, v67
    v_exp_f32 v68, v68
    v_exp_f32 v69, v69
    v_exp_f32 v70, v70
    s_waitcnt lgkmcnt(2)
    v_mfma_f32_32x32x16_bf16 v[80:95], v[16:19], v[8:11], v[48:63]
    v_exp_f32 v71, v71
    v_cvt_pk_bf16_f32 v32, v64, v65
    v_cvt_pk_bf16_f32 v33, v66, v67
    v_cvt_pk_bf16_f32 v34, v68, v69
    v_cvt_pk_bf16_f32 v35, v70, v71
    v_exp_f32 v72, v72
    v_exp_f32 v73, v73
    v_mfma_f32_32x32x8_bf16 v[80:95], v[20:21], v[12:13], v[80:95]
    ds_read_b128 v[16:19], v40 offset:0
    ds_read_b64 v[20:21], v41 offset:0
    s_mov_b32 m0, s67
    s_add_u32 s67, s67, 8192
    buffer_load_dwordx4 v125, s[20:23], s68 offen sc1 lds
    s_add_u32 s68, s68, 8192
    v_exp_f32 v74, v74
    v_exp_f32 v75, v75
    v_exp_f32 v76, v76
    v_exp_f32 v77, v77
    v_exp_f32 v78, v78
    s_waitcnt lgkmcnt(2)
    v_mfma_f32_32x32x16_bf16 v[96:111], v[24:27], v[32:35], v[96:111]
    v_exp_f32 v79, v79
    v_cvt_pk_bf16_f32 v36, v72, v73
    v_cvt_pk_bf16_f32 v37, v74, v75
    v_cvt_pk_bf16_f32 v38, v76, v77
    v_cvt_pk_bf16_f32 v39, v78, v79
    s_setprio 0
    v_exp_f32 v80, v80
    v_exp_f32 v81, v81
    v_mfma_f32_32x32x16_bf16 v[96:111], v[28:31], v[36:39], v[96:111]
    s_mov_b64 exec, s[32:33]
    ds_read_b128 v[24:27], v42 offset:64000
    ds_read_b128 v[28:31], v42 offset:64640
    s_mov_b64 exec, -1
    buffer_load_dwordx4 v[232:235], v125, s[20:23], s35 offen offset:2048 sc1
    v_exp_f32 v82, v82
    v_exp_f32 v83, v83
    v_exp_f32 v84, v84
    v_exp_f32 v85, v85
    v_exp_f32 v86, v86
    s_waitcnt lgkmcnt(2)
    v_mfma_f32_32x32x16_bf16 v[64:79], v[16:19], v[8:11], v[48:63]
    v_exp_f32 v87, v87
    v_cvt_pk_bf16_f32 v32, v80, v81
    v_cvt_pk_bf16_f32 v33, v82, v83
    v_cvt_pk_bf16_f32 v34, v84, v85
    v_cvt_pk_bf16_f32 v35, v86, v87
    v_exp_f32 v88, v88
    v_exp_f32 v89, v89
    v_mfma_f32_32x32x8_bf16 v[64:79], v[20:21], v[12:13], v[64:79]
    ds_read_b128 v[16:19], v40 offset:2560
    ds_read_b64 v[20:21], v41 offset:2560
    s_mov_b32 m0, s67
    s_add_u32 s67, s67, 8192
    buffer_load_dwordx4 v125, s[20:23], s68 offen sc1 lds
    s_add_u32 s68, s68, 8192
    v_exp_f32 v90, v90
    v_exp_f32 v91, v91
    v_exp_f32 v92, v92
    v_exp_f32 v93, v93
    v_exp_f32 v94, v94
    s_waitcnt lgkmcnt(2)
    v_mfma_f32_32x32x16_bf16 v[96:111], v[24:27], v[32:35], v[96:111]
    v_exp_f32 v95, v95
    v_cvt_pk_bf16_f32 v36, v88, v89
    v_cvt_pk_bf16_f32 v37, v90, v91
    v_cvt_pk_bf16_f32 v38, v92, v93
    v_cvt_pk_bf16_f32 v39, v94, v95
    s_setprio 3
    v_add_u32 v42, 66560, v42
    v_exp_f32 v64, v64
    v_exp_f32 v65, v65
    v_mfma_f32_32x32x16_bf16 v[96:111], v[28:31], v[36:39], v[96:111]
    s_mov_b64 exec, s[32:33]
    ds_read_b128 v[24:27], v42 offset:0
    ds_read_b128 v[28:31], v42 offset:640
    s_mov_b64 exec, -1
    buffer_load_dwordx4 v[236:239], v125, s[20:23], s35 offen offset:3072 sc1
    s_add_u32 s35, s35, 4096
    v_exp_f32 v66, v66
    v_exp_f32 v67, v67
    v_exp_f32 v68, v68
    v_exp_f32 v69, v69
    v_exp_f32 v70, v70
    s_waitcnt lgkmcnt(2)
    v_mfma_f32_32x32x16_bf16 v[80:95], v[16:19], v[8:11], v[48:63]
    v_exp_f32 v71, v71
    v_cvt_pk_bf16_f32 v32, v64, v65
    v_cvt_pk_bf16_f32 v33, v66, v67
    v_cvt_pk_bf16_f32 v34, v68, v69
    v_cvt_pk_bf16_f32 v35, v70, v71
    v_exp_f32 v72, v72
    v_exp_f32 v73, v73
    v_mfma_f32_32x32x8_bf16 v[80:95], v[20:21], v[12:13], v[80:95]
    ds_read_b128 v[16:19], v40 offset:5120
    ds_read_b64 v[20:21], v41 offset:5120
    s_mov_b32 m0, s67
    s_add_u32 s67, s67, 8192
    buffer_load_dwordx4 v125, s[20:23], s68 offen sc1 lds
    s_add_u32 s68, s68, 8192
    v_exp_f32 v74, v74
    v_exp_f32 v75, v75
    v_exp_f32 v76, v76
    v_exp_f32 v77, v77
    v_exp_f32 v78, v78
    s_waitcnt lgkmcnt(2)
    v_mfma_f32_32x32x16_bf16 v[96:111], v[24:27], v[32:35], v[96:111]
    v_exp_f32 v79, v79
    v_cvt_pk_bf16_f32 v36, v72, v73
    v_cvt_pk_bf16_f32 v37, v74, v75
    v_cvt_pk_bf16_f32 v38, v76, v77
    v_cvt_pk_bf16_f32 v39, v78, v79
    s_setprio 2
    v_exp_f32 v80, v80
    v_exp_f32 v81, v81
    v_mfma_f32_32x32x16_bf16 v[96:111], v[28:31], v[36:39], v[96:111]
    s_mov_b64 exec, s[32:33]
    ds_read_b128 v[24:27], v42 offset:2560
    ds_read_b128 v[28:31], v42 offset:3200
    s_mov_b64 exec, -1
    buffer_load_dwordx4 v[240:243], v125, s[20:23], s35 offen offset:0 sc1
    v_exp_f32 v82, v82
    v_exp_f32 v83, v83
    v_exp_f32 v84, v84
    v_exp_f32 v85, v85
    v_exp_f32 v86, v86
    s_waitcnt lgkmcnt(2)
    v_mfma_f32_32x32x16_bf16 v[64:79], v[16:19], v[8:11], v[48:63]
    v_exp_f32 v87, v87
    v_cvt_pk_bf16_f32 v32, v80, v81
    v_cvt_pk_bf16_f32 v33, v82, v83
    v_cvt_pk_bf16_f32 v34, v84, v85
    v_cvt_pk_bf16_f32 v35, v86, v87
    v_exp_f32 v88, v88
    v_exp_f32 v89, v89
    v_mfma_f32_32x32x8_bf16 v[64:79], v[20:21], v[12:13], v[64:79]
    ds_read_b128 v[16:19], v40 offset:7680
    ds_read_b64 v[20:21], v41 offset:7680
    s_mov_b32 m0, s67
    s_add_u32 s67, s67, 8192
    buffer_load_dwordx4 v125, s[20:23], s68 offen sc1 lds
    s_add_u32 s68, s68, 8192
    v_exp_f32 v90, v90
    v_exp_f32 v91, v91
    v_exp_f32 v92, v92
    v_exp_f32 v93, v93
    v_exp_f32 v94, v94
    s_waitcnt lgkmcnt(2)
    v_mfma_f32_32x32x16_bf16 v[96:111], v[24:27], v[32:35], v[96:111]
    v_exp_f32 v95, v95
    v_cvt_pk_bf16_f32 v36, v88, v89
    v_cvt_pk_bf16_f32 v37, v90, v91
    v_cvt_pk_bf16_f32 v38, v92, v93
    v_cvt_pk_bf16_f32 v39, v94, v95
    s_setprio 1
    v_exp_f32 v64, v64
    v_exp_f32 v65, v65
    v_mfma_f32_32x32x16_bf16 v[96:111], v[28:31], v[36:39], v[96:111]
    s_mov_b64 exec, s[32:33]
    ds_read_b128 v[24:27], v42 offset:5120
    ds_read_b128 v[28:31], v42 offset:5760
    s_mov_b64 exec, -1
    buffer_load_dwordx4 v[244:247], v125, s[20:23], s35 offen offset:1024 sc1
    v_exp_f32 v66, v66
    v_exp_f32 v67, v67
    v_exp_f32 v68, v68
    v_exp_f32 v69, v69
    v_exp_f32 v70, v70
    s_waitcnt lgkmcnt(2)
    v_mfma_f32_32x32x16_bf16 v[80:95], v[16:19], v[8:11], v[48:63]
    v_exp_f32 v71, v71
    v_cvt_pk_bf16_f32 v32, v64, v65
    v_cvt_pk_bf16_f32 v33, v66, v67
    v_cvt_pk_bf16_f32 v34, v68, v69
    v_cvt_pk_bf16_f32 v35, v70, v71
    v_exp_f32 v72, v72
    v_exp_f32 v73, v73
    v_mfma_f32_32x32x8_bf16 v[80:95], v[20:21], v[12:13], v[80:95]
    ds_read_b128 v[16:19], v40 offset:10240
    ds_read_b64 v[20:21], v41 offset:10240
    s_mov_b32 m0, s67
    s_add_u32 s67, s67, 8192
    buffer_load_dwordx4 v125, s[20:23], s68 offen sc1 lds
    s_add_u32 s68, s68, 8192
    v_exp_f32 v74, v74
    v_exp_f32 v75, v75
    v_exp_f32 v76, v76
    v_exp_f32 v77, v77
    v_exp_f32 v78, v78
    s_waitcnt lgkmcnt(2)
    v_mfma_f32_32x32x16_bf16 v[96:111], v[24:27], v[32:35], v[96:111]
    v_exp_f32 v79, v79
    v_cvt_pk_bf16_f32 v36, v72, v73
    v_cvt_pk_bf16_f32 v37, v74, v75
    v_cvt_pk_bf16_f32 v38, v76, v77
    v_cvt_pk_bf16_f32 v39, v78, v79
    s_setprio 0
    v_exp_f32 v80, v80
    v_exp_f32 v81, v81
    v_mfma_f32_32x32x16_bf16 v[96:111], v[28:31], v[36:39], v[96:111]
    s_mov_b64 exec, s[32:33]
    ds_read_b128 v[24:27], v42 offset:7680
    ds_read_b128 v[28:31], v42 offset:8320
    s_mov_b64 exec, -1
    v_exp_f32 v82, v82
    v_exp_f32 v83, v83
    v_exp_f32 v84, v84
    v_exp_f32 v85, v85
    v_exp_f32 v86, v86
    s_waitcnt lgkmcnt(2)
    v_mfma_f32_32x32x16_bf16 v[64:79], v[16:19], v[8:11], v[48:63]
    v_exp_f32 v87, v87
    v_cvt_pk_bf16_f32 v32, v80, v81
    v_cvt_pk_bf16_f32 v33, v82, v83
    v_cvt_pk_bf16_f32 v34, v84, v85
    v_cvt_pk_bf16_f32 v35, v86, v87
    v_exp_f32 v88, v88
    v_exp_f32 v89, v89
    v_mfma_f32_32x32x8_bf16 v[64:79], v[20:21], v[12:13], v[64:79]
    ds_read_b128 v[16:19], v40 offset:12800
    ds_read_b64 v[20:21], v41 offset:12800
    s_mov_b32 m0, s67
    s_add_u32 s67, s67, 8192
    buffer_load_dwordx4 v125, s[20:23], s68 offen sc1 lds
    s_add_u32 s68, s68, 8192
    v_exp_f32 v90, v90
    v_exp_f32 v91, v91
    v_exp_f32 v92, v92
    v_exp_f32 v93, v93
    v_exp_f32 v94, v94
    s_waitcnt lgkmcnt(2)
    v_mfma_f32_32x32x16_bf16 v[96:111], v[24:27], v[32:35], v[96:111]
    v_exp_f32 v95, v95
    v_cvt_pk_bf16_f32 v36, v88, v89
    v_cvt_pk_bf16_f32 v37, v90, v91
    v_cvt_pk_bf16_f32 v38, v92, v93
    v_cvt_pk_bf16_f32 v39, v94, v95
    s_setprio 3
    v_exp_f32 v64, v64
    v_exp_f32 v65, v65
    v_mfma_f32_32x32x16_bf16 v[96:111], v[28:31], v[36:39], v[96:111]
    s_mov_b64 exec, s[32:33]
    ds_read_b128 v[24:27], v42 offset:10240
    ds_read_b128 v[28:31], v42 offset:10880
    s_mov_b64 exec, -1
    s_mov_b64 exec, 0x1ffffff
    buffer_load_dword v123, v121, s[20:23], s36 offen sc1
    s_mov_b64 exec, -1
    v_exp_f32 v66, v66
    v_exp_f32 v67, v67
    v_exp_f32 v68, v68
    v_exp_f32 v69, v69
    v_exp_f32 v70, v70
    s_waitcnt lgkmcnt(2)
    v_mfma_f32_32x32x16_bf16 v[80:95], v[16:19], v[8:11], v[48:63]
    v_exp_f32 v71, v71
    v_cvt_pk_bf16_f32 v32, v64, v65
    v_cvt_pk_bf16_f32 v33, v66, v67
    v_cvt_pk_bf16_f32 v34, v68, v69
    v_cvt_pk_bf16_f32 v35, v70, v71
    v_exp_f32 v72, v72
    v_exp_f32 v73, v73
    v_mfma_f32_32x32x8_bf16 v[80:95], v[20:21], v[12:13], v[80:95]
    ds_read_b128 v[16:19], v40 offset:15360
    ds_read_b64 v[20:21], v41 offset:15360
    s_cmp_ge_u32 s24, 4
    s_cbranch_scc1 F_wc_1
    s_mov_b32 m0, s67
    s_add_u32 s67, s67, 8192
    buffer_load_dwordx4 v125, s[20:23], s68 offen sc1 lds
    s_add_u32 s68, s68, 8192
F_wc_1:
    v_exp_f32 v74, v74
    v_exp_f32 v75, v75
    v_exp_f32 v76, v76
    v_exp_f32 v77, v77
    v_exp_f32 v78, v78
    s_waitcnt lgkmcnt(2)
    v_mfma_f32_32x32x16_bf16 v[96:111], v[24:27], v[32:35], v[96:111]
    v_exp_f32 v79, v79
    v_cvt_pk_bf16_f32 v36, v72, v73
    v_cvt_pk_bf16_f32 v37, v74, v75
    v_cvt_pk_bf16_f32 v38, v76, v77
    v_cvt_pk_bf16_f32 v39, v78, v79
    s_setprio 2
    v_exp_f32 v80, v80
    v_exp_f32 v81, v81
    v_mfma_f32_32x32x16_bf16 v[96:111], v[28:31], v[36:39], v[96:111]
    s_mov_b64 exec, s[32:33]
    ds_read_b128 v[24:27], v42 offset:12800
    ds_read_b128 v[28:31], v42 offset:13440
    s_mov_b64 exec, -1
    v_exp_f32 v82, v82
    v_exp_f32 v83, v83
    v_exp_f32 v84, v84
    v_exp_f32 v85, v85
    v_exp_f32 v86, v86
    s_waitcnt lgkmcnt(2)
    v_mfma_f32_32x32x16_bf16 v[64:79], v[16:19], v[8:11], v[48:63]
    v_exp_f32 v87, v87
    v_cvt_pk_bf16_f32 v32, v80, v81
    v_cvt_pk_bf16_f32 v33, v82, v83
    v_cvt_pk_bf16_f32 v34, v84, v85
    v_cvt_pk_bf16_f32 v35, v86, v87
    v_exp_f32 v88, v88
    v_exp_f32 v89, v89
    v_mfma_f32_32x32x8_bf16 v[64:79], v[20:21], v[12:13], v[64:79]
    ds_read_b128 v[16:19], v40 offset:17920
    ds_read_b64 v[20:21], v41 offset:17920
    s_lshl_b32 s10, s24, 10
    s_add_u32 m0, s10, 102400
    s_nop 0
    buffer_load_dwordx4 v112, s[12:15], s69 offen lds
    v_exp_f32 v90, v90
    v_exp_f32 v91, v91
    v_exp_f32 v92, v92
    v_exp_f32 v93, v93
    v_exp_f32 v94, v94
    s_waitcnt lgkmcnt(2)
    v_mfma_f32_32x32x16_bf16 v[96:111], v[24:27], v[32:35], v[96:111]
    v_exp_f32 v95, v95
    v_cvt_pk_bf16_f32 v36, v88, v89
    v_cvt_pk_bf16_f32 v37, v90, v91
    v_cvt_pk_bf16_f32 v38, v92, v93
    v_cvt_pk_bf16_f32 v39, v94, v95
    s_setprio 1
    v_exp_f32 v64, v64
    v_exp_f32 v65, v65
    v_mfma_f32_32x32x16_bf16 v[96:111], v[28:31], v[36:39], v[96:111]
    s_mov_b64 exec, s[32:33]
    ds_read_b128 v[24:27], v42 offset:15360
    ds_read_b128 v[28:31], v42 offset:16000
    s_mov_b64 exec, -1
    v_exp_f32 v66, v66
    v_exp_f32 v67, v67
    v_exp_f32 v68, v68
    v_exp_f32 v69, v69
    v_exp_f32 v70, v70
    s_waitcnt lgkmcnt(2)
    v_mfma_f32_32x32x16_bf16 v[80:95], v[16:19], v[8:11], v[48:63]
    v_exp_f32 v71, v71
    v_cvt_pk_bf16_f32 v32, v64, v65
    v_cvt_pk_bf16_f32 v33, v66, v67
    v_cvt_pk_bf16_f32 v34, v68, v69
    v_cvt_pk_bf16_f32 v35, v70, v71
    v_exp_f32 v72, v72
    v_exp_f32 v73, v73
    v_mfma_f32_32x32x8_bf16 v[80:95], v[20:21], v[12:13], v[80:95]
    ds_read_b128 v[16:19], v40 offset:20480
    ds_read_b64 v[20:21], v41 offset:20480
    s_cmp_ge_u32 s24, 2
    s_cbranch_scc1 F_xp_2
    s_lshl_b32 s10, s24, 10
    s_add_u32 m0, s10, 110592
    s_nop 0
    buffer_load_dwordx4 v113, s[12:15], s69 offen lds
F_xp_2:
    v_exp_f32 v74, v74
    v_exp_f32 v75, v75
    v_exp_f32 v76, v76
    v_exp_f32 v77, v77
    v_exp_f32 v78, v78
    s_waitcnt lgkmcnt(2)
    v_mfma_f32_32x32x16_bf16 v[96:111], v[24:27], v[32:35], v[96:111]
    v_exp_f32 v79, v79
    v_cvt_pk_bf16_f32 v36, v72, v73
    v_cvt_pk_bf16_f32 v37, v74, v75
    v_cvt_pk_bf16_f32 v38, v76, v77
    v_cvt_pk_bf16_f32 v39, v78, v79
    s_setprio 0
    v_exp_f32 v80, v80
    v_exp_f32 v81, v81
    v_mfma_f32_32x32x16_bf16 v[96:111], v[28:31], v[36:39], v[96:111]
    s_mov_b64 exec, s[32:33]
    ds_read_b128 v[24:27], v42 offset:17920
    ds_read_b128 v[28:31], v42 offset:18560
    s_mov_b64 exec, -1
    v_exp_f32 v82, v82
    v_exp_f32 v83, v83
    v_exp_f32 v84, v84
    v_exp_f32 v85, v85
    v_exp_f32 v86, v86
    s_waitcnt lgkmcnt(2)
    v_mfma_f32_32x32x16_bf16 v[64:79], v[16:19], v[8:11], v[48:63]
    v_exp_f32 v87, v87
    v_cvt_pk_bf16_f32 v32, v80, v81
    v_cvt_pk_bf16_f32 v33, v82, v83
    v_cvt_pk_bf16_f32 v34, v84, v85
    v_cvt_pk_bf16_f32 v35, v86, v87
    v_exp_f32 v88, v88
    v_exp_f32 v89, v89
    v_mfma_f32_32x32x8_bf16 v[64:79], v[20:21], v[12:13], v[64:79]
    ds_read_b128 v[16:19], v40 offset:23040
    ds_read_b64 v[20:21], v41 offset:23040
    v_exp_f32 v90, v90
    v_exp_f32 v91, v91
    v_exp_f32 v92, v92
    v_exp_f32 v93, v93
    v_exp_f32 v94, v94
    s_waitcnt lgkmcnt(2)
    v_mfma_f32_32x32x16_bf16 v[96:111], v[24:27], v[32:35], v[96:111]
    v_exp_f32 v95, v95
    v_cvt_pk_bf16_f32 v36, v88, v89
    v_cvt_pk_bf16_f32 v37, v90, v91
    v_cvt_pk_bf16_f32 v38, v92, v93
    v_cvt_pk_bf16_f32 v39, v94, v95
    s_setprio 3
    v_exp_f32 v64, v64
    v_exp_f32 v65, v65
    v_mfma_f32_32x32x16_bf16 v[96:111], v[28:31], v[36:39], v[96:111]
    s_mov_b64 exec, s[32:33]
    ds_read_b128 v[24:27], v42 offset:20480
    ds_read_b128 v[28:31], v42 offset:21120
    s_mov_b64 exec, -1
    v_exp_f32 v66, v66
    v_exp_f32 v67, v67
    v_exp_f32 v68, v68
    v_exp_f32 v69, v69
    v_exp_f32 v70, v70
    s_waitcnt lgkmcnt(2)
    v_mfma_f32_32x32x16_bf16 v[80:95], v[16:19], v[8:11], v[48:63]
    v_exp_f32 v71, v71
    v_cvt_pk_bf16_f32 v32, v64, v65
    v_cvt_pk_bf16_f32 v33, v66, v67
    v_cvt_pk_bf16_f32 v34, v68, v69
    v_cvt_pk_bf16_f32 v35, v70, v71
    v_exp_f32 v72, v72
    v_exp_f32 v73, v73
    v_mfma_f32_32x32x8_bf16 v[80:95], v[20:21], v[12:13], v[80:95]
    ds_read_b128 v[16:19], v40 offset:25600
    ds_read_b64 v[20:21], v41 offset:25600
    v_exp_f32 v74, v74
    v_exp_f32 v75, v75
    v_exp_f32 v76, v76
    v_exp_f32 v77, v77
    v_exp_f32 v78, v78
    s_waitcnt lgkmcnt(2)
    v_mfma_f32_32x32x16_bf16 v[96:111], v[24:27], v[32:35], v[96:111]
    v_exp_f32 v79, v79
    v_cvt_pk_bf16_f32 v36, v72, v73
    v_cvt_pk_bf16_f32 v37, v74, v75
    v_cvt_pk_bf16_f32 v38, v76, v77
    v_cvt_pk_bf16_f32 v39, v78, v79
    s_setprio 2
    v_exp_f32 v80, v80
    v_exp_f32 v81, v81
    v_mfma_f32_32x32x16_bf16 v[96:111], v[28:31], v[36:39], v[96:111]
    s_mov_b64 exec, s[32:33]
    ds_read_b128 v[24:27], v42 offset:23040
    ds_read_b128 v[28:31], v42 offset:23680
    s_mov_b64 exec, -1
    v_exp_f32 v82, v82
    v_exp_f32 v83, v83
    v_exp_f32 v84, v84
    v_exp_f32 v85, v85
    v_exp_f32 v86, v86
    s_waitcnt lgkmcnt(2)
    v_mfma_f32_32x32x16_bf16 v[64:79], v[16:19], v[8:11], v[48:63]
    v_exp_f32 v87, v87
    v_cvt_pk_bf16_f32 v32, v80, v81
    v_cvt_pk_bf16_f32 v33, v82, v83
    v_cvt_pk_bf16_f32 v34, v84, v85
    v_cvt_pk_bf16_f32 v35, v86, v87
    v_exp_f32 v88, v88
    v_exp_f32 v89, v89
    v_mfma_f32_32x32x8_bf16 v[64:79], v[20:21], v[12:13], v[64:79]
    ds_read_b128 v[16:19], v40 offset:28160
    ds_read_b64 v[20:21], v41 offset:28160
    v_exp_f32 v90, v90
    v_exp_f32 v91, v91
    v_exp_f32 v92, v92
    v_exp_f32 v93, v93
    v_exp_f32 v94, v94
    s_waitcnt lgkmcnt(2)
    v_mfma_f32_32x32x16_bf16 v[96:111], v[24:27], v[32:35], v[96:111]
    v_exp_f32 v95, v95
    v_cvt_pk_bf16_f32 v36, v88, v89
    v_cvt_pk_bf16_f32 v37, v90, v91
    v_cvt_pk_bf16_f32 v38, v92, v93
    v_cvt_pk_bf16_f32 v39, v94, v95
    s_setprio 1
    v_exp_f32 v64, v64
    v_exp_f32 v65, v65
    v_mfma_f32_32x32x16_bf16 v[96:111], v[28:31], v[36:39], v[96:111]
    s_mov_b64 exec, s[32:33]
    ds_read_b128 v[24:27], v42 offset:25600
    ds_read_b128 v[28:31], v42 offset:26240
    s_mov_b64 exec, -1
    v_exp_f32 v66, v66
    v_exp_f32 v67, v67
    v_exp_f32 v68, v68
    v_exp_f32 v69, v69
    v_exp_f32 v70, v70
    s_waitcnt lgkmcnt(2)
    v_mfma_f32_32x32x16_bf16 v[80:95], v[16:19], v[8:11], v[48:63]
    v_exp_f32 v71, v71
    v_cvt_pk_bf16_f32 v32, v64, v65
    v_cvt_pk_bf16_f32 v33, v66, v67
    v_cvt_pk_bf16_f32 v34, v68, v69
    v_cvt_pk_bf16_f32 v35, v70, v71
    v_exp_f32 v72, v72
    v_exp_f32 v73, v73
    v_mfma_f32_32x32x8_bf16 v[80:95], v[20:21], v[12:13], v[80:95]
    v_exp_f32 v74, v74
    v_exp_f32 v75, v75
    v_exp_f32 v76, v76
    v_exp_f32 v77, v77
    v_exp_f32 v78, v78
    s_waitcnt lgkmcnt(0)
    v_mfma_f32_32x32x16_bf16 v[96:111], v[24:27], v[32:35], v[96:111]
    v_exp_f32 v79, v79
    v_cvt_pk_bf16_f32 v36, v72, v73
    v_cvt_pk_bf16_f32 v37, v74, v75
    v_cvt_pk_bf16_f32 v38, v76, v77
    v_cvt_pk_bf16_f32 v39, v78, v79
    s_setprio 0
    v_exp_f32 v80, v80
    v_exp_f32 v81, v81
    v_mfma_f32_32x32x16_bf16 v[96:111], v[28:31], v[36:39], v[96:111]
    s_mov_b64 exec, s[32:33]
    ds_read_b128 v[24:27], v42 offset:28160
    ds_read_b128 v[28:31], v42 offset:28800
    s_mov_b64 exec, -1
    v_exp_f32 v82, v82
    v_exp_f32 v83, v83
    v_exp_f32 v84, v84
    v_exp_f32 v85, v85
    v_exp_f32 v86, v86
    v_exp_f32 v87, v87
    v_cvt_pk_bf16_f32 v32, v80, v81
    v_cvt_pk_bf16_f32 v33, v82, v83
    v_cvt_pk_bf16_f32 v34, v84, v85
    v_cvt_pk_bf16_f32 v35, v86, v87
    v_exp_f32 v88, v88
    v_exp_f32 v89, v89
    v_exp_f32 v90, v90
    v_exp_f32 v91, v91
    v_exp_f32 v92, v92
    v_exp_f32 v93, v93
    v_exp_f32 v94, v94
    s_waitcnt lgkmcnt(0)
    v_mfma_f32_32x32x16_bf16 v[96:111], v[24:27], v[32:35], v[96:111]
    v_exp_f32 v95, v95
    v_cvt_pk_bf16_f32 v36, v88, v89
    v_cvt_pk_bf16_f32 v37, v90, v91
    v_cvt_pk_bf16_f32 v38, v92, v93
    v_cvt_pk_bf16_f32 v39, v94, v95
    s_setprio 0
    s_nop 0
    v_mfma_f32_32x32x16_bf16 v[96:111], v[28:31], v[36:39], v[96:111]
    v_lshrrev_b32 v5, 4, v3
    v_mul_u32_u24 v5, 20480, v5
    v_and_b32 v6, 15, v3
    v_lshl_add_u32 v17, v6, 4, v5
    v_lshl_add_u32 v16, v4, 8, v17
    s_mul_i32 s44, s39, 1130496
    s_mul_i32 s10, s24, 40960
    s_add_u32 s44, s44, s10
    s_add_u32 s44, s44, 7864320
    s_lshr_b32 s10, s38, 1
    s_lshl_b32 s10, s10, 8
    s_and_b32 s11, s38, 1
    s_lshl_b32 s11, s11, 3
    s_add_u32 s45, s10, s11
    s_add_u32 s45, s45, s44
    s_add_u32 s45, s45, 16384
    s_lshl_b32 s10, s38, 9
    s_add_u32 s44, s44, s10
    v_add_f32 v6, abs(v96), abs(v97)
    v_add_f32 v7, abs(v98), abs(v99)
    v_add_f32 v6, v6, abs(v100)
    v_add_f32 v7, v7, abs(v101)
    v_add_f32 v6, v6, abs(v102)
    v_add_f32 v7, v7, abs(v103)
    v_add_f32 v6, v6, abs(v104)
    v_add_f32 v7, v7, abs(v105)
    v_add_f32 v6, v6, abs(v106)
    v_add_f32 v7, v7, abs(v107)
    v_add_f32 v6, v6, v7
    v_cmp_ngt_f32 vcc, 0x5f800000, v108
    s_mov_b64 s[10:11], vcc
    v_cmp_ngt_f32 vcc, 0x7e800000, v6
    s_or_b64 s[10:11], s[10:11], vcc
    s_cbranch_scc1 F_slow
F_out:
    v_rcp_f32 v6, v108
    s_nop 0
    v_mul_f32 v96, v96, v6
    v_mul_f32 v97, v97, v6
    v_mul_f32 v98, v98, v6
    v_mul_f32 v99, v99, v6
    v_mul_f32 v100, v100, v6
    v_mul_f32 v101, v101, v6
    v_mul_f32 v102, v102, v6
    v_mul_f32 v103, v103, v6
    v_mul_f32 v104, v104, v6
    v_mul_f32 v105, v105, v6
    v_mul_f32 v106, v106, v6
    v_mul_f32 v107, v107, v6
    v_cvt_pk_bf16_f32 v96, v96, v97
    v_cvt_pk_bf16_f32 v97, v98, v99
    v_cvt_pk_bf16_f32 v98, v100, v101
    v_cvt_pk_bf16_f32 v99, v102, v103
    v_cvt_pk_bf16_f32 v100, v104, v105
    v_cvt_pk_bf16_f32 v101, v106, v107
    buffer_store_dwordx4 v[96:99], v16, s[20:23], s44 offen sc1
    s_mov_b32 exec_hi, 0
    buffer_store_dwordx2 v[100:101], v17, s[20:23], s45 offen sc1
    s_mov_b32 exec_hi, -1
    s_mov_b32 s11, 0x40000
    s_waitcnt vmcnt(34)
F_xc:
    v_cmp_ne_u64 vcc, s[98:99], v[116:117]
    s_cbranch_vccz F_xc2
    buffer_load_dwordx4 v[116:119], v122, s[20:23], s51 offen sc1
    s_sub_u32 s11, s11, 1
    s_waitcnt vmcnt(0)
    s_cmp_lg_u32 s11, 0
    s_cbranch_scc1 F_xc
F_xc2:
    v_cmp_ne_u32 vcc, s55, v118
    s_mov_b32 s54, 0
    s_cbranch_vccz F_xc3
    s_mov_b32 s54, 1
F_xc3:
    s_lshr_b32 s60, s57, 2
    s_xor_b32 s60, s60, s59
    s_mul_i32 s10, s60, 51200
    v_add_u32 v108, s10, v125
    s_mul_i32 s31, s66, 20480
    s_mul_i32 s11, s60, 10240
    s_add_u32 s31, s31, s11
    s_add_u32 s31, s31, s52
    s_mov_b32 s28, 0x3f803f80
    s_waitcnt vmcnt(0)
    s_barrier
    s_cmp_lg_u32 s24, 4
    s_cbranch_scc1 F_s1_o
    s_lshl_b32 s10, s39, 12
    s_lshl_b32 s11, s38, 7
    s_add_u32 s10, s10, s11
    s_add_u32 s10, s10, 16990208
    v_mov_b32 v6, s98
    v_mov_b32 v7, s99
    v_mov_b32 v5, 0
    s_mov_b64 exec, 1
    buffer_store_dwordx2 v[6:7], v5, s[20:23], s10 offen sc1
    s_mov_b64 exec, -1
F_s1_o:
    ds_read_b128 v[28:31], v108 offset:0
    ds_read_b128 v[32:35], v108 offset:1024
    ds_read_b128 v[36:39], v108 offset:2048
    ds_read_b128 v[40:43], v108 offset:3072
    ds_read_b128 v[44:47], v108 offset:4096
    ds_read_b128 v[48:51], v108 offset:5120
    ds_read_b128 v[52:55], v108 offset:6144
    ds_read_b128 v[56:59], v108 offset:7168
    ds_read_b128 v[60:63], v108 offset:8192
    ds_read_b128 v[64:67], v108 offset:9216
    s_cmp_eq_u32 s59, 0
    s_cbranch_scc1 F_s1_a
    v_and_b32 v5, 15, v2
    v_mul_u32_u24 v5, 160, v5
    v_lshrrev_b32 v6, 4, v2
    v_lshl_add_u32 v5, v6, 3, v5
    s_mul_i32 s10, s58, 2560
    s_add_u32 s10, s10, 102400
    v_add_u32 v5, s10, v5
    ds_read_b64 v[110:111], v5 offset:0
    ds_read_b64 v[112:113], v5 offset:32
    ds_read_b64 v[114:115], v5 offset:64
    ds_read_b64 v[116:117], v5 offset:96
    ds_read_b64 v[118:119], v5 offset:128
    s_waitcnt lgkmcnt(0)
    v_lshlrev_b32 v8, 16, v110
    v_and_b32 v9, 0xffff0000, v110
    v_lshlrev_b32 v10, 16, v111
    v_and_b32 v11, 0xffff0000, v111
    v_lshlrev_b32 v12, 16, v112
    v_and_b32 v13, 0xffff0000, v112
    v_lshlrev_b32 v14, 16, v113
    v_and_b32 v15, 0xffff0000, v113
    v_lshlrev_b32 v16, 16, v114
    v_and_b32 v17, 0xffff0000, v114
    v_lshlrev_b32 v18, 16, v115
    v_and_b32 v19, 0xffff0000, v115
    v_lshlrev_b32 v20, 16, v116
    v_and_b32 v21, 0xffff0000, v116
    v_lshlrev_b32 v22, 16, v117
    v_and_b32 v23, 0xffff0000, v117
    v_lshlrev_b32 v24, 16, v118
    v_and_b32 v25, 0xffff0000, v118
    v_lshlrev_b32 v26, 16, v119
    v_and_b32 v27, 0xffff0000, v119
    s_cmp_lg_u32 s24, 4
    s_cbranch_scc1 F_s1_done
    v_lshlrev_b32 v5, 7, v3
    s_lshl_b32 s10, s25, 12
    s_add_u32 s10, s10, 16990208
    s_mov_b32 s11, 0x40000
F_s1_poll:
    buffer_load_dwordx2 v[6:7], v5, s[20:23], s10 offen offset:0 sc1
    s_sub_u32 s11, s11, 1
    s_cmp_eq_u32 s11, 0
    s_cbranch_scc1 F_s1_got
    s_waitcnt vmcnt(0)
    v_cmp_ne_u64 vcc, s[98:99], v[6:7]
    s_cbranch_vccnz F_s1_poll
F_s1_got:
    s_branch F_s1_done
F_s1_a:
    v_mov_b32 v8, 0
    v_mov_b32 v9, 0
    v_mov_b32 v10, 0
    s_lshl_b32 s10, s24, 2
    s_add_u32 s10, s10, 143360
    v_lshl_add_u32 v7, v2, 4, s10
    v_dot2c_f32_bf16 v8, s28, v128
    v_dot2c_f32_bf16 v9, s28, v132
    v_dot2c_f32_bf16 v10, s28, v136
    v_dot2c_f32_bf16 v8, s28, v129
    v_dot2c_f32_bf16 v9, s28, v133
    v_dot2c_f32_bf16 v10, s28, v137
    v_dot2c_f32_bf16 v8, s28, v130
    v_dot2c_f32_bf16 v9, s28, v134
    v_dot2c_f32_bf16 v10, s28, v138
    v_dot2c_f32_bf16 v8, s28, v131
    v_dot2c_f32_bf16 v9, s28, v135
    v_dot2c_f32_bf16 v10, s28, v139
    v_dot2c_f32_bf16 v8, s28, v140
    v_dot2c_f32_bf16 v9, s28, v144
    v_dot2c_f32_bf16 v10, s28, v148
    v_dot2c_f32_bf16 v8, s28, v141
    v_dot2c_f32_bf16 v9, s28, v145
    v_dot2c_f32_bf16 v10, s28, v149
    v_dot2c_f32_bf16 v8, s28, v142
    v_dot2c_f32_bf16 v9, s28, v146
    v_dot2c_f32_bf16 v10, s28, v150
    v_dot2c_f32_bf16 v8, s28, v143
    v_dot2c_f32_bf16 v9, s28, v147
    v_dot2c_f32_bf16 v10, s28, v151
    v_dot2c_f32_bf16 v8, s28, v152
    v_dot2c_f32_bf16 v9, s28, v156
    v_dot2c_f32_bf16 v10, s28, v160
    v_dot2c_f32_bf16 v8, s28, v153
    v_dot2c_f32_bf16 v9, s28, v157
    v_dot2c_f32_bf16 v10, s28, v161
    v_dot2c_f32_bf16 v8, s28, v154
    v_dot2c_f32_bf16 v9, s28, v158
    v_dot2c_f32_bf16 v10, s28, v162
    v_dot2c_f32_bf16 v8, s28, v155
    v_dot2c_f32_bf16 v9, s28, v159
    v_dot2c_f32_bf16 v10, s28, v163
    v_dot2c_f32_bf16 v8, s28, v164
    v_dot2c_f32_bf16 v9, s28, v168
    v_dot2c_f32_bf16 v10, s28, v172
    v_dot2c_f32_bf16 v8, s28, v165
    v_dot2c_f32_bf16 v9, s28, v169
    v_dot2c_f32_bf16 v10, s28, v173
    v_dot2c_f32_bf16 v8, s28, v166
    v_dot2c_f32_bf16 v9, s28, v170
    v_dot2c_f32_bf16 v10, s28, v174
    v_dot2c_f32_bf16 v8, s28, v167
    v_dot2c_f32_bf16 v9, s28, v171
    v_dot2c_f32_bf16 v10, s28, v175
    v_dot2c_f32_bf16 v8, s28, v176
    v_dot2c_f32_bf16 v9, s28, v180
    v_dot2c_f32_bf16 v10, s28, v184
    v_dot2c_f32_bf16 v8, s28, v177
    v_dot2c_f32_bf16 v9, s28, v181
    v_dot2c_f32_bf16 v10, s28, v185
    v_dot2c_f32_bf16 v8, s28, v178
    v_dot2c_f32_bf16 v9, s28, v182
    v_dot2c_f32_bf16 v10, s28, v186
    v_dot2c_f32_bf16 v8, s28, v179
    v_dot2c_f32_bf16 v9, s28, v183
    v_dot2c_f32_bf16 v10, s28, v187
    v_dot2c_f32_bf16 v8, s28, v188
    v_dot2c_f32_bf16 v9, s28, v192
    v_dot2c_f32_bf16 v10, s28, v196
    v_dot2c_f32_bf16 v8, s28, v189
    v_dot2c_f32_bf16 v9, s28, v193
    v_dot2c_f32_bf16 v10, s28, v197
    v_dot2c_f32_bf16 v8, s28, v190
    v_dot2c_f32_bf16 v9, s28, v194
    v_dot2c_f32_bf16 v10, s28, v198
    v_dot2c_f32_bf16 v8, s28, v191
    v_dot2c_f32_bf16 v9, s28, v195
    v_dot2c_f32_bf16 v10, s28, v199
    v_dot2c_f32_bf16 v8, s28, v200
    v_dot2c_f32_bf16 v9, s28, v204
    v_dot2c_f32_bf16 v10, s28, v208
    v_dot2c_f32_bf16 v8, s28, v201
    v_dot2c_f32_bf16 v9, s28, v205
    v_dot2c_f32_bf16 v10, s28, v209
    v_dot2c_f32_bf16 v8, s28, v202
    v_dot2c_f32_bf16 v9, s28, v206
    v_dot2c_f32_bf16 v10, s28, v210
    v_dot2c_f32_bf16 v8, s28, v203
    v_dot2c_f32_bf16 v9, s28, v207
    v_dot2c_f32_bf16 v10, s28, v211
    v_dot2c_f32_bf16 v8, s28, v212
    v_dot2c_f32_bf16 v9, s28, v216
    v_dot2c_f32_bf16 v10, s28, v220
    v_dot2c_f32_bf16 v8, s28, v213
    v_dot2c_f32_bf16 v9, s28, v217
    v_dot2c_f32_bf16 v10, s28, v221
    v_dot2c_f32_bf16 v8, s28, v214
    v_dot2c_f32_bf16 v9, s28, v218
    v_dot2c_f32_bf16 v10, s28, v222
    v_dot2c_f32_bf16 v8, s28, v215
    v_dot2c_f32_bf16 v9, s28, v219
    v_dot2c_f32_bf16 v10, s28, v223
    v_dot2c_f32_bf16 v8, s28, v224
    v_dot2c_f32_bf16 v9, s28, v228
    v_dot2c_f32_bf16 v10, s28, v232
    v_dot2c_f32_bf16 v8, s28, v225
    v_dot2c_f32_bf16 v9, s28, v229
    v_dot2c_f32_bf16 v10, s28, v233
    v_dot2c_f32_bf16 v8, s28, v226
    v_dot2c_f32_bf16 v9, s28, v230
    v_dot2c_f32_bf16 v10, s28, v234
    v_dot2c_f32_bf16 v8, s28, v227
    v_dot2c_f32_bf16 v9, s28, v231
    v_dot2c_f32_bf16 v10, s28, v235
    v_dot2c_f32_bf16 v8, s28, v236
    v_dot2c_f32_bf16 v9, s28, v240
    v_dot2c_f32_bf16 v10, s28, v244
    v_dot2c_f32_bf16 v8, s28, v237
    v_dot2c_f32_bf16 v9, s28, v241
    v_dot2c_f32_bf16 v10, s28, v245
    v_dot2c_f32_bf16 v8, s28, v238
    v_dot2c_f32_bf16 v9, s28, v242
    v_dot2c_f32_bf16 v10, s28, v246
    v_dot2c_f32_bf16 v8, s28, v239
    v_dot2c_f32_bf16 v9, s28, v243
    v_dot2c_f32_bf16 v10, s28, v247
    s_nop 2
    ds_write_b32 v7, v8 offset:0
    ds_write_b32 v7, v9 offset:1024
    ds_write_b32 v7, v10 offset:2048
    s_waitcnt lgkmcnt(0)
    v_mov_b32 v8, 0
    v_mov_b32 v9, 0
    v_mov_b32 v10, 0
    v_mov_b32 v11, 0
    v_mov_b32 v12, 0
    v_mov_b32 v13, 0
    v_mov_b32 v14, 0
    v_mov_b32 v15, 0
    v_mov_b32 v16, 0
    v_mov_b32 v17, 0
    v_mov_b32 v18, 0
    v_mov_b32 v19, 0
    v_mov_b32 v20, 0
    v_mov_b32 v21, 0
    v_mov_b32 v22, 0
    v_mov_b32 v23, 0
    v_mov_b32 v24, 0
    v_mov_b32 v25, 0
    v_mov_b32 v26, 0
    v_mov_b32 v27, 0
F_s1_done:
    s_barrier
    buffer_load_dwordx4 v[68:71], v125, s[20:23], s31 offen offset:0 sc1
    buffer_load_dwordx4 v[72:75], v125, s[20:23], s31 offen offset:1024 sc1
    buffer_load_dwordx4 v[76:79], v125, s[20:23], s31 offen offset:2048 sc1
    buffer_load_dwordx4 v[80:83], v125, s[20:23], s31 offen offset:3072 sc1
    s_add_u32 s31, s31, 4096
    buffer_load_dwordx4 v[84:87], v125, s[20:23], s31 offen offset:0 sc1
    buffer_load_dwordx4 v[88:91], v125, s[20:23], s31 offen offset:1024 sc1
    buffer_load_dwordx4 v[92:95], v125, s[20:23], s31 offen offset:2048 sc1
    buffer_load_dwordx4 v[96:99], v125, s[20:23], s31 offen offset:3072 sc1
    s_add_u32 s31, s31, 4096
    buffer_load_dwordx4 v[100:103], v125, s[20:23], s31 offen offset:0 sc1
    buffer_load_dwordx4 v[104:107], v125, s[20:23], s31 offen offset:1024 sc1
    s_mul_i32 s10, s58, 5120
    s_add_u32 s10, s10, 122880
    v_add_u32 v1, s10, v125
    s_waitcnt vmcnt(9) lgkmcnt(5)
    v_mfma_f32_16x16x32_bf16 v[8:11], v[28:31], v[68:71], v[8:11]
    v_mfma_f32_16x16x32_bf16 v[12:15], v[32:35], v[68:71], v[12:15]
    v_mfma_f32_16x16x32_bf16 v[16:19], v[36:39], v[68:71], v[16:19]
    v_mfma_f32_16x16x32_bf16 v[20:23], v[40:43], v[68:71], v[20:23]
    v_mfma_f32_16x16x32_bf16 v[24:27], v[44:47], v[68:71], v[24:27]
    ds_read_b128 v[28:31], v108 offset:10240
    ds_read_b128 v[32:35], v108 offset:11264
    ds_read_b128 v[36:39], v108 offset:12288
    ds_read_b128 v[40:43], v108 offset:13312
    ds_read_b128 v[44:47], v108 offset:14336
    s_waitcnt vmcnt(8) lgkmcnt(5)
    v_mfma_f32_16x16x32_bf16 v[8:11], v[48:51], v[72:75], v[8:11]
    v_mfma_f32_16x16x32_bf16 v[12:15], v[52:55], v[72:75], v[12:15]
    v_mfma_f32_16x16x32_bf16 v[16:19], v[56:59], v[72:75], v[16:19]
    v_mfma_f32_16x16x32_bf16 v[20:23], v[60:63], v[72:75], v[20:23]
    v_mfma_f32_16x16x32_bf16 v[24:27], v[64:67], v[72:75], v[24:27]
    ds_read_b128 v[48:51], v108 offset:15360
    ds_read_b128 v[52:55], v108 offset:16384
    ds_read_b128 v[56:59], v108 offset:17408
    ds_read_b128 v[60:63], v108 offset:18432
    ds_read_b128 v[64:67], v108 offset:19456
    s_waitcnt vmcnt(7) lgkmcnt(5)
    v_mfma_f32_16x16x32_bf16 v[8:11], v[28:31], v[76:79], v[8:11]
    v_mfma_f32_16x16x32_bf16 v[12:15], v[32:35], v[76:79], v[12:15]
    v_mfma_f32_16x16x32_bf16 v[16:19], v[36:39], v[76:79], v[16:19]
    v_mfma_f32_16x16x32_bf16 v[20:23], v[40:43], v[76:79], v[20:23]
    v_mfma_f32_16x16x32_bf16 v[24:27], v[44:47], v[76:79], v[24:27]
    ds_read_b128 v[28:31], v108 offset:20480
    ds_read_b128 v[32:35], v108 offset:21504
    ds_read_b128 v[36:39], v108 offset:22528
    ds_read_b128 v[40:43], v108 offset:23552
    ds_read_b128 v[44:47], v108 offset:24576
    s_waitcnt vmcnt(6) lgkmcnt(5)
    v_mfma_f32_16x16x32_bf16 v[8:11], v[48:51], v[80:83], v[8:11]
    v_mfma_f32_16x16x32_bf16 v[12:15], v[52:55], v[80:83], v[12:15]
    v_mfma_f32_16x16x32_bf16 v[16:19], v[56:59], v[80:83], v[16:19]
    v_mfma_f32_16x16x32_bf16 v[20:23], v[60:63], v[80:83], v[20:23]
    v_mfma_f32_16x16x32_bf16 v[24:27], v[64:67], v[80:83], v[24:27]
    ds_read_b128 v[48:51], v108 offset:25600
    ds_read_b128 v[52:55], v108 offset:26624
    ds_read_b128 v[56:59], v108 offset:27648
    ds_read_b128 v[60:63], v108 offset:28672
    ds_read_b128 v[64:67], v108 offset:29696
    s_waitcnt vmcnt(5) lgkmcnt(5)
    v_mfma_f32_16x16x32_bf16 v[8:11], v[28:31], v[84:87], v[8:11]
    v_mfma_f32_16x16x32_bf16 v[12:15], v[32:35], v[84:87], v[12:15]
    v_mfma_f32_16x16x32_bf16 v[16:19], v[36:39], v[84:87], v[16:19]
    v_mfma_f32_16x16x32_bf16 v[20:23], v[40:43], v[84:87], v[20:23]
    v_mfma_f32_16x16x32_bf16 v[24:27], v[44:47], v[84:87], v[24:27]
    ds_read_b128 v[28:31], v108 offset:30720
    ds_read_b128 v[32:35], v108 offset:31744
    ds_read_b128 v[36:39], v108 offset:32768
    ds_read_b128 v[40:43], v108 offset:33792
    ds_read_b128 v[44:47], v108 offset:34816
    s_waitcnt vmcnt(4) lgkmcnt(5)
    v_mfma_f32_16x16x32_bf16 v[8:11], v[48:51], v[88:91], v[8:11]
    v_mfma_f32_16x16x32_bf16 v[12:15], v[52:55], v[88:91], v[12:15]
    v_mfma_f32_16x16x32_bf16 v[16:19], v[56:59], v[88:91], v[16:19]
    v_mfma_f32_16x16x32_bf16 v[20:23], v[60:63], v[88:91], v[20:23]
    v_mfma_f32_16x16x32_bf16 v[24:27], v[64:67], v[88:91], v[24:27]
    ds_read_b128 v[48:51], v108 offset:35840
    ds_read_b128 v[52:55], v108 offset:36864
    ds_read_b128 v[56:59], v108 offset:37888
    ds_read_b128 v[60:63], v108 offset:38912
    ds_read_b128 v[64:67], v108 offset:39936
    s_waitcnt vmcnt(3) lgkmcnt(5)
    v_mfma_f32_16x16x32_bf16 v[8:11], v[28:31], v[92:95], v[8:11]
    v_mfma_f32_16x16x32_bf16 v[12:15], v[32:35], v[92:95], v[12:15]
    v_mfma_f32_16x16x32_bf16 v[16:19], v[36:39], v[92:95], v[16:19]
    v_mfma_f32_16x16x32_bf16 v[20:23], v[40:43], v[92:95], v[20:23]
    v_mfma_f32_16x16x32_bf16 v[24:27], v[44:47], v[92:95], v[24:27]
    ds_read_b128 v[28:31], v108 offset:40960
    ds_read_b128 v[32:35], v108 offset:41984
    ds_read_b128 v[36:39], v108 offset:43008
    ds_read_b128 v[40:43], v108 offset:44032
    ds_read_b128 v[44:47], v108 offset:45056
    s_waitcnt vmcnt(2) lgkmcnt(5)
    v_mfma_f32_16x16x32_bf16 v[8:11], v[48:51], v[96:99], v[8:11]
    v_mfma_f32_16x16x32_bf16 v[12:15], v[52:55], v[96:99], v[12:15]
    v_mfma_f32_16x16x32_bf16 v[16:19], v[56:59], v[96:99], v[16:19]
    v_mfma_f32_16x16x32_bf16 v[20:23], v[60:63], v[96:99], v[20:23]
    v_mfma_f32_16x16x32_bf16 v[24:27], v[64:67], v[96:99], v[24:27]
    ds_read_b128 v[48:51], v108 offset:46080
    ds_read_b128 v[52:55], v108 offset:47104
    ds_read_b128 v[56:59], v108 offset:48128
    ds_read_b128 v[60:63], v108 offset:49152
    ds_read_b128 v[64:67], v108 offset:50176
    s_cmp_eq_u32 s59, 1
    s_cbranch_scc1 F_cb
    s_waitcnt vmcnt(1) lgkmcnt(5)
    v_mfma_f32_16x16x32_bf16 v[8:11], v[28:31], v[100:103], v[8:11]
    v_mfma_f32_16x16x32_bf16 v[12:15], v[32:35], v[100:103], v[12:15]
    v_mfma_f32_16x16x32_bf16 v[16:19], v[36:39], v[100:103], v[16:19]
    v_mfma_f32_16x16x32_bf16 v[20:23], v[40:43], v[100:103], v[20:23]
    v_mfma_f32_16x16x32_bf16 v[24:27], v[44:47], v[100:103], v[24:27]
    s_waitcnt vmcnt(0) lgkmcnt(0)
    v_mfma_f32_16x16x32_bf16 v[8:11], v[48:51], v[104:107], v[8:11]
    v_mfma_f32_16x16x32_bf16 v[12:15], v[52:55], v[104:107], v[12:15]
    v_mfma_f32_16x16x32_bf16 v[16:19], v[56:59], v[104:107], v[16:19]
    v_mfma_f32_16x16x32_bf16 v[20:23], v[60:63], v[104:107], v[20:23]
    v_mfma_f32_16x16x32_bf16 v[24:27], v[64:67], v[104:107], v[24:27]
    s_mul_i32 s10, s24, 30720
    v_add_u32 v7, s10, v125
    v_add_u32 v6, 143360, v125
    s_nop 4
    ds_write_b128 v1, v[8:11] offset:0
    ds_write_b128 v1, v[12:15] offset:1024
    ds_write_b128 v1, v[16:19] offset:2048
    ds_write_b128 v1, v[20:23] offset:3072
    ds_write_b128 v1, v[24:27] offset:4096
    ds_read_b128 v[28:31], v6 offset:0
    ds_read_b128 v[32:35], v6 offset:1024
    ds_read_b128 v[36:39], v6 offset:2048
    s_waitcnt lgkmcnt(0)
    s_barrier
    s_mov_b32 s10, 0x07060302
    v_add_f32 v28, v28, v29
    v_add_f32 v30, v30, v31
    v_add_f32 v28, v28, v30
    v_and_b32 v6, 0xffff0000, v28
    v_sub_f32 v6, v28, v6
    v_perm_b32 v104, v6, v28, s10
    v_perm_b32 v105, v6, v28, s10
    v_add_f32 v32, v32, v33
    v_add_f32 v34, v34, v35
    v_add_f32 v32, v32, v34
    v_and_b32 v6, 0xffff0000, v32
    v_sub_f32 v6, v32, v6
    v_perm_b32 v106, v6, v32, s10
    v_perm_b32 v107, v6, v32, s10
    v_add_f32 v36, v36, v37
    v_add_f32 v38, v38, v39
    v_add_f32 v36, v36, v38
    v_and_b32 v6, 0xffff0000, v36
    v_sub_f32 v6, v36, v6
    v_perm_b32 v108, v6, v36, s10
    v_perm_b32 v109, v6, v36, s10
    v_add_u32 v111, 61440, v125
    s_mul_i32 s31, s24, 81920
    s_add_u32 s31, s31, 786432
    s_add_u32 s31, s31, s52
    s_add_u32 s29, s31, 40960
    v_lshlrev_b32 v5, 3, v3
    v_lshl_add_u32 v1, v4, 13, v5
    s_lshl_b32 s30, s24, 9
    s_add_u32 s30, s30, 1114112
    s_add_u32 s30, s30, s52
    s_lshl_b32 s48, s24, 8
    s_add_u32 s48, s48, s53
    s_barrier
    ds_write_b128 v7, v[128:131] offset:0
    ds_write_b128 v7, v[132:135] offset:1024
    ds_write_b128 v7, v[136:139] offset:2048
    ds_write_b128 v7, v[140:143] offset:3072
    ds_write_b128 v7, v[144:147] offset:4096
    ds_write_b128 v7, v[148:151] offset:5120
    ds_write_b128 v7, v[152:155] offset:6144
    ds_write_b128 v7, v[156:159] offset:7168
    ds_write_b128 v7, v[160:163] offset:8192
    ds_write_b128 v7, v[164:167] offset:9216
    ds_write_b128 v7, v[168:171] offset:10240
    ds_write_b128 v7, v[172:175] offset:11264
    ds_write_b128 v7, v[176:179] offset:12288
    ds_write_b128 v7, v[180:183] offset:13312
    ds_write_b128 v7, v[184:187] offset:14336
    ds_write_b128 v7, v[188:191] offset:15360
    ds_write_b128 v7, v[192:195] offset:16384
    ds_write_b128 v7, v[196:199] offset:17408
    ds_write_b128 v7, v[200:203] offset:18432
    ds_write_b128 v7, v[204:207] offset:19456
    ds_write_b128 v7, v[208:211] offset:20480
    ds_write_b128 v7, v[212:215] offset:21504
    ds_write_b128 v7, v[216:219] offset:22528
    ds_write_b128 v7, v[220:223] offset:23552
    ds_write_b128 v7, v[224:227] offset:24576
    ds_write_b128 v7, v[228:231] offset:25600
    ds_write_b128 v7, v[232:235] offset:26624
    ds_write_b128 v7, v[236:239] offset:27648
    ds_write_b128 v7, v[240:243] offset:28672
    ds_write_b128 v7, v[244:247] offset:29696
    s_mov_b32 s11, 0x40000
F_s2_poll:
    buffer_load_dwordx2 v[6:7], v124, s[20:23], s48 offen offset:0 sc1
    s_sub_u32 s11, s11, 1
    s_cmp_eq_u32 s11, 0
    s_cbranch_scc1 F_s2_got
    s_waitcnt vmcnt(0)
    v_cmp_ne_u64 vcc, s[98:99], v[6:7]
    s_cbranch_vccnz F_s2_poll
F_s2_got:
    s_cmp_eq_u32 s54, 0
    s_cbranch_scc1 F_s2_p1
    buffer_inv sc1
    s_waitcnt vmcnt(0)
F_s2_p1:
    s_waitcnt lgkmcnt(0)
    buffer_load_dwordx4 v[164:167], v125, s[20:23], s31 offen offset:0 sc1
    buffer_load_dwordx4 v[168:171], v125, s[20:23], s29 offen offset:0 sc1
    buffer_load_dwordx4 v[172:175], v125, s[20:23], s31 offen offset:1024 sc1
    buffer_load_dwordx4 v[176:179], v125, s[20:23], s29 offen offset:1024 sc1
    buffer_load_dwordx4 v[180:183], v125, s[20:23], s31 offen offset:2048 sc1
    buffer_load_dwordx4 v[184:187], v125, s[20:23], s29 offen offset:2048 sc1
    buffer_load_dwordx4 v[188:191], v125, s[20:23], s31 offen offset:3072 sc1
    buffer_load_dwordx4 v[192:195], v125, s[20:23], s29 offen offset:3072 sc1
    s_add_u32 s31, s31, 4096
    s_add_u32 s29, s29, 4096
    s_barrier
    ds_read_b128 v[128:131], v125 offset:0
    ds_read_b128 v[132:135], v125 offset:1024
    ds_read_b128 v[136:139], v125 offset:2048
    ds_read_b128 v[140:143], v125 offset:3072
    ds_read_b128 v[144:147], v125 offset:4096
    ds_read_b128 v[148:151], v125 offset:5120
    s_add_u32 s46, s30, 4096
    s_waitcnt vmcnt(7) lgkmcnt(3)
    v_mfma_f32_32x32x16_bf16 v[8:23], v[128:131], v[164:167], 0
    ds_read_b128 v[152:155], v125 offset:6144
    v_mfma_f32_32x32x16_bf16 v[24:39], v[132:135], v[164:167], 0
    ds_read_b128 v[156:159], v125 offset:7168
    v_mfma_f32_32x32x16_bf16 v[40:55], v[136:139], v[164:167], 0
    ds_read_b128 v[160:163], v125 offset:8192
    s_waitcnt vmcnt(6)
    v_mfma_f32_32x32x16_bf16 v[56:71], v[128:131], v[168:171], 0
    buffer_load_dwordx4 v[196:199], v125, s[20:23], s31 offen offset:0 sc1
    v_mfma_f32_32x32x16_bf16 v[72:87], v[132:135], v[168:171], 0
    buffer_load_dwordx4 v[200:203], v125, s[20:23], s29 offen offset:0 sc1
    v_mfma_f32_32x32x16_bf16 v[88:103], v[136:139], v[168:171], 0
    buffer_load_dwordx4 v[204:207], v125, s[20:23], s31 offen offset:1024 sc1
    buffer_load_dwordx4 v[208:211], v125, s[20:23], s29 offen offset:1024 sc1
    s_waitcnt vmcnt(9) lgkmcnt(3)
    v_mfma_f32_32x32x16_bf16 v[8:23], v[140:143], v[172:175], v[8:23]
    ds_read_b128 v[128:131], v125 offset:9216
    v_mfma_f32_32x32x16_bf16 v[24:39], v[144:147], v[172:175], v[24:39]
    ds_read_b128 v[132:135], v125 offset:10240
    v_mfma_f32_32x32x16_bf16 v[40:55], v[148:151], v[172:175], v[40:55]
    ds_read_b128 v[136:139], v125 offset:11264
    s_waitcnt vmcnt(8)
    v_mfma_f32_32x32x16_bf16 v[56:71], v[140:143], v[176:179], v[56:71]
    buffer_load_dwordx4 v[212:215], v125, s[20:23], s31 offen offset:2048 sc1
    v_mfma_f32_32x32x16_bf16 v[72:87], v[144:147], v[176:179], v[72:87]
    buffer_load_dwordx4 v[216:219], v125, s[20:23], s29 offen offset:2048 sc1
    v_mfma_f32_32x32x16_bf16 v[88:103], v[148:151], v[176:179], v[88:103]
    buffer_load_dwordx4 v[220:223], v125, s[20:23], s31 offen offset:3072 sc1
    buffer_load_dwordx4 v[224:227], v125, s[20:23], s29 offen offset:3072 sc1
    s_add_u32 s31, s31, 4096
    s_add_u32 s29, s29, 4096
    s_waitcnt vmcnt(11) lgkmcnt(3)
    v_mfma_f32_32x32x16_bf16 v[8:23], v[152:155], v[180:183], v[8:23]
    ds_read_b128 v[140:143], v125 offset:12288
    v_mfma_f32_32x32x16_bf16 v[24:39], v[156:159], v[180:183], v[24:39]
    ds_read_b128 v[144:147], v125 offset:13312
    v_mfma_f32_32x32x16_bf16 v[40:55], v[160:163], v[180:183], v[40:55]
    ds_read_b128 v[148:151], v125 offset:14336
    s_waitcnt vmcnt(10)
    v_mfma_f32_32x32x16_bf16 v[56:71], v[152:155], v[184:187], v[56:71]
    buffer_load_dwordx4 v[164:167], v125, s[20:23], s31 offen offset:0 sc1
    v_mfma_f32_32x32x16_bf16 v[72:87], v[156:159], v[184:187], v[72:87]
    buffer_load_dwordx4 v[168:171], v125, s[20:23], s29 offen offset:0 sc1
    v_mfma_f32_32x32x16_bf16 v[88:103], v[160:163], v[184:187], v[88:103]
    s_waitcnt vmcnt(11) lgkmcnt(3)
    v_mfma_f32_32x32x16_bf16 v[8:23], v[128:131], v[188:191], v[8:23]
    ds_read_b128 v[152:155], v125 offset:15360
    v_mfma_f32_32x32x16_bf16 v[24:39], v[132:135], v[188:191], v[24:39]
    ds_read_b128 v[156:159], v125 offset:16384
    v_mfma_f32_32x32x16_bf16 v[40:55], v[136:139], v[188:191], v[40:55]
    ds_read_b128 v[160:163], v125 offset:17408
    s_waitcnt vmcnt(10)
    v_mfma_f32_32x32x16_bf16 v[56:71], v[128:131], v[192:195], v[56:71]
    buffer_load_dwordx4 v[172:175], v125, s[20:23], s31 offen offset:1024 sc1
    v_mfma_f32_32x32x16_bf16 v[72:87], v[132:135], v[192:195], v[72:87]
    buffer_load_dwordx4 v[176:179], v125, s[20:23], s29 offen offset:1024 sc1
    v_mfma_f32_32x32x16_bf16 v[88:103], v[136:139], v[192:195], v[88:103]
    s_waitcnt vmcnt(11) lgkmcnt(3)
    v_mfma_f32_32x32x16_bf16 v[8:23], v[140:143], v[196:199], v[8:23]
    ds_read_b128 v[128:131], v125 offset:18432
    v_mfma_f32_32x32x16_bf16 v[24:39], v[144:147], v[196:199], v[24:39]
    ds_read_b128 v[132:135], v125 offset:19456
    v_mfma_f32_32x32x16_bf16 v[40:55], v[148:151], v[196:199], v[40:55]
    ds_read_b128 v[136:139], v125 offset:20480
    s_waitcnt vmcnt(10)
    v_mfma_f32_32x32x16_bf16 v[56:71], v[140:143], v[200:203], v[56:71]
    buffer_load_dwordx4 v[180:183], v125, s[20:23], s31 offen offset:2048 sc1
    v_mfma_f32_32x32x16_bf16 v[72:87], v[144:147], v[200:203], v[72:87]
    buffer_load_dwordx4 v[184:187], v125, s[20:23], s29 offen offset:2048 sc1
    v_mfma_f32_32x32x16_bf16 v[88:103], v[148:151], v[200:203], v[88:103]
    buffer_load_dwordx2 v[228:229], v1, s[20:23], s30 offen offset:0 sc1
    s_waitcnt vmcnt(12) lgkmcnt(3)
    v_mfma_f32_32x32x16_bf16 v[8:23], v[152:155], v[204:207], v[8:23]
    ds_read_b128 v[140:143], v125 offset:21504
    v_mfma_f32_32x32x16_bf16 v[24:39], v[156:159], v[204:207], v[24:39]
    ds_read_b128 v[144:147], v125 offset:22528
    v_mfma_f32_32x32x16_bf16 v[40:55], v[160:163], v[204:207], v[40:55]
    ds_read_b128 v[148:151], v125 offset:23552
    s_waitcnt vmcnt(11)
    v_mfma_f32_32x32x16_bf16 v[56:71], v[152:155], v[208:211], v[56:71]
    buffer_load_dwordx4 v[188:191], v125, s[20:23], s31 offen offset:3072 sc1
    v_mfma_f32_32x32x16_bf16 v[72:87], v[156:159], v[208:211], v[72:87]
    buffer_load_dwordx4 v[192:195], v125, s[20:23], s29 offen offset:3072 sc1
    s_add_u32 s31, s31, 4096
    s_add_u32 s29, s29, 4096
    v_mfma_f32_32x32x16_bf16 v[88:103], v[160:163], v[208:211], v[88:103]
    buffer_load_dwordx2 v[230:231], v1, s[20:23], s30 offen offset:2048 sc1
    s_waitcnt vmcnt(13) lgkmcnt(3)
    v_mfma_f32_32x32x16_bf16 v[8:23], v[128:131], v[212:215], v[8:23]
    ds_read_b128 v[152:155], v125 offset:24576
    v_mfma_f32_32x32x16_bf16 v[24:39], v[132:135], v[212:215], v[24:39]
    ds_read_b128 v[156:159], v125 offset:25600
    v_mfma_f32_32x32x16_bf16 v[40:55], v[136:139], v[212:215], v[40:55]
    ds_read_b128 v[160:163], v125 offset:26624
    s_waitcnt vmcnt(12)
    v_mfma_f32_32x32x16_bf16 v[56:71], v[128:131], v[216:219], v[56:71]
    buffer_load_dwordx4 v[196:199], v125, s[20:23], s31 offen offset:0 sc1
    v_mfma_f32_32x32x16_bf16 v[72:87], v[132:135], v[216:219], v[72:87]
    buffer_load_dwordx4 v[200:203], v125, s[20:23], s29 offen offset:0 sc1
    v_mfma_f32_32x32x16_bf16 v[88:103], v[136:139], v[216:219], v[88:103]
    buffer_load_dwordx2 v[232:233], v1, s[20:23], s46 offen offset:0 sc1
    s_waitcnt vmcnt(14) lgkmcnt(3)
    v_mfma_f32_32x32x16_bf16 v[8:23], v[140:143], v[220:223], v[8:23]
    ds_read_b128 v[128:131], v125 offset:27648
    v_mfma_f32_32x32x16_bf16 v[24:39], v[144:147], v[220:223], v[24:39]
    ds_read_b128 v[132:135], v125 offset:28672
    v_mfma_f32_32x32x16_bf16 v[40:55], v[148:151], v[220:223], v[40:55]
    ds_read_b128 v[136:139], v125 offset:29696
    s_waitcnt vmcnt(13)
    v_mfma_f32_32x32x16_bf16 v[56:71], v[140:143], v[224:227], v[56:71]
    buffer_load_dwordx4 v[204:207], v125, s[20:23], s31 offen offset:1024 sc1
    v_mfma_f32_32x32x16_bf16 v[72:87], v[144:147], v[224:227], v[72:87]
    buffer_load_dwordx4 v[208:211], v125, s[20:23], s29 offen offset:1024 sc1
    v_mfma_f32_32x32x16_bf16 v[88:103], v[148:151], v[224:227], v[88:103]
    buffer_load_dwordx2 v[234:235], v1, s[20:23], s46 offen offset:2048 sc1
    s_waitcnt vmcnt(15) lgkmcnt(3)
    v_mfma_f32_32x32x16_bf16 v[8:23], v[152:155], v[164:167], v[8:23]
    ds_read_b128 v[140:143], v125 offset:30720
    v_mfma_f32_32x32x16_bf16 v[24:39], v[156:159], v[164:167], v[24:39]
    ds_read_b128 v[144:147], v125 offset:31744
    v_mfma_f32_32x32x16_bf16 v[40:55], v[160:163], v[164:167], v[40:55]
    ds_read_b128 v[148:151], v125 offset:32768
    s_waitcnt vmcnt(14)
    v_mfma_f32_32x32x16_bf16 v[56:71], v[152:155], v[168:171], v[56:71]
    buffer_load_dwordx4 v[212:215], v125, s[20:23], s31 offen offset:2048 sc1
    v_mfma_f32_32x32x16_bf16 v[72:87], v[156:159], v[168:171], v[72:87]
    buffer_load_dwordx4 v[216:219], v125, s[20:23], s29 offen offset:2048 sc1
    v_mfma_f32_32x32x16_bf16 v[88:103], v[160:163], v[168:171], v[88:103]
    buffer_load_dwordx2 v[236:237], v1, s[20:23], s30 offen offset:256 sc1
    s_waitcnt vmcnt(16) lgkmcnt(3)
    v_mfma_f32_32x32x16_bf16 v[8:23], v[128:131], v[172:175], v[8:23]
    ds_read_b128 v[152:155], v125 offset:33792
    v_mfma_f32_32x32x16_bf16 v[24:39], v[132:135], v[172:175], v[24:39]
    ds_read_b128 v[156:159], v125 offset:34816
    v_mfma_f32_32x32x16_bf16 v[40:55], v[136:139], v[172:175], v[40:55]
    ds_read_b128 v[160:163], v125 offset:35840
    s_waitcnt vmcnt(15)
    v_mfma_f32_32x32x16_bf16 v[56:71], v[128:131], v[176:179], v[56:71]
    buffer_load_dwordx4 v[220:223], v125, s[20:23], s31 offen offset:3072 sc1
    v_mfma_f32_32x32x16_bf16 v[72:87], v[132:135], v[176:179], v[72:87]
    buffer_load_dwordx4 v[224:227], v125, s[20:23], s29 offen offset:3072 sc1
    s_add_u32 s31, s31, 4096
    s_add_u32 s29, s29, 4096
    v_mfma_f32_32x32x16_bf16 v[88:103], v[136:139], v[176:179], v[88:103]
    buffer_load_dwordx2 v[238:239], v1, s[20:23], s30 offen offset:2304 sc1
    s_waitcnt vmcnt(17) lgkmcnt(3)
    v_mfma_f32_32x32x16_bf16 v[8:23], v[140:143], v[180:183], v[8:23]
    ds_read_b128 v[128:131], v125 offset:36864
    v_mfma_f32_32x32x16_bf16 v[24:39], v[144:147], v[180:183], v[24:39]
    ds_read_b128 v[132:135], v125 offset:37888
    v_mfma_f32_32x32x16_bf16 v[40:55], v[148:151], v[180:183], v[40:55]
    ds_read_b128 v[136:139], v125 offset:38912
    s_waitcnt vmcnt(16)
    v_mfma_f32_32x32x16_bf16 v[56:71], v[140:143], v[184:187], v[56:71]
    buffer_load_dwordx4 v[164:167], v125, s[20:23], s31 offen offset:0 sc1
    v_mfma_f32_32x32x16_bf16 v[72:87], v[144:147], v[184:187], v[72:87]
    buffer_load_dwordx4 v[168:171], v125, s[20:23], s29 offen offset:0 sc1
    v_mfma_f32_32x32x16_bf16 v[88:103], v[148:151], v[184:187], v[88:103]
    buffer_load_dwordx2 v[240:241], v1, s[20:23], s46 offen offset:256 sc1
    s_waitcnt vmcnt(17) lgkmcnt(3)
    v_mfma_f32_32x32x16_bf16 v[8:23], v[152:155], v[188:191], v[8:23]
    ds_read_b128 v[140:143], v125 offset:39936
    v_mfma_f32_32x32x16_bf16 v[24:39], v[156:159], v[188:191], v[24:39]
    ds_read_b128 v[144:147], v125 offset:40960
    v_mfma_f32_32x32x16_bf16 v[40:55], v[160:163], v[188:191], v[40:55]
    ds_read_b128 v[148:151], v125 offset:41984
    s_waitcnt vmcnt(16)
    v_mfma_f32_32x32x16_bf16 v[56:71], v[152:155], v[192:195], v[56:71]
    buffer_load_dwordx4 v[172:175], v125, s[20:23], s31 offen offset:1024 sc1
    v_mfma_f32_32x32x16_bf16 v[72:87], v[156:159], v[192:195], v[72:87]
    buffer_load_dwordx4 v[176:179], v125, s[20:23], s29 offen offset:1024 sc1
    v_mfma_f32_32x32x16_bf16 v[88:103], v[160:163], v[192:195], v[88:103]
    buffer_load_dwordx2 v[242:243], v1, s[20:23], s46 offen offset:2304 sc1
    s_waitcnt vmcnt(17) lgkmcnt(3)
    v_mfma_f32_32x32x16_bf16 v[8:23], v[128:131], v[196:199], v[8:23]
    ds_read_b128 v[152:155], v125 offset:43008
    v_mfma_f32_32x32x16_bf16 v[24:39], v[132:135], v[196:199], v[24:39]
    ds_read_b128 v[156:159], v125 offset:44032
    v_mfma_f32_32x32x16_bf16 v[40:55], v[136:139], v[196:199], v[40:55]
    ds_read_b128 v[160:163], v125 offset:45056
    s_waitcnt vmcnt(16)
    v_mfma_f32_32x32x16_bf16 v[56:71], v[128:131], v[200:203], v[56:71]
    buffer_load_dwordx4 v[180:183], v125, s[20:23], s31 offen offset:2048 sc1
    v_mfma_f32_32x32x16_bf16 v[72:87], v[132:135], v[200:203], v[72:87]
    buffer_load_dwordx4 v[184:187], v125, s[20:23], s29 offen offset:2048 sc1
    v_mfma_f32_32x32x16_bf16 v[88:103], v[136:139], v[200:203], v[88:103]
    s_waitcnt vmcnt(16) lgkmcnt(3)
    v_mfma_f32_32x32x16_bf16 v[8:23], v[140:143], v[204:207], v[8:23]
    ds_read_b128 v[128:131], v125 offset:46080
    v_mfma_f32_32x32x16_bf16 v[24:39], v[144:147], v[204:207], v[24:39]
    ds_read_b128 v[132:135], v125 offset:47104
    v_mfma_f32_32x32x16_bf16 v[40:55], v[148:151], v[204:207], v[40:55]
    ds_read_b128 v[136:139], v125 offset:48128
    s_waitcnt vmcnt(15)
    v_mfma_f32_32x32x16_bf16 v[56:71], v[140:143], v[208:211], v[56:71]
    buffer_load_dwordx4 v[188:191], v125, s[20:23], s31 offen offset:3072 sc1
    v_mfma_f32_32x32x16_bf16 v[72:87], v[144:147], v[208:211], v[72:87]
    buffer_load_dwordx4 v[192:195], v125, s[20:23], s29 offen offset:3072 sc1
    s_add_u32 s31, s31, 4096
    s_add_u32 s29, s29, 4096
    v_mfma_f32_32x32x16_bf16 v[88:103], v[148:151], v[208:211], v[88:103]
    s_waitcnt vmcnt(15) lgkmcnt(3)
    v_mfma_f32_32x32x16_bf16 v[8:23], v[152:155], v[212:215], v[8:23]
    ds_read_b128 v[140:143], v125 offset:49152
    v_mfma_f32_32x32x16_bf16 v[24:39], v[156:159], v[212:215], v[24:39]
    ds_read_b128 v[144:147], v125 offset:50176
    v_mfma_f32_32x32x16_bf16 v[40:55], v[160:163], v[212:215], v[40:55]
    ds_read_b128 v[148:151], v125 offset:51200
    s_waitcnt vmcnt(14)
    v_mfma_f32_32x32x16_bf16 v[56:71], v[152:155], v[216:219], v[56:71]
    buffer_load_dwordx4 v[196:199], v125, s[20:23], s31 offen offset:0 sc1
    v_mfma_f32_32x32x16_bf16 v[72:87], v[156:159], v[216:219], v[72:87]
    buffer_load_dwordx4 v[200:203], v125, s[20:23], s29 offen offset:0 sc1
    v_mfma_f32_32x32x16_bf16 v[88:103], v[160:163], v[216:219], v[88:103]
    s_waitcnt vmcnt(14) lgkmcnt(3)
    v_mfma_f32_32x32x16_bf16 v[8:23], v[128:131], v[220:223], v[8:23]
    ds_read_b128 v[152:155], v125 offset:52224
    v_mfma_f32_32x32x16_bf16 v[24:39], v[132:135], v[220:223], v[24:39]
    ds_read_b128 v[156:159], v125 offset:53248
    v_mfma_f32_32x32x16_bf16 v[40:55], v[136:139], v[220:223], v[40:55]
    ds_read_b128 v[160:163], v125 offset:54272
    s_waitcnt vmcnt(13)
    v_mfma_f32_32x32x16_bf16 v[56:71], v[128:131], v[224:227], v[56:71]
    buffer_load_dwordx4 v[204:207], v125, s[20:23], s31 offen offset:1024 sc1
    v_mfma_f32_32x32x16_bf16 v[72:87], v[132:135], v[224:227], v[72:87]
    buffer_load_dwordx4 v[208:211], v125, s[20:23], s29 offen offset:1024 sc1
    v_mfma_f32_32x32x16_bf16 v[88:103], v[136:139], v[224:227], v[88:103]
    s_waitcnt vmcnt(13) lgkmcnt(3)
    v_mfma_f32_32x32x16_bf16 v[8:23], v[140:143], v[164:167], v[8:23]
    ds_read_b128 v[128:131], v125 offset:55296
    v_mfma_f32_32x32x16_bf16 v[24:39], v[144:147], v[164:167], v[24:39]
    ds_read_b128 v[132:135], v125 offset:56320
    v_mfma_f32_32x32x16_bf16 v[40:55], v[148:151], v[164:167], v[40:55]
    ds_read_b128 v[136:139], v125 offset:57344
    s_waitcnt vmcnt(12)
    v_mfma_f32_32x32x16_bf16 v[56:71], v[140:143], v[168:171], v[56:71]
    buffer_load_dwordx4 v[212:215], v125, s[20:23], s31 offen offset:2048 sc1
    v_mfma_f32_32x32x16_bf16 v[72:87], v[144:147], v[168:171], v[72:87]
    buffer_load_dwordx4 v[216:219], v125, s[20:23], s29 offen offset:2048 sc1
    v_mfma_f32_32x32x16_bf16 v[88:103], v[148:151], v[168:171], v[88:103]
    s_waitcnt vmcnt(12) lgkmcnt(3)
    v_mfma_f32_32x32x16_bf16 v[8:23], v[152:155], v[172:175], v[8:23]
    ds_read_b128 v[140:143], v125 offset:58368
    v_mfma_f32_32x32x16_bf16 v[24:39], v[156:159], v[172:175], v[24:39]
    ds_read_b128 v[144:147], v125 offset:59392
    v_mfma_f32_32x32x16_bf16 v[40:55], v[160:163], v[172:175], v[40:55]
    ds_read_b128 v[148:151], v125 offset:60416
    s_waitcnt vmcnt(11)
    v_mfma_f32_32x32x16_bf16 v[56:71], v[152:155], v[176:179], v[56:71]
    buffer_load_dwordx4 v[220:223], v125, s[20:23], s31 offen offset:3072 sc1
    v_mfma_f32_32x32x16_bf16 v[72:87], v[156:159], v[176:179], v[72:87]
    buffer_load_dwordx4 v[224:227], v125, s[20:23], s29 offen offset:3072 sc1
    s_add_u32 s31, s31, 4096
    s_add_u32 s29, s29, 4096
    v_mfma_f32_32x32x16_bf16 v[88:103], v[160:163], v[176:179], v[88:103]
    s_waitcnt vmcnt(11) lgkmcnt(3)
    v_mfma_f32_32x32x16_bf16 v[8:23], v[128:131], v[180:183], v[8:23]
    ds_read_b128 v[152:155], v111 offset:0
    v_mfma_f32_32x32x16_bf16 v[24:39], v[132:135], v[180:183], v[24:39]
    ds_read_b128 v[156:159], v111 offset:1024
    v_mfma_f32_32x32x16_bf16 v[40:55], v[136:139], v[180:183], v[40:55]
    ds_read_b128 v[160:163], v111 offset:2048
    s_waitcnt vmcnt(10)
    v_mfma_f32_32x32x16_bf16 v[56:71], v[128:131], v[184:187], v[56:71]
    buffer_load_dwordx4 v[164:167], v125, s[20:23], s31 offen offset:0 sc1
    v_mfma_f32_32x32x16_bf16 v[72:87], v[132:135], v[184:187], v[72:87]
    buffer_load_dwordx4 v[168:171], v125, s[20:23], s29 offen offset:0 sc1
    v_mfma_f32_32x32x16_bf16 v[88:103], v[136:139], v[184:187], v[88:103]
    s_waitcnt vmcnt(11) lgkmcnt(3)
    v_mfma_f32_32x32x16_bf16 v[8:23], v[140:143], v[188:191], v[8:23]
    ds_read_b128 v[128:131], v111 offset:3072
    v_mfma_f32_32x32x16_bf16 v[24:39], v[144:147], v[188:191], v[24:39]
    ds_read_b128 v[132:135], v111 offset:4096
    v_mfma_f32_32x32x16_bf16 v[40:55], v[148:151], v[188:191], v[40:55]
    ds_read_b128 v[136:139], v111 offset:5120
    s_waitcnt vmcnt(10)
    v_mfma_f32_32x32x16_bf16 v[56:71], v[140:143], v[192:195], v[56:71]
    buffer_load_dwordx4 v[172:175], v125, s[20:23], s31 offen offset:1024 sc1
    v_mfma_f32_32x32x16_bf16 v[72:87], v[144:147], v[192:195], v[72:87]
    buffer_load_dwordx4 v[176:179], v125, s[20:23], s29 offen offset:1024 sc1
    v_mfma_f32_32x32x16_bf16 v[88:103], v[148:151], v[192:195], v[88:103]
    s_waitcnt vmcnt(11) lgkmcnt(3)
    v_mfma_f32_32x32x16_bf16 v[8:23], v[152:155], v[196:199], v[8:23]
    ds_read_b128 v[140:143], v111 offset:6144
    v_add_f32 v228, v228, v230
    v_mfma_f32_32x32x16_bf16 v[24:39], v[156:159], v[196:199], v[24:39]
    ds_read_b128 v[144:147], v111 offset:7168
    v_add_f32 v229, v229, v231
    v_mfma_f32_32x32x16_bf16 v[40:55], v[160:163], v[196:199], v[40:55]
    ds_read_b128 v[148:151], v111 offset:8192
    v_add_f32 v232, v232, v234
    s_waitcnt vmcnt(10)
    v_mfma_f32_32x32x16_bf16 v[56:71], v[152:155], v[200:203], v[56:71]
    buffer_load_dwordx4 v[180:183], v125, s[20:23], s31 offen offset:2048 sc1
    v_add_f32 v233, v233, v235
    v_mfma_f32_32x32x16_bf16 v[72:87], v[156:159], v[200:203], v[72:87]
    buffer_load_dwordx4 v[184:187], v125, s[20:23], s29 offen offset:2048 sc1
    v_add_f32 v228, v228, v232
    v_mfma_f32_32x32x16_bf16 v[88:103], v[160:163], v[200:203], v[88:103]
    v_add_f32 v229, v229, v233
    s_waitcnt vmcnt(11) lgkmcnt(3)
    v_mfma_f32_32x32x16_bf16 v[8:23], v[128:131], v[204:207], v[8:23]
    ds_read_b128 v[152:155], v111 offset:9216
    v_mov_b32 v230, v228
    v_mfma_f32_32x32x16_bf16 v[24:39], v[132:135], v[204:207], v[24:39]
    ds_read_b128 v[156:159], v111 offset:10240
    v_mov_b32 v231, v229
    v_mfma_f32_32x32x16_bf16 v[40:55], v[136:139], v[204:207], v[40:55]
    ds_read_b128 v[160:163], v111 offset:11264
    s_nop 1
    s_waitcnt vmcnt(10)
    v_mfma_f32_32x32x16_bf16 v[56:71], v[128:131], v[208:211], v[56:71]
    buffer_load_dwordx4 v[188:191], v125, s[20:23], s31 offen offset:3072 sc1
    v_permlane32_swap_b32 v228, v230
    v_mfma_f32_32x32x16_bf16 v[72:87], v[132:135], v[208:211], v[72:87]
    buffer_load_dwordx4 v[192:195], v125, s[20:23], s29 offen offset:3072 sc1
    s_add_u32 s31, s31, 4096
    s_add_u32 s29, s29, 4096
    v_permlane32_swap_b32 v229, v231
    v_mfma_f32_32x32x16_bf16 v[88:103], v[136:139], v[208:211], v[88:103]
    s_nop 1
    s_waitcnt vmcnt(11) lgkmcnt(3)
    v_mfma_f32_32x32x16_bf16 v[8:23], v[140:143], v[212:215], v[8:23]
    ds_read_b128 v[128:131], v111 offset:12288
    v_add_f32 v228, v228, v230
    v_mfma_f32_32x32x16_bf16 v[24:39], v[144:147], v[212:215], v[24:39]
    ds_read_b128 v[132:135], v111 offset:13312
    v_add_f32 v229, v229, v231
    v_mfma_f32_32x32x16_bf16 v[40:55], v[148:151], v[212:215], v[40:55]
    ds_read_b128 v[136:139], v111 offset:14336
    v_mul_f32 v228, 0xbacccccd, v228
    s_waitcnt vmcnt(10)
    v_mfma_f32_32x32x16_bf16 v[56:71], v[140:143], v[216:219], v[56:71]
    buffer_load_dwordx4 v[196:199], v125, s[20:23], s31 offen offset:0 sc1
    v_mul_f32 v229, 0x3acccccd, v229
    v_mfma_f32_32x32x16_bf16 v[72:87], v[144:147], v[216:219], v[72:87]
    buffer_load_dwordx4 v[200:203], v125, s[20:23], s29 offen offset:0 sc1
    v_fma_f32 v229, -v228, v228, v229
    v_mfma_f32_32x32x16_bf16 v[88:103], v[148:151], v[216:219], v[88:103]
    v_max_f32 v229, 0, v229
    s_waitcnt vmcnt(11) lgkmcnt(3)
    v_mfma_f32_32x32x16_bf16 v[8:23], v[152:155], v[220:223], v[8:23]
    ds_read_b128 v[140:143], v111 offset:15360
    v_add_f32 v230, 0x3727c5ac, v229
    v_mfma_f32_32x32x16_bf16 v[24:39], v[156:159], v[220:223], v[24:39]
    ds_read_b128 v[144:147], v111 offset:16384
    v_rsq_f32 v229, v230
    v_mfma_f32_32x32x16_bf16 v[40:55], v[160:163], v[220:223], v[40:55]
    ds_read_b128 v[148:151], v111 offset:17408
    s_mov_b32 s11, 0x03020302
    s_waitcnt vmcnt(10)
    v_mfma_f32_32x32x16_bf16 v[56:71], v[152:155], v[224:227], v[56:71]
    buffer_load_dwordx4 v[204:207], v125, s[20:23], s31 offen offset:1024 sc1
    v_and_b32 v5, 0xffff0000, v228
    v_mfma_f32_32x32x16_bf16 v[72:87], v[156:159], v[224:227], v[72:87]
    buffer_load_dwordx4 v[208:211], v125, s[20:23], s29 offen offset:1024 sc1
    v_sub_f32 v5, v228, v5
    v_mfma_f32_32x32x16_bf16 v[88:103], v[160:163], v[224:227], v[88:103]
    v_perm_b32 v234, v228, v228, s11
    s_waitcnt vmcnt(11) lgkmcnt(3)
    v_mfma_f32_32x32x16_bf16 v[8:23], v[128:131], v[164:167], v[8:23]
    ds_read_b128 v[152:155], v111 offset:18432
    v_perm_b32 v235, v5, v5, s11
    v_mfma_f32_32x32x16_bf16 v[24:39], v[132:135], v[164:167], v[24:39]
    ds_read_b128 v[156:159], v111 offset:19456
    v_mul_f32 v232, 0xc0135761, v229
    v_mfma_f32_32x32x16_bf16 v[40:55], v[136:139], v[164:167], v[40:55]
    ds_read_b128 v[160:163], v111 offset:20480
    v_mul_f32 v233, v229, v229
    s_waitcnt vmcnt(10)
    v_mfma_f32_32x32x16_bf16 v[56:71], v[128:131], v[168:171], v[56:71]
    buffer_load_dwordx4 v[212:215], v125, s[20:23], s31 offen offset:2048 sc1
    v_mul_f32 v233, v233, v229
    v_mfma_f32_32x32x16_bf16 v[72:87], v[132:135], v[168:171], v[72:87]
    buffer_load_dwordx4 v[216:219], v125, s[20:23], s29 offen offset:2048 sc1
    v_mul_f32 v233, 0xbdd2d3e8, v233
    v_mfma_f32_32x32x16_bf16 v[88:103], v[136:139], v[168:171], v[88:103]
    v_add_f32 v236, v236, v238
    s_waitcnt vmcnt(11) lgkmcnt(3)
    v_mfma_f32_32x32x16_bf16 v[8:23], v[140:143], v[172:175], v[8:23]
    ds_read_b128 v[128:131], v111 offset:21504
    v_add_f32 v237, v237, v239
    v_mfma_f32_32x32x16_bf16 v[24:39], v[144:147], v[172:175], v[24:39]
    ds_read_b128 v[132:135], v111 offset:22528
    v_add_f32 v240, v240, v242
    v_mfma_f32_32x32x16_bf16 v[40:55], v[148:151], v[172:175], v[40:55]
    ds_read_b128 v[136:139], v111 offset:23552
    v_add_f32 v241, v241, v243
    s_waitcnt vmcnt(10)
    v_mfma_f32_32x32x16_bf16 v[56:71], v[140:143], v[176:179], v[56:71]
    buffer_load_dwordx4 v[220:223], v125, s[20:23], s31 offen offset:3072 sc1
    v_add_f32 v236, v236, v240
    v_mfma_f32_32x32x16_bf16 v[72:87], v[144:147], v[176:179], v[72:87]
    buffer_load_dwordx4 v[224:227], v125, s[20:23], s29 offen offset:3072 sc1
    s_add_u32 s31, s31, 4096
    s_add_u32 s29, s29, 4096
    v_add_f32 v237, v237, v241
    v_mfma_f32_32x32x16_bf16 v[88:103], v[148:151], v[176:179], v[88:103]
    v_mov_b32 v238, v236
    s_waitcnt vmcnt(11) lgkmcnt(3)
    v_mfma_f32_32x32x16_bf16 v[8:23], v[152:155], v[180:183], v[8:23]
    ds_read_b128 v[140:143], v111 offset:24576
    v_mov_b32 v239, v237
    v_mfma_f32_32x32x16_bf16 v[24:39], v[156:159], v[180:183], v[24:39]
    ds_read_b128 v[144:147], v111 offset:25600
    s_nop 1
    v_mfma_f32_32x32x16_bf16 v[40:55], v[160:163], v[180:183], v[40:55]
    ds_read_b128 v[148:151], v111 offset:26624
    v_permlane32_swap_b32 v236, v238
    s_waitcnt vmcnt(10)
    v_mfma_f32_32x32x16_bf16 v[56:71], v[152:155], v[184:187], v[56:71]
    buffer_load_dwordx4 v[164:167], v125, s[20:23], s31 offen offset:0 sc1
    v_permlane32_swap_b32 v237, v239
    v_mfma_f32_32x32x16_bf16 v[72:87], v[156:159], v[184:187], v[72:87]
    buffer_load_dwordx4 v[168:171], v125, s[20:23], s29 offen offset:0 sc1
    s_nop 1
    v_mfma_f32_32x32x16_bf16 v[88:103], v[160:163], v[184:187], v[88:103]
    v_add_f32 v236, v236, v238
    s_waitcnt vmcnt(11) lgkmcnt(3)
    v_mfma_f32_32x32x16_bf16 v[8:23], v[128:131], v[188:191], v[8:23]
    ds_read_b128 v[152:155], v111 offset:27648
    v_add_f32 v237, v237, v239
    v_mfma_f32_32x32x16_bf16 v[24:39], v[132:135], v[188:191], v[24:39]
    ds_read_b128 v[156:159], v111 offset:28672
    v_mul_f32 v236, 0xbacccccd, v236
    v_mfma_f32_32x32x16_bf16 v[40:55], v[136:139], v[188:191], v[40:55]
    ds_read_b128 v[160:163], v111 offset:29696
    v_mul_f32 v237, 0x3acccccd, v237
    s_waitcnt vmcnt(10)
    v_mfma_f32_32x32x16_bf16 v[56:71], v[128:131], v[192:195], v[56:71]
    buffer_load_dwordx4 v[172:175], v125, s[20:23], s31 offen offset:1024 sc1
    v_fma_f32 v237, -v236, v236, v237
    v_mfma_f32_32x32x16_bf16 v[72:87], v[132:135], v[192:195], v[72:87]
    buffer_load_dwordx4 v[176:179], v125, s[20:23], s29 offen offset:1024 sc1
    v_max_f32 v237, 0, v237
    v_mfma_f32_32x32x16_bf16 v[88:103], v[136:139], v[192:195], v[88:103]
    v_add_f32 v238, 0x3727c5ac, v237
    s_waitcnt vmcnt(11) lgkmcnt(3)
    v_mfma_f32_32x32x16_bf16 v[8:23], v[140:143], v[196:199], v[8:23]
    ds_read_b128 v[128:131], v111 offset:30720
    v_rsq_f32 v237, v238
    v_mfma_f32_32x32x16_bf16 v[24:39], v[144:147], v[196:199], v[24:39]
    ds_read_b128 v[132:135], v111 offset:31744
    s_mov_b32 s11, 0x03020302
    v_mfma_f32_32x32x16_bf16 v[40:55], v[148:151], v[196:199], v[40:55]
    ds_read_b128 v[136:139], v111 offset:32768
    v_and_b32 v5, 0xffff0000, v236
    s_waitcnt vmcnt(10)
    v_mfma_f32_32x32x16_bf16 v[56:71], v[140:143], v[200:203], v[56:71]
    buffer_load_dwordx4 v[180:183], v125, s[20:23], s31 offen offset:2048 sc1
    v_sub_f32 v5, v236, v5
    v_mfma_f32_32x32x16_bf16 v[72:87], v[144:147], v[200:203], v[72:87]
    buffer_load_dwordx4 v[184:187], v125, s[20:23], s29 offen offset:2048 sc1
    v_perm_b32 v242, v236, v236, s11
    v_mfma_f32_32x32x16_bf16 v[88:103], v[148:151], v[200:203], v[88:103]
    v_perm_b32 v243, v5, v5, s11
    s_waitcnt vmcnt(11) lgkmcnt(3)
    v_mfma_f32_32x32x16_bf16 v[8:23], v[152:155], v[204:207], v[8:23]
    ds_read_b128 v[140:143], v111 offset:33792
    v_mul_f32 v240, 0xc0135761, v237
    v_mfma_f32_32x32x16_bf16 v[24:39], v[156:159], v[204:207], v[24:39]
    ds_read_b128 v[144:147], v111 offset:34816
    v_mul_f32 v241, v237, v237
    v_mfma_f32_32x32x16_bf16 v[40:55], v[160:163], v[204:207], v[40:55]
    ds_read_b128 v[148:151], v111 offset:35840
    v_mul_f32 v241, v241, v237
    s_waitcnt vmcnt(10)
    v_mfma_f32_32x32x16_bf16 v[56:71], v[152:155], v[208:211], v[56:71]
    buffer_load_dwordx4 v[188:191], v125, s[20:23], s31 offen offset:3072 sc1
    v_mul_f32 v241, 0xbdd2d3e8, v241
    v_mfma_f32_32x32x16_bf16 v[72:87], v[156:159], v[208:211], v[72:87]
    buffer_load_dwordx4 v[192:195], v125, s[20:23], s29 offen offset:3072 sc1
    s_add_u32 s31, s31, 4096
    s_add_u32 s29, s29, 4096
    v_and_b32 v5, 15, v2
    v_mfma_f32_32x32x16_bf16 v[88:103], v[160:163], v[208:211], v[88:103]
    v_lshlrev_b32 v5, 4, v5
    s_waitcnt vmcnt(11) lgkmcnt(3)
    v_mfma_f32_32x32x16_bf16 v[8:23], v[128:131], v[212:215], v[8:23]
    ds_read_b128 v[152:155], v111 offset:36864
    v_lshl_add_u32 v5, v4, 8, v5
    v_mfma_f32_32x32x16_bf16 v[24:39], v[132:135], v[212:215], v[24:39]
    ds_read_b128 v[156:159], v111 offset:37888
    v_bfe_u32 v6, v2, 4, 1
    v_mfma_f32_32x32x16_bf16 v[40:55], v[136:139], v[212:215], v[40:55]
    ds_read_b128 v[160:163], v111 offset:38912
    v_mul_u32_u24 v6, 49152, v6
    s_waitcnt vmcnt(10)
    v_mfma_f32_32x32x16_bf16 v[56:71], v[128:131], v[216:219], v[56:71]
    buffer_load_dwordx4 v[196:199], v125, s[20:23], s31 offen offset:0 sc1
    v_add_u32 v110, v5, v6
    v_mfma_f32_32x32x16_bf16 v[72:87], v[132:135], v[216:219], v[72:87]
    buffer_load_dwordx4 v[200:203], v125, s[20:23], s29 offen offset:0 sc1
    s_mul_i32 s46, s24, 196608
    v_mfma_f32_32x32x16_bf16 v[88:103], v[136:139], v[216:219], v[88:103]
    s_mul_i32 s11, s26, 1536
    s_waitcnt vmcnt(11) lgkmcnt(3)
    v_mfma_f32_32x32x16_bf16 v[8:23], v[140:143], v[220:223], v[8:23]
    ds_read_b128 v[128:131], v111 offset:39936
    s_add_u32 s46, s46, s11
    v_mfma_f32_32x32x16_bf16 v[24:39], v[144:147], v[220:223], v[24:39]
    ds_read_b128 v[132:135], v111 offset:40960
    s_add_u32 s46, s46, 0
    v_mfma_f32_32x32x16_bf16 v[40:55], v[148:151], v[220:223], v[40:55]
    ds_read_b128 v[136:139], v111 offset:41984
    s_add_u32 s46, s46, s52
    s_waitcnt vmcnt(10)
    v_mfma_f32_32x32x16_bf16 v[56:71], v[140:143], v[224:227], v[56:71]
    buffer_load_dwordx4 v[204:207], v125, s[20:23], s31 offen offset:1024 sc1
    s_add_u32 s47, s46, 98304
    v_mfma_f32_32x32x16_bf16 v[72:87], v[144:147], v[224:227], v[72:87]
    buffer_load_dwordx4 v[208:211], v125, s[20:23], s29 offen offset:1024 sc1
    v_mfma_f32_32x32x16_bf16 v[88:103], v[148:151], v[224:227], v[88:103]
    s_waitcnt vmcnt(11) lgkmcnt(3)
    v_mfma_f32_32x32x16_bf16 v[8:23], v[152:155], v[164:167], v[8:23]
    ds_read_b128 v[140:143], v111 offset:43008
    v_mfma_f32_32x32x16_bf16 v[24:39], v[156:159], v[164:167], v[24:39]
    ds_read_b128 v[144:147], v111 offset:44032
    v_mfma_f32_32x32x16_bf16 v[40:55], v[160:163], v[164:167], v[40:55]
    ds_read_b128 v[148:151], v111 offset:45056
    s_waitcnt vmcnt(10)
    v_mfma_f32_32x32x16_bf16 v[56:71], v[152:155], v[168:171], v[56:71]
    buffer_load_dwordx4 v[212:215], v125, s[20:23], s31 offen offset:2048 sc1
    v_mfma_f32_32x32x16_bf16 v[72:87], v[156:159], v[168:171], v[72:87]
    buffer_load_dwordx4 v[216:219], v125, s[20:23], s29 offen offset:2048 sc1
    v_mfma_f32_32x32x16_bf16 v[88:103], v[160:163], v[168:171], v[88:103]
    s_waitcnt vmcnt(11) lgkmcnt(3)
    v_mfma_f32_32x32x16_bf16 v[8:23], v[128:131], v[172:175], v[8:23]
    ds_read_b128 v[152:155], v111 offset:46080
    v_mfma_f32_32x32x16_bf16 v[24:39], v[132:135], v[172:175], v[24:39]
    ds_read_b128 v[156:159], v111 offset:47104
    v_mfma_f32_32x32x16_bf16 v[40:55], v[136:139], v[172:175], v[40:55]
    ds_read_b128 v[160:163], v111 offset:48128
    s_waitcnt vmcnt(10)
    v_mfma_f32_32x32x16_bf16 v[56:71], v[128:131], v[176:179], v[56:71]
    buffer_load_dwordx4 v[220:223], v125, s[20:23], s31 offen offset:3072 sc1
    v_mfma_f32_32x32x16_bf16 v[72:87], v[132:135], v[176:179], v[72:87]
    buffer_load_dwordx4 v[224:227], v125, s[20:23], s29 offen offset:3072 sc1
    s_add_u32 s31, s31, 4096
    s_add_u32 s29, s29, 4096
    v_mfma_f32_32x32x16_bf16 v[88:103], v[136:139], v[176:179], v[88:103]
    s_waitcnt vmcnt(11) lgkmcnt(3)
    v_mfma_f32_32x32x16_bf16 v[8:23], v[140:143], v[180:183], v[8:23]
    ds_read_b128 v[128:131], v111 offset:49152
    v_mfma_f32_32x32x16_bf16 v[24:39], v[144:147], v[180:183], v[24:39]
    ds_read_b128 v[132:135], v111 offset:50176
    v_mfma_f32_32x32x16_bf16 v[40:55], v[148:151], v[180:183], v[40:55]
    ds_read_b128 v[136:139], v111 offset:51200
    s_waitcnt vmcnt(10)
    v_mfma_f32_32x32x16_bf16 v[56:71], v[140:143], v[184:187], v[56:71]
    v_mfma_f32_32x32x16_bf16 v[72:87], v[144:147], v[184:187], v[72:87]
    v_mfma_f32_32x32x16_bf16 v[88:103], v[148:151], v[184:187], v[88:103]
    s_waitcnt vmcnt(9) lgkmcnt(3)
    v_mfma_f32_32x32x16_bf16 v[8:23], v[152:155], v[188:191], v[8:23]
    ds_read_b128 v[140:143], v111 offset:52224
    v_mfma_f32_32x32x16_bf16 v[24:39], v[156:159], v[188:191], v[24:39]
    ds_read_b128 v[144:147], v111 offset:53248
    v_mfma_f32_32x32x16_bf16 v[40:55], v[160:163], v[188:191], v[40:55]
    ds_read_b128 v[148:151], v111 offset:54272
    s_waitcnt vmcnt(8)
    v_mfma_f32_32x32x16_bf16 v[56:71], v[152:155], v[192:195], v[56:71]
    v_mfma_f32_32x32x16_bf16 v[72:87], v[156:159], v[192:195], v[72:87]
    v_mfma_f32_32x32x16_bf16 v[88:103], v[160:163], v[192:195], v[88:103]
    s_waitcnt vmcnt(7) lgkmcnt(3)
    v_mfma_f32_32x32x16_bf16 v[8:23], v[128:131], v[196:199], v[8:23]
    ds_read_b128 v[152:155], v111 offset:55296
    v_mfma_f32_32x32x16_bf16 v[24:39], v[132:135], v[196:199], v[24:39]
    ds_read_b128 v[156:159], v111 offset:56320
    v_mfma_f32_32x32x16_bf16 v[40:55], v[136:139], v[196:199], v[40:55]
    ds_read_b128 v[160:163], v111 offset:57344
    s_waitcnt vmcnt(6)
    v_mfma_f32_32x32x16_bf16 v[56:71], v[128:131], v[200:203], v[56:71]
    v_mfma_f32_32x32x16_bf16 v[72:87], v[132:135], v[200:203], v[72:87]
    v_mfma_f32_32x32x16_bf16 v[88:103], v[136:139], v[200:203], v[88:103]
    v_mfma_f32_32x32x8_bf16 v[8:23], v[104:105], v[234:235], v[8:23]
    v_mfma_f32_32x32x8_bf16 v[24:39], v[106:107], v[234:235], v[24:39]
    v_mfma_f32_32x32x8_bf16 v[40:55], v[108:109], v[234:235], v[40:55]
    v_mfma_f32_32x32x8_bf16 v[56:71], v[104:105], v[242:243], v[56:71]
    v_mfma_f32_32x32x8_bf16 v[72:87], v[106:107], v[242:243], v[72:87]
    v_mfma_f32_32x32x8_bf16 v[88:103], v[108:109], v[242:243], v[88:103]
    s_waitcnt vmcnt(5) lgkmcnt(3)
    v_mfma_f32_32x32x16_bf16 v[8:23], v[140:143], v[204:207], v[8:23]
    ds_read_b128 v[128:131], v111 offset:58368
    v_mfma_f32_32x32x16_bf16 v[24:39], v[144:147], v[204:207], v[24:39]
    ds_read_b128 v[132:135], v111 offset:59392
    v_mfma_f32_32x32x16_bf16 v[40:55], v[148:151], v[204:207], v[40:55]
    ds_read_b128 v[136:139], v111 offset:60416
    s_waitcnt vmcnt(4)
    v_mfma_f32_32x32x16_bf16 v[56:71], v[140:143], v[208:211], v[56:71]
    v_mfma_f32_32x32x16_bf16 v[72:87], v[144:147], v[208:211], v[72:87]
    v_mfma_f32_32x32x16_bf16 v[88:103], v[148:151], v[208:211], v[88:103]
    s_waitcnt vmcnt(3) lgkmcnt(3)
    v_mfma_f32_32x32x16_bf16 v[8:23], v[152:155], v[212:215], v[8:23]
    v_mfma_f32_32x32x16_bf16 v[24:39], v[156:159], v[212:215], v[24:39]
    v_mfma_f32_32x32x16_bf16 v[40:55], v[160:163], v[212:215], v[40:55]
    s_waitcnt vmcnt(2)
    v_mfma_f32_32x32x16_bf16 v[56:71], v[152:155], v[216:219], v[56:71]
    v_mfma_f32_32x32x16_bf16 v[72:87], v[156:159], v[216:219], v[72:87]
    v_mfma_f32_32x32x16_bf16 v[88:103], v[160:163], v[216:219], v[88:103]
    s_waitcnt vmcnt(1) lgkmcnt(0)
    v_mfma_f32_32x32x16_bf16 v[8:23], v[128:131], v[220:223], v[8:23]
    v_mfma_f32_32x32x16_bf16 v[24:39], v[132:135], v[220:223], v[24:39]
    v_mfma_f32_32x32x16_bf16 v[40:55], v[136:139], v[220:223], v[40:55]
    s_waitcnt vmcnt(0)
    v_mfma_f32_32x32x16_bf16 v[56:71], v[128:131], v[224:227], v[56:71]
    v_mfma_f32_32x32x16_bf16 v[72:87], v[132:135], v[224:227], v[72:87]
    v_mfma_f32_32x32x16_bf16 v[88:103], v[136:139], v[224:227], v[88:103]
    s_barrier
    s_nop 6
    v_pk_mul_f32 v[128:129], v[8:9], v[8:9]
    v_pk_mul_f32 v[130:131], v[10:11], v[10:11]
    v_pk_mul_f32 v[132:133], v[12:13], v[12:13]
    v_pk_mul_f32 v[134:135], v[14:15], v[14:15]
    v_pk_fma_f32 v[128:129], v[128:129], v[232:233], v[232:233] op_sel:[0,1,0] op_sel_hi:[1,1,0]
    v_pk_fma_f32 v[130:131], v[130:131], v[232:233], v[232:233] op_sel:[0,1,0] op_sel_hi:[1,1,0]
    v_pk_fma_f32 v[132:133], v[132:133], v[232:233], v[232:233] op_sel:[0,1,0] op_sel_hi:[1,1,0]
    v_pk_fma_f32 v[134:135], v[134:135], v[232:233], v[232:233] op_sel:[0,1,0] op_sel_hi:[1,1,0]
    v_pk_mul_f32 v[128:129], v[128:129], v[8:9]
    v_pk_mul_f32 v[130:131], v[130:131], v[10:11]
    v_pk_mul_f32 v[132:133], v[132:133], v[12:13]
    v_pk_mul_f32 v[134:135], v[134:135], v[14:15]
    v_exp_f32 v128, v128
    v_exp_f32 v129, v129
    v_exp_f32 v130, v130
    v_exp_f32 v131, v131
    v_exp_f32 v132, v132
    v_exp_f32 v133, v133
    v_exp_f32 v134, v134
    v_exp_f32 v135, v135
    v_pk_mul_f32 v[8:9], v[8:9], v[16:17]
    v_pk_mul_f32 v[10:11], v[10:11], v[18:19]
    v_pk_mul_f32 v[12:13], v[12:13], v[20:21]
    v_pk_mul_f32 v[14:15], v[14:15], v[22:23]
    v_pk_fma_f32 v[128:129], v[128:129], v[230:231], v[230:231] op_sel_hi:[1,0,0]
    v_pk_fma_f32 v[130:131], v[130:131], v[230:231], v[230:231] op_sel_hi:[1,0,0]
    v_pk_fma_f32 v[132:133], v[132:133], v[230:231], v[230:231] op_sel_hi:[1,0,0]
    v_pk_fma_f32 v[134:135], v[134:135], v[230:231], v[230:231] op_sel_hi:[1,0,0]
    v_rcp_f32 v128, v128
    v_rcp_f32 v129, v129
    v_rcp_f32 v130, v130
    v_rcp_f32 v131, v131
    v_rcp_f32 v132, v132
    v_rcp_f32 v133, v133
    v_rcp_f32 v134, v134
    v_rcp_f32 v135, v135
    s_nop 0
    v_pk_mul_f32 v[8:9], v[8:9], v[128:129]
    v_pk_mul_f32 v[10:11], v[10:11], v[130:131]
    v_pk_mul_f32 v[12:13], v[12:13], v[132:133]
    v_pk_mul_f32 v[14:15], v[14:15], v[134:135]
    v_cvt_pk_bf16_f32 v16, v8, v9
    v_cvt_pk_bf16_f32 v17, v10, v11
    v_cvt_pk_bf16_f32 v18, v12, v13
    v_cvt_pk_bf16_f32 v19, v14, v15
    buffer_store_dwordx4 v[16:19], v110, s[20:23], s46 offen offset:0
    v_pk_mul_f32 v[128:129], v[24:25], v[24:25]
    v_pk_mul_f32 v[130:131], v[26:27], v[26:27]
    v_pk_mul_f32 v[132:133], v[28:29], v[28:29]
    v_pk_mul_f32 v[134:135], v[30:31], v[30:31]
    v_pk_fma_f32 v[128:129], v[128:129], v[232:233], v[232:233] op_sel:[0,1,0] op_sel_hi:[1,1,0]
    v_pk_fma_f32 v[130:131], v[130:131], v[232:233], v[232:233] op_sel:[0,1,0] op_sel_hi:[1,1,0]
    v_pk_fma_f32 v[132:133], v[132:133], v[232:233], v[232:233] op_sel:[0,1,0] op_sel_hi:[1,1,0]
    v_pk_fma_f32 v[134:135], v[134:135], v[232:233], v[232:233] op_sel:[0,1,0] op_sel_hi:[1,1,0]
    v_pk_mul_f32 v[128:129], v[128:129], v[24:25]
    v_pk_mul_f32 v[130:131], v[130:131], v[26:27]
    v_pk_mul_f32 v[132:133], v[132:133], v[28:29]
    v_pk_mul_f32 v[134:135], v[134:135], v[30:31]
    v_exp_f32 v128, v128
    v_exp_f32 v129, v129
    v_exp_f32 v130, v130
    v_exp_f32 v131, v131
    v_exp_f32 v132, v132
    v_exp_f32 v133, v133
    v_exp_f32 v134, v134
    v_exp_f32 v135, v135
    v_pk_mul_f32 v[24:25], v[24:25], v[32:33]
    v_pk_mul_f32 v[26:27], v[26:27], v[34:35]
    v_pk_mul_f32 v[28:29], v[28:29], v[36:37]
    v_pk_mul_f32 v[30:31], v[30:31], v[38:39]
    v_pk_fma_f32 v[128:129], v[128:129], v[230:231], v[230:231] op_sel_hi:[1,0,0]
    v_pk_fma_f32 v[130:131], v[130:131], v[230:231], v[230:231] op_sel_hi:[1,0,0]
    v_pk_fma_f32 v[132:133], v[132:133], v[230:231], v[230:231] op_sel_hi:[1,0,0]
    v_pk_fma_f32 v[134:135], v[134:135], v[230:231], v[230:231] op_sel_hi:[1,0,0]
    v_rcp_f32 v128, v128
    v_rcp_f32 v129, v129
    v_rcp_f32 v130, v130
    v_rcp_f32 v131, v131
    v_rcp_f32 v132, v132
    v_rcp_f32 v133, v133
    v_rcp_f32 v134, v134
    v_rcp_f32 v135, v135
    s_nop 0
    v_pk_mul_f32 v[24:25], v[24:25], v[128:129]
    v_pk_mul_f32 v[26:27], v[26:27], v[130:131]
    v_pk_mul_f32 v[28:29], v[28:29], v[132:133]
    v_pk_mul_f32 v[30:31], v[30:31], v[134:135]
    v_cvt_pk_bf16_f32 v32, v24, v25
    v_cvt_pk_bf16_f32 v33, v26, v27
    v_cvt_pk_bf16_f32 v34, v28, v29
    v_cvt_pk_bf16_f32 v35, v30, v31
    buffer_store_dwordx4 v[32:35], v110, s[20:23], s46 offen offset:512
    v_pk_mul_f32 v[128:129], v[40:41], v[40:41]
    v_pk_mul_f32 v[130:131], v[42:43], v[42:43]
    v_pk_mul_f32 v[132:133], v[44:45], v[44:45]
    v_pk_mul_f32 v[134:135], v[46:47], v[46:47]
    v_pk_fma_f32 v[128:129], v[128:129], v[232:233], v[232:233] op_sel:[0,1,0] op_sel_hi:[1,1,0]
    v_pk_fma_f32 v[130:131], v[130:131], v[232:233], v[232:233] op_sel:[0,1,0] op_sel_hi:[1,1,0]
    v_pk_fma_f32 v[132:133], v[132:133], v[232:233], v[232:233] op_sel:[0,1,0] op_sel_hi:[1,1,0]
    v_pk_fma_f32 v[134:135], v[134:135], v[232:233], v[232:233] op_sel:[0,1,0] op_sel_hi:[1,1,0]
    v_pk_mul_f32 v[128:129], v[128:129], v[40:41]
    v_pk_mul_f32 v[130:131], v[130:131], v[42:43]
    v_pk_mul_f32 v[132:133], v[132:133], v[44:45]
    v_pk_mul_f32 v[134:135], v[134:135], v[46:47]
    v_exp_f32 v128, v128
    v_exp_f32 v129, v129
    v_exp_f32 v130, v130
    v_exp_f32 v131, v131
    v_exp_f32 v132, v132
    v_exp_f32 v133, v133
    v_exp_f32 v134, v134
    v_exp_f32 v135, v135
    v_pk_mul_f32 v[40:41], v[40:41], v[48:49]
    v_pk_mul_f32 v[42:43], v[42:43], v[50:51]
    v_pk_mul_f32 v[44:45], v[44:45], v[52:53]
    v_pk_mul_f32 v[46:47], v[46:47], v[54:55]
    v_pk_fma_f32 v[128:129], v[128:129], v[230:231], v[230:231] op_sel_hi:[1,0,0]
    v_pk_fma_f32 v[130:131], v[130:131], v[230:231], v[230:231] op_sel_hi:[1,0,0]
    v_pk_fma_f32 v[132:133], v[132:133], v[230:231], v[230:231] op_sel_hi:[1,0,0]
    v_pk_fma_f32 v[134:135], v[134:135], v[230:231], v[230:231] op_sel_hi:[1,0,0]
    v_rcp_f32 v128, v128
    v_rcp_f32 v129, v129
    v_rcp_f32 v130, v130
    v_rcp_f32 v131, v131
    v_rcp_f32 v132, v132
    v_rcp_f32 v133, v133
    v_rcp_f32 v134, v134
    v_rcp_f32 v135, v135
    s_nop 0
    v_pk_mul_f32 v[40:41], v[40:41], v[128:129]
    v_pk_mul_f32 v[42:43], v[42:43], v[130:131]
    v_pk_mul_f32 v[44:45], v[44:45], v[132:133]
    v_pk_mul_f32 v[46:47], v[46:47], v[134:135]
    v_cvt_pk_bf16_f32 v48, v40, v41
    v_cvt_pk_bf16_f32 v49, v42, v43
    v_cvt_pk_bf16_f32 v50, v44, v45
    v_cvt_pk_bf16_f32 v51, v46, v47
    buffer_store_dwordx4 v[48:51], v110, s[20:23], s46 offen offset:1024
    v_pk_mul_f32 v[128:129], v[56:57], v[56:57]
    v_pk_mul_f32 v[130:131], v[58:59], v[58:59]
    v_pk_mul_f32 v[132:133], v[60:61], v[60:61]
    v_pk_mul_f32 v[134:135], v[62:63], v[62:63]
    v_pk_fma_f32 v[128:129], v[128:129], v[240:241], v[240:241] op_sel:[0,1,0] op_sel_hi:[1,1,0]
    v_pk_fma_f32 v[130:131], v[130:131], v[240:241], v[240:241] op_sel:[0,1,0] op_sel_hi:[1,1,0]
    v_pk_fma_f32 v[132:133], v[132:133], v[240:241], v[240:241] op_sel:[0,1,0] op_sel_hi:[1,1,0]
    v_pk_fma_f32 v[134:135], v[134:135], v[240:241], v[240:241] op_sel:[0,1,0] op_sel_hi:[1,1,0]
    v_pk_mul_f32 v[128:129], v[128:129], v[56:57]
    v_pk_mul_f32 v[130:131], v[130:131], v[58:59]
    v_pk_mul_f32 v[132:133], v[132:133], v[60:61]
    v_pk_mul_f32 v[134:135], v[134:135], v[62:63]
    v_exp_f32 v128, v128
    v_exp_f32 v129, v129
    v_exp_f32 v130, v130
    v_exp_f32 v131, v131
    v_exp_f32 v132, v132
    v_exp_f32 v133, v133
    v_exp_f32 v134, v134
    v_exp_f32 v135, v135
    v_pk_mul_f32 v[56:57], v[56:57], v[64:65]
    v_pk_mul_f32 v[58:59], v[58:59], v[66:67]
    v_pk_mul_f32 v[60:61], v[60:61], v[68:69]
    v_pk_mul_f32 v[62:63], v[62:63], v[70:71]
    v_pk_fma_f32 v[128:129], v[128:129], v[238:239], v[238:239] op_sel_hi:[1,0,0]
    v_pk_fma_f32 v[130:131], v[130:131], v[238:239], v[238:239] op_sel_hi:[1,0,0]
    v_pk_fma_f32 v[132:133], v[132:133], v[238:239], v[238:239] op_sel_hi:[1,0,0]
    v_pk_fma_f32 v[134:135], v[134:135], v[238:239], v[238:239] op_sel_hi:[1,0,0]
    v_rcp_f32 v128, v128
    v_rcp_f32 v129, v129
    v_rcp_f32 v130, v130
    v_rcp_f32 v131, v131
    v_rcp_f32 v132, v132
    v_rcp_f32 v133, v133
    v_rcp_f32 v134, v134
    v_rcp_f32 v135, v135
    s_nop 0
    v_pk_mul_f32 v[56:57], v[56:57], v[128:129]
    v_pk_mul_f32 v[58:59], v[58:59], v[130:131]
    v_pk_mul_f32 v[60:61], v[60:61], v[132:133]
    v_pk_mul_f32 v[62:63], v[62:63], v[134:135]
    v_cvt_pk_bf16_f32 v64, v56, v57
    v_cvt_pk_bf16_f32 v65, v58, v59
    v_cvt_pk_bf16_f32 v66, v60, v61
    v_cvt_pk_bf16_f32 v67, v62, v63
    buffer_store_dwordx4 v[64:67], v110, s[20:23], s47 offen offset:0
    v_pk_mul_f32 v[128:129], v[72:73], v[72:73]
    v_pk_mul_f32 v[130:131], v[74:75], v[74:75]
    v_pk_mul_f32 v[132:133], v[76:77], v[76:77]
    v_pk_mul_f32 v[134:135], v[78:79], v[78:79]
    v_pk_fma_f32 v[128:129], v[128:129], v[240:241], v[240:241] op_sel:[0,1,0] op_sel_hi:[1,1,0]
    v_pk_fma_f32 v[130:131], v[130:131], v[240:241], v[240:241] op_sel:[0,1,0] op_sel_hi:[1,1,0]
    v_pk_fma_f32 v[132:133], v[132:133], v[240:241], v[240:241] op_sel:[0,1,0] op_sel_hi:[1,1,0]
    v_pk_fma_f32 v[134:135], v[134:135], v[240:241], v[240:241] op_sel:[0,1,0] op_sel_hi:[1,1,0]
    v_pk_mul_f32 v[128:129], v[128:129], v[72:73]
    v_pk_mul_f32 v[130:131], v[130:131], v[74:75]
    v_pk_mul_f32 v[132:133], v[132:133], v[76:77]
    v_pk_mul_f32 v[134:135], v[134:135], v[78:79]
    v_exp_f32 v128, v128
    v_exp_f32 v129, v129
    v_exp_f32 v130, v130
    v_exp_f32 v131, v131
    v_exp_f32 v132, v132
    v_exp_f32 v133, v133
    v_exp_f32 v134, v134
    v_exp_f32 v135, v135
    v_pk_mul_f32 v[72:73], v[72:73], v[80:81]
    v_pk_mul_f32 v[74:75], v[74:75], v[82:83]
    v_pk_mul_f32 v[76:77], v[76:77], v[84:85]
    v_pk_mul_f32 v[78:79], v[78:79], v[86:87]
    v_pk_fma_f32 v[128:129], v[128:129], v[238:239], v[238:239] op_sel_hi:[1,0,0]
    v_pk_fma_f32 v[130:131], v[130:131], v[238:239], v[238:239] op_sel_hi:[1,0,0]
    v_pk_fma_f32 v[132:133], v[132:133], v[238:239], v[238:239] op_sel_hi:[1,0,0]
    v_pk_fma_f32 v[134:135], v[134:135], v[238:239], v[238:239] op_sel_hi:[1,0,0]
    v_rcp_f32 v128, v128
    v_rcp_f32 v129, v129
    v_rcp_f32 v130, v130
    v_rcp_f32 v131, v131
    v_rcp_f32 v132, v132
    v_rcp_f32 v133, v133
    v_rcp_f32 v134, v134
    v_rcp_f32 v135, v135
    s_nop 0
    v_pk_mul_f32 v[72:73], v[72:73], v[128:129]
    v_pk_mul_f32 v[74:75], v[74:75], v[130:131]
    v_pk_mul_f32 v[76:77], v[76:77], v[132:133]
    v_pk_mul_f32 v[78:79], v[78:79], v[134:135]
    v_cvt_pk_bf16_f32 v80, v72, v73
    v_cvt_pk_bf16_f32 v81, v74, v75
    v_cvt_pk_bf16_f32 v82, v76, v77
    v_cvt_pk_bf16_f32 v83, v78, v79
    buffer_store_dwordx4 v[80:83], v110, s[20:23], s47 offen offset:512
    v_pk_mul_f32 v[128:129], v[88:89], v[88:89]
    v_pk_mul_f32 v[130:131], v[90:91], v[90:91]
    v_pk_mul_f32 v[132:133], v[92:93], v[92:93]
    v_pk_mul_f32 v[134:135], v[94:95], v[94:95]
    v_pk_fma_f32 v[128:129], v[128:129], v[240:241], v[240:241] op_sel:[0,1,0] op_sel_hi:[1,1,0]
    v_pk_fma_f32 v[130:131], v[130:131], v[240:241], v[240:241] op_sel:[0,1,0] op_sel_hi:[1,1,0]
    v_pk_fma_f32 v[132:133], v[132:133], v[240:241], v[240:241] op_sel:[0,1,0] op_sel_hi:[1,1,0]
    v_pk_fma_f32 v[134:135], v[134:135], v[240:241], v[240:241] op_sel:[0,1,0] op_sel_hi:[1,1,0]
    v_pk_mul_f32 v[128:129], v[128:129], v[88:89]
    v_pk_mul_f32 v[130:131], v[130:131], v[90:91]
    v_pk_mul_f32 v[132:133], v[132:133], v[92:93]
    v_pk_mul_f32 v[134:135], v[134:135], v[94:95]
    v_exp_f32 v128, v128
    v_exp_f32 v129, v129
    v_exp_f32 v130, v130
    v_exp_f32 v131, v131
    v_exp_f32 v132, v132
    v_exp_f32 v133, v133
    v_exp_f32 v134, v134
    v_exp_f32 v135, v135
    v_pk_mul_f32 v[88:89], v[88:89], v[96:97]
    v_pk_mul_f32 v[90:91], v[90:91], v[98:99]
    v_pk_mul_f32 v[92:93], v[92:93], v[100:101]
    v_pk_mul_f32 v[94:95], v[94:95], v[102:103]
    v_pk_fma_f32 v[128:129], v[128:129], v[238:239], v[238:239] op_sel_hi:[1,0,0]
    v_pk_fma_f32 v[130:131], v[130:131], v[238:239], v[238:239] op_sel_hi:[1,0,0]
    v_pk_fma_f32 v[132:133], v[132:133], v[238:239], v[238:239] op_sel_hi:[1,0,0]
    v_pk_fma_f32 v[134:135], v[134:135], v[238:239], v[238:239] op_sel_hi:[1,0,0]
    v_rcp_f32 v128, v128
    v_rcp_f32 v129, v129
    v_rcp_f32 v130, v130
    v_rcp_f32 v131, v131
    v_rcp_f32 v132, v132
    v_rcp_f32 v133, v133
    v_rcp_f32 v134, v134
    v_rcp_f32 v135, v135
    s_nop 0
    v_pk_mul_f32 v[88:89], v[88:89], v[128:129]
    v_pk_mul_f32 v[90:91], v[90:91], v[130:131]
    v_pk_mul_f32 v[92:93], v[92:93], v[132:133]
    v_pk_mul_f32 v[94:95], v[94:95], v[134:135]
    v_cvt_pk_bf16_f32 v96, v88, v89
    v_cvt_pk_bf16_f32 v97, v90, v91
    v_cvt_pk_bf16_f32 v98, v92, v93
    v_cvt_pk_bf16_f32 v99, v94, v95
    buffer_store_dwordx4 v[96:99], v110, s[20:23], s47 offen offset:1024
    s_mul_i32 s10, s24, 10240
    s_add_u32 s10, s10, 122880
    v_add_u32 v7, s10, v125
    s_lshl_b32 s10, s26, 3
    s_add_u32 s48, s48, s10
    s_add_u32 s48, s48, 1024
    s_mul_i32 s10, s24, 30720
    s_add_u32 s65, s65, s10
    s_add_u32 s65, s65, 20480
    ds_read_b128 v[128:131], v7 offset:0
    ds_read_b128 v[132:135], v7 offset:1024
    ds_read_b128 v[136:139], v7 offset:2048
    ds_read_b128 v[140:143], v7 offset:3072
    ds_read_b128 v[144:147], v7 offset:4096
    ds_read_b128 v[148:151], v7 offset:5120
    ds_read_b128 v[152:155], v7 offset:6144
    ds_read_b128 v[156:159], v7 offset:7168
    ds_read_b128 v[160:163], v7 offset:8192
    ds_read_b128 v[164:167], v7 offset:9216
    v_mov_b32 v6, s98
    v_mov_b32 v7, s99
    v_mov_b32 v5, 0
    s_waitcnt vmcnt(0)
    s_mov_b64 exec, 1
    s_cmp_lg_u32 s54, 0
    s_cbranch_scc1 F_g3_slow
    buffer_store_dwordx2 v[6:7], v5, s[20:23], s48 offen
    s_branch F_g3_p0
F_g3_slow:
    buffer_wbl2 sc1
    s_waitcnt vmcnt(0)
    buffer_store_dwordx2 v[6:7], v5, s[20:23], s48 offen sc0 sc1
F_g3_p0:
    s_mov_b64 exec, -1
    v_mov_b32 v8, 0
    v_mov_b32 v9, 0
    v_mov_b32 v10, 0
    v_mov_b32 v11, 0
    v_mov_b32 v12, 0
    v_mov_b32 v13, 0
    v_mov_b32 v14, 0
    v_mov_b32 v15, 0
    v_mov_b32 v16, 0
    v_mov_b32 v17, 0
    v_mov_b32 v18, 0
    v_mov_b32 v19, 0
    v_mov_b32 v20, 0
    v_mov_b32 v21, 0
    v_mov_b32 v22, 0
    v_mov_b32 v23, 0
    v_mov_b32 v24, 0
    v_mov_b32 v25, 0
    v_mov_b32 v26, 0
    v_mov_b32 v27, 0
    s_add_u32 s10, s58, 0
    s_and_b32 s10, s10, 3
    s_mul_i32 s44, s10, 5120
    s_lshl_b32 s11, s56, 2
    s_add_u32 s10, s10, s11
    s_mul_i32 s10, s10, 49152
    s_mul_i32 s11, s24, 6144
    s_add_u32 s10, s10, s11
    s_add_u32 s28, s10, s52
    s_add_u32 s10, s58, 1
    s_and_b32 s10, s10, 3
    s_mul_i32 s45, s10, 5120
    s_lshl_b32 s11, s56, 2
    s_add_u32 s10, s10, s11
    s_mul_i32 s10, s10, 49152
    s_mul_i32 s11, s24, 6144
    s_add_u32 s10, s10, s11
    s_add_u32 s29, s10, s52
    s_add_u32 s10, s58, 2
    s_and_b32 s10, s10, 3
    s_mul_i32 s46, s10, 5120
    s_lshl_b32 s11, s56, 2
    s_add_u32 s10, s10, s11
    s_mul_i32 s10, s10, 49152
    s_mul_i32 s11, s24, 6144
    s_add_u32 s10, s10, s11
    s_add_u32 s30, s10, s52
    s_add_u32 s10, s58, 3
    s_and_b32 s10, s10, 3
    s_mul_i32 s47, s10, 5120
    s_lshl_b32 s11, s56, 2
    s_add_u32 s10, s10, s11
    s_mul_i32 s10, s10, 49152
    s_mul_i32 s11, s24, 6144
    s_add_u32 s10, s10, s11
    s_add_u32 s31, s10, s52
    v_and_b32 v7, 15, v2
    v_mul_u32_u24 v7, 320, v7
    v_lshrrev_b32 v5, 4, v2
    v_bfe_u32 v6, v2, 1, 2
    v_xor_b32 v5, v5, v6
    v_lshl_add_u32 v7, v5, 4, v7
    s_mul_i32 s10, s24, 20480
    v_add_u32 v7, s10, v7
    v_add_u32 v248, s44, v7
    v_add_u32 v249, s45, v7
    v_add_u32 v250, s46, v7
    v_add_u32 v251, s47, v7
    v_add_u32 v5, 0, v0
    v_mul_u32_u24 v6, 3277, v5
    v_lshrrev_b32 v6, 16, v6
    v_mul_u32_u24 v7, 20, v6
    v_sub_u32 v5, v5, v7
    v_bfe_u32 v1, v6, 1, 2
    v_xor_b32 v1, v1, v5
    v_mul_u32_u24 v7, 320, v6
    v_lshl_add_u32 v252, v1, 4, v7
    v_mul_u32_u24 v7, 1280, v6
    v_lshl_add_u32 v121, v5, 3, v7
    v_add_u32 v5, 512, v0
    v_mul_u32_u24 v6, 3277, v5
    v_lshrrev_b32 v6, 16, v6
    v_mul_u32_u24 v7, 20, v6
    v_sub_u32 v5, v5, v7
    v_bfe_u32 v1, v6, 1, 2
    v_xor_b32 v1, v1, v5
    v_mul_u32_u24 v7, 320, v6
    v_lshl_add_u32 v253, v1, 4, v7
    v_mul_u32_u24 v7, 1280, v6
    v_lshl_add_u32 v122, v5, 3, v7
    v_add_u32 v5, 1024, v0
    v_mul_u32_u24 v6, 3277, v5
    v_lshrrev_b32 v6, 16, v6
    v_mul_u32_u24 v7, 20, v6
    v_sub_u32 v5, v5, v7
    v_bfe_u32 v1, v6, 1, 2
    v_xor_b32 v1, v1, v5
    v_mul_u32_u24 v7, 320, v6
    v_lshl_add_u32 v254, v1, 4, v7
    v_mul_u32_u24 v7, 1280, v6
    v_lshl_add_u32 v123, v5, 3, v7
    s_mul_i32 s10, s24, 20480
    v_add_u32 v7, s10, v125
    s_waitcnt lgkmcnt(0)
    s_barrier
    ds_read_b128 v[168:171], v7 offset:0
    ds_read_b128 v[172:175], v7 offset:1024
    ds_read_b128 v[176:179], v7 offset:2048
    ds_read_b128 v[180:183], v7 offset:3072
    ds_read_b128 v[184:187], v7 offset:4096
    ds_read_b128 v[188:191], v7 offset:5120
    ds_read_b128 v[192:195], v7 offset:6144
    ds_read_b128 v[196:199], v7 offset:7168
    ds_read_b128 v[200:203], v7 offset:8192
    ds_read_b128 v[204:207], v7 offset:9216
    ds_read_b128 v[208:211], v7 offset:10240
    ds_read_b128 v[212:215], v7 offset:11264
    ds_read_b128 v[216:219], v7 offset:12288
    ds_read_b128 v[220:223], v7 offset:13312
    ds_read_b128 v[224:227], v7 offset:14336
    ds_read_b128 v[228:231], v7 offset:15360
    ds_read_b128 v[232:235], v7 offset:16384
    ds_read_b128 v[236:239], v7 offset:17408
    ds_read_b128 v[240:243], v7 offset:18432
    ds_read_b128 v[244:247], v7 offset:19456
    s_branch F_e
F_cb:
    s_barrier
    ds_read_b128 v[68:71], v1 offset:0
    ds_read_b128 v[72:75], v1 offset:1024
    ds_read_b128 v[76:79], v1 offset:2048
    ds_read_b128 v[80:83], v1 offset:3072
    ds_read_b128 v[84:87], v1 offset:4096
    s_waitcnt vmcnt(1) lgkmcnt(10)
    v_mfma_f32_16x16x32_bf16 v[8:11], v[28:31], v[100:103], v[8:11]
    v_mfma_f32_16x16x32_bf16 v[12:15], v[32:35], v[100:103], v[12:15]
    v_mfma_f32_16x16x32_bf16 v[16:19], v[36:39], v[100:103], v[16:19]
    v_mfma_f32_16x16x32_bf16 v[20:23], v[40:43], v[100:103], v[20:23]
    v_mfma_f32_16x16x32_bf16 v[24:27], v[44:47], v[100:103], v[24:27]
    s_waitcnt vmcnt(0) lgkmcnt(5)
    v_mfma_f32_16x16x32_bf16 v[8:11], v[48:51], v[104:107], v[8:11]
    v_mfma_f32_16x16x32_bf16 v[12:15], v[52:55], v[104:107], v[12:15]
    v_mfma_f32_16x16x32_bf16 v[16:19], v[56:59], v[104:107], v[16:19]
    v_mfma_f32_16x16x32_bf16 v[20:23], v[60:63], v[104:107], v[20:23]
    v_mfma_f32_16x16x32_bf16 v[24:27], v[64:67], v[104:107], v[24:27]
    s_barrier
    s_lshr_b32 s10, s66, 1
    s_mul_i32 s10, s10, 40
    s_mul_i32 s11, s57, 5
    s_add_u32 s10, s10, s11
    s_lshl_b32 s10, s10, 10
    s_add_u32 s10, s10, 786432
    s_add_u32 s10, s10, s52
    s_and_b32 s11, s66, 1
    s_lshl_b32 s11, s11, 8
    s_add_u32 s10, s10, s11
    s_add_u32 s11, s10, 4096
    v_and_b32 v5, 15, v2
    v_lshlrev_b32 v7, 4, v5
    v_lshl_add_u32 v7, v4, 9, v7
    v_bfe_u32 v6, v2, 4, 1
    v_lshl_add_u32 v7, v6, 3, v7
    s_waitcnt lgkmcnt(0)
    v_pk_add_f32 v[8:9], v[8:9], v[68:69]
    v_pk_add_f32 v[10:11], v[10:11], v[70:71]
    v_cvt_pk_bf16_f32 v110, v8, v9
    v_cvt_pk_bf16_f32 v111, v10, v11
    buffer_store_dwordx2 v[110:111], v7, s[20:23], s10 offen offset:0
    v_pk_add_f32 v[12:13], v[12:13], v[72:73]
    v_pk_add_f32 v[14:15], v[14:15], v[74:75]
    v_cvt_pk_bf16_f32 v112, v12, v13
    v_cvt_pk_bf16_f32 v113, v14, v15
    buffer_store_dwordx2 v[112:113], v7, s[20:23], s10 offen offset:1024
    v_pk_add_f32 v[16:17], v[16:17], v[76:77]
    v_pk_add_f32 v[18:19], v[18:19], v[78:79]
    v_cvt_pk_bf16_f32 v114, v16, v17
    v_cvt_pk_bf16_f32 v115, v18, v19
    buffer_store_dwordx2 v[114:115], v7, s[20:23], s10 offen offset:2048
    v_pk_add_f32 v[20:21], v[20:21], v[80:81]
    v_pk_add_f32 v[22:23], v[22:23], v[82:83]
    v_cvt_pk_bf16_f32 v116, v20, v21
    v_cvt_pk_bf16_f32 v117, v22, v23
    buffer_store_dwordx2 v[116:117], v7, s[20:23], s10 offen offset:3072
    v_pk_add_f32 v[24:25], v[24:25], v[84:85]
    v_pk_add_f32 v[26:27], v[26:27], v[86:87]
    v_cvt_pk_bf16_f32 v118, v24, v25
    v_cvt_pk_bf16_f32 v119, v26, v27
    buffer_store_dwordx2 v[118:119], v7, s[20:23], s11 offen
    v_mov_b32 v89, 0
    v_mov_b32 v90, 0
    v_lshlrev_b32 v5, 3, v5
    v_lshl_add_u32 v88, v4, 2, v5
    s_lshl_b32 s31, s57, 11
    s_lshl_b32 s29, s66, 7
    s_add_u32 s31, s31, s29
    s_add_u32 s31, s31, 1114112
    s_add_u32 s31, s31, s52
    v_dot2c_f32_bf16 v89, s28, v110
    v_dot2c_f32_bf16 v90, v110, v110
    v_dot2c_f32_bf16 v89, s28, v111
    v_dot2c_f32_bf16 v90, v111, v111
    v_dot2c_f32_bf16 v89, s28, v112
    v_dot2c_f32_bf16 v90, v112, v112
    v_dot2c_f32_bf16 v89, s28, v113
    v_dot2c_f32_bf16 v90, v113, v113
    v_dot2c_f32_bf16 v89, s28, v114
    v_dot2c_f32_bf16 v90, v114, v114
    v_dot2c_f32_bf16 v89, s28, v115
    v_dot2c_f32_bf16 v90, v115, v115
    v_dot2c_f32_bf16 v89, s28, v116
    v_dot2c_f32_bf16 v90, v116, v116
    v_dot2c_f32_bf16 v89, s28, v117
    v_dot2c_f32_bf16 v90, v117, v117
    v_dot2c_f32_bf16 v89, s28, v118
    v_dot2c_f32_bf16 v90, v118, v118
    v_dot2c_f32_bf16 v89, s28, v119
    v_dot2c_f32_bf16 v90, v119, v119
    s_lshl_b32 s48, s56, 8
    s_add_u32 s48, s48, s53
    s_lshl_b32 s10, s57, 5
    s_lshl_b32 s11, s58, 3
    v_permlane32_swap_b32 v89, v90
    s_add_u32 s10, s10, s11
    s_add_u32 s10, s10, s48
    v_add_f32 v89, v89, v90
    v_mov_b32 v90, v89
    s_nop 0
    s_nop 0
    v_permlane16_swap_b32 v89, v90
    s_nop 1
    v_add_f32 v89, v89, v90
    buffer_store_dword v89, v88, s[20:23], s31 offen
    v_lshlrev_b32 v8, 16, v110
    v_and_b32 v9, 0xffff0000, v110
    v_lshlrev_b32 v10, 16, v111
    v_and_b32 v11, 0xffff0000, v111
    v_lshlrev_b32 v12, 16, v112
    v_and_b32 v13, 0xffff0000, v112
    v_lshlrev_b32 v14, 16, v113
    v_and_b32 v15, 0xffff0000, v113
    v_lshlrev_b32 v16, 16, v114
    v_and_b32 v17, 0xffff0000, v114
    v_lshlrev_b32 v18, 16, v115
    v_and_b32 v19, 0xffff0000, v115
    v_lshlrev_b32 v20, 16, v116
    v_and_b32 v21, 0xffff0000, v116
    v_lshlrev_b32 v22, 16, v117
    v_and_b32 v23, 0xffff0000, v117
    v_lshlrev_b32 v24, 16, v118
    v_and_b32 v25, 0xffff0000, v118
    v_lshlrev_b32 v26, 16, v119
    v_and_b32 v27, 0xffff0000, v119
    v_mov_b32 v6, s98
    v_mov_b32 v7, s99
    v_mov_b32 v5, 0
    s_waitcnt vmcnt(0)
    s_mov_b64 exec, 1
    s_cmp_lg_u32 s54, 0
    s_cbranch_scc1 F_g2_slow
    buffer_store_dwordx2 v[6:7], v5, s[20:23], s10 offen
    s_branch F_g2_p0
F_g2_slow:
    buffer_wbl2 sc1
    s_waitcnt vmcnt(0)
    buffer_store_dwordx2 v[6:7], v5, s[20:23], s10 offen sc0 sc1
F_g2_p0:
    s_mov_b64 exec, -1
    s_add_u32 s10, s58, 0
    s_and_b32 s10, s10, 3
    s_mul_i32 s44, s10, 5120
    s_lshl_b32 s11, s56, 2
    s_add_u32 s10, s10, s11
    s_mul_i32 s10, s10, 49152
    s_mul_i32 s11, s24, 6144
    s_add_u32 s10, s10, s11
    s_add_u32 s28, s10, s52
    s_add_u32 s10, s58, 1
    s_and_b32 s10, s10, 3
    s_mul_i32 s45, s10, 5120
    s_lshl_b32 s11, s56, 2
    s_add_u32 s10, s10, s11
    s_mul_i32 s10, s10, 49152
    s_mul_i32 s11, s24, 6144
    s_add_u32 s10, s10, s11
    s_add_u32 s29, s10, s52
    s_add_u32 s10, s58, 2
    s_and_b32 s10, s10, 3
    s_mul_i32 s46, s10, 5120
    s_lshl_b32 s11, s56, 2
    s_add_u32 s10, s10, s11
    s_mul_i32 s10, s10, 49152
    s_mul_i32 s11, s24, 6144
    s_add_u32 s10, s10, s11
    s_add_u32 s30, s10, s52
    s_add_u32 s10, s58, 3
    s_and_b32 s10, s10, 3
    s_mul_i32 s47, s10, 5120
    s_lshl_b32 s11, s56, 2
    s_add_u32 s10, s10, s11
    s_mul_i32 s10, s10, 49152
    s_mul_i32 s11, s24, 6144
    s_add_u32 s10, s10, s11
    s_add_u32 s31, s10, s52
    v_and_b32 v7, 15, v2
    v_mul_u32_u24 v7, 320, v7
    v_lshrrev_b32 v5, 4, v2
    v_bfe_u32 v6, v2, 1, 2
    v_xor_b32 v5, v5, v6
    v_lshl_add_u32 v7, v5, 4, v7
    s_mul_i32 s10, s24, 20480
    v_add_u32 v7, s10, v7
    v_add_u32 v248, s44, v7
    v_add_u32 v249, s45, v7
    v_add_u32 v250, s46, v7
    v_add_u32 v251, s47, v7
    v_add_u32 v5, 0, v0
    v_mul_u32_u24 v6, 3277, v5
    v_lshrrev_b32 v6, 16, v6
    v_mul_u32_u24 v7, 20, v6
    v_sub_u32 v5, v5, v7
    v_bfe_u32 v1, v6, 1, 2
    v_xor_b32 v1, v1, v5
    v_mul_u32_u24 v7, 320, v6
    v_lshl_add_u32 v252, v1, 4, v7
    v_mul_u32_u24 v7, 1280, v6
    v_lshl_add_u32 v121, v5, 3, v7
    v_add_u32 v5, 512, v0
    v_mul_u32_u24 v6, 3277, v5
    v_lshrrev_b32 v6, 16, v6
    v_mul_u32_u24 v7, 20, v6
    v_sub_u32 v5, v5, v7
    v_bfe_u32 v1, v6, 1, 2
    v_xor_b32 v1, v1, v5
    v_mul_u32_u24 v7, 320, v6
    v_lshl_add_u32 v253, v1, 4, v7
    v_mul_u32_u24 v7, 1280, v6
    v_lshl_add_u32 v122, v5, 3, v7
    v_add_u32 v5, 1024, v0
    v_mul_u32_u24 v6, 3277, v5
    v_lshrrev_b32 v6, 16, v6
    v_mul_u32_u24 v7, 20, v6
    v_sub_u32 v5, v5, v7
    v_bfe_u32 v1, v6, 1, 2
    v_xor_b32 v1, v1, v5
    v_mul_u32_u24 v7, 320, v6
    v_lshl_add_u32 v254, v1, 4, v7
    v_mul_u32_u24 v7, 1280, v6
    v_lshl_add_u32 v123, v5, 3, v7
    s_barrier
    s_mul_i32 s10, s58, 30720
    s_add_u32 s65, s65, s10
    s_mul_i32 s67, s58, 10240
    s_add_u32 s67, s67, 122880
    s_mov_b32 s49, 10
F_b1:
    s_mov_b32 m0, s67
    s_add_u32 s67, s67, 1024
    buffer_load_dwordx4 v125, s[20:23], s65 offen sc1 lds
    s_add_u32 s65, s65, 1024
    s_sub_u32 s49, s49, 1
    s_cmp_lg_u32 s49, 0
    s_waitcnt vmcnt(2)
    s_cbranch_scc1 F_b1
    s_mul_i32 s67, s58, 20480
    s_mov_b32 s49, 5
    v_add_u32 v7, s67, v125
    s_add_u32 s50, s65, 10240
    buffer_load_dwordx4 v[28:31], v125, s[20:23], s50 offen offset:0 sc1
    s_waitcnt vmcnt(2)
    buffer_load_dwordx4 v[32:35], v125, s[20:23], s50 offen offset:1024 sc1
    s_waitcnt vmcnt(2)
    buffer_load_dwordx4 v[36:39], v125, s[20:23], s50 offen offset:2048 sc1
    s_waitcnt vmcnt(2)
    buffer_load_dwordx4 v[40:43], v125, s[20:23], s50 offen offset:3072 sc1
    s_add_u32 s50, s50, 4096
    s_waitcnt vmcnt(2)
    buffer_load_dwordx4 v[44:47], v125, s[20:23], s50 offen offset:0 sc1
    s_waitcnt vmcnt(2)
    buffer_load_dwordx4 v[48:51], v125, s[20:23], s50 offen offset:1024 sc1
    s_waitcnt vmcnt(2)
    buffer_load_dwordx4 v[52:55], v125, s[20:23], s50 offen offset:2048 sc1
    s_waitcnt vmcnt(2)
    buffer_load_dwordx4 v[56:59], v125, s[20:23], s50 offen offset:3072 sc1
    s_add_u32 s50, s50, 4096
    s_waitcnt vmcnt(2)
    buffer_load_dwordx4 v[60:63], v125, s[20:23], s50 offen offset:0 sc1
    s_waitcnt vmcnt(2)
    buffer_load_dwordx4 v[64:67], v125, s[20:23], s50 offen offset:1024 sc1
    s_waitcnt vmcnt(2)
    s_waitcnt vmcnt(0)
    s_barrier
F_b2:
    s_mov_b32 m0, s67
    s_add_u32 s67, s67, 2048
    buffer_load_dwordx4 v125, s[20:23], s65 offen sc1 lds
    buffer_load_dwordx4 v125, s[20:23], s65 offen offset:1024 sc1 lds
    s_add_u32 s65, s65, 2048
    s_sub_u32 s49, s49, 1
    s_cmp_lg_u32 s49, 0
    s_waitcnt vmcnt(2)
    s_cbranch_scc1 F_b2
    ds_write_b128 v7, v[28:31] offset:10240
    ds_write_b128 v7, v[32:35] offset:11264
    ds_write_b128 v7, v[36:39] offset:12288
    ds_write_b128 v7, v[40:43] offset:13312
    ds_write_b128 v7, v[44:47] offset:14336
    ds_write_b128 v7, v[48:51] offset:15360
    ds_write_b128 v7, v[52:55] offset:16384
    ds_write_b128 v7, v[56:59] offset:17408
    ds_write_b128 v7, v[60:63] offset:18432
    ds_write_b128 v7, v[64:67] offset:19456
    s_waitcnt vmcnt(0) lgkmcnt(0)
    s_setprio 1
    s_cmp_lg_u32 s24, 4
    s_cbranch_scc1 F_s3_done
    s_mov_b32 s11, 0x40000
F_s3_poll:
    buffer_load_dwordx2 v[6:7], v124, s[20:23], s48 offen offset:1024 sc1
    s_sub_u32 s11, s11, 1
    s_cmp_eq_u32 s11, 0
    s_cbranch_scc1 F_s3_got
    s_waitcnt vmcnt(0)
    v_cmp_ne_u64 vcc, s[98:99], v[6:7]
    s_cbranch_vccnz F_s3_poll
F_s3_got:
    s_cmp_eq_u32 s54, 0
    s_cbranch_scc1 F_s3_p1
    buffer_inv sc1
    s_waitcnt vmcnt(0)
F_s3_p1:
F_s3_done:
    s_barrier
F_e:
    buffer_load_dwordx4 v[48:51], v125, s[20:23], s28 offen offset:0 sc1
    buffer_load_dwordx4 v[52:55], v125, s[20:23], s28 offen offset:1024 sc1
    buffer_load_dwordx4 v[56:59], v125, s[20:23], s28 offen offset:2048 sc1
    buffer_load_dwordx4 v[60:63], v125, s[20:23], s28 offen offset:3072 sc1
    s_add_u32 s28, s28, 4096
    buffer_load_dwordx4 v[64:67], v125, s[20:23], s28 offen offset:0 sc1
    buffer_load_dwordx4 v[68:71], v125, s[20:23], s28 offen offset:1024 sc1
    s_waitcnt lgkmcnt(0)
    s_waitcnt vmcnt(5)
    v_mfma_f32_16x16x32_bf16 v[8:11], v[128:131], v[48:51], v[8:11]
    v_mfma_f32_16x16x32_bf16 v[12:15], v[132:135], v[48:51], v[12:15]
    buffer_load_dwordx4 v[72:75], v125, s[20:23], s29 offen offset:0 sc1
    v_mfma_f32_16x16x32_bf16 v[16:19], v[136:139], v[48:51], v[16:19]
    v_mfma_f32_16x16x32_bf16 v[20:23], v[140:143], v[48:51], v[20:23]
    buffer_load_dwordx4 v[76:79], v125, s[20:23], s29 offen offset:1024 sc1
    v_mfma_f32_16x16x32_bf16 v[24:27], v[144:147], v[48:51], v[24:27]
    s_waitcnt vmcnt(6)
    v_mfma_f32_16x16x32_bf16 v[8:11], v[148:151], v[52:55], v[8:11]
    v_mfma_f32_16x16x32_bf16 v[12:15], v[152:155], v[52:55], v[12:15]
    buffer_load_dwordx4 v[80:83], v125, s[20:23], s29 offen offset:2048 sc1
    v_mfma_f32_16x16x32_bf16 v[16:19], v[156:159], v[52:55], v[16:19]
    v_mfma_f32_16x16x32_bf16 v[20:23], v[160:163], v[52:55], v[20:23]
    buffer_load_dwordx4 v[84:87], v125, s[20:23], s29 offen offset:3072 sc1
    v_mfma_f32_16x16x32_bf16 v[24:27], v[164:167], v[52:55], v[24:27]
    s_waitcnt vmcnt(7)
    v_mfma_f32_16x16x32_bf16 v[8:11], v[168:171], v[56:59], v[8:11]
    v_mfma_f32_16x16x32_bf16 v[12:15], v[172:175], v[56:59], v[12:15]
    s_add_u32 s29, s29, 4096
    buffer_load_dwordx4 v[88:91], v125, s[20:23], s29 offen offset:0 sc1
    v_mfma_f32_16x16x32_bf16 v[16:19], v[176:179], v[56:59], v[16:19]
    v_mfma_f32_16x16x32_bf16 v[20:23], v[180:183], v[56:59], v[20:23]
    buffer_load_dwordx4 v[92:95], v125, s[20:23], s29 offen offset:1024 sc1
    v_mfma_f32_16x16x32_bf16 v[24:27], v[184:187], v[56:59], v[24:27]
    s_waitcnt vmcnt(8)
    v_mfma_f32_16x16x32_bf16 v[8:11], v[188:191], v[60:63], v[8:11]
    v_mfma_f32_16x16x32_bf16 v[12:15], v[192:195], v[60:63], v[12:15]
    buffer_load_dwordx4 v[96:99], v125, s[20:23], s30 offen offset:0 sc1
    v_mfma_f32_16x16x32_bf16 v[16:19], v[196:199], v[60:63], v[16:19]
    v_mfma_f32_16x16x32_bf16 v[20:23], v[200:203], v[60:63], v[20:23]
    buffer_load_dwordx4 v[100:103], v125, s[20:23], s30 offen offset:1024 sc1
    v_mfma_f32_16x16x32_bf16 v[24:27], v[204:207], v[60:63], v[24:27]
    s_waitcnt vmcnt(9)
    v_mfma_f32_16x16x32_bf16 v[8:11], v[208:211], v[64:67], v[8:11]
    v_mfma_f32_16x16x32_bf16 v[12:15], v[212:215], v[64:67], v[12:15]
    buffer_load_dwordx4 v[104:107], v125, s[20:23], s30 offen offset:2048 sc1
    v_mfma_f32_16x16x32_bf16 v[16:19], v[216:219], v[64:67], v[16:19]
    v_mfma_f32_16x16x32_bf16 v[20:23], v[220:223], v[64:67], v[20:23]
    buffer_load_dwordx4 v[108:111], v125, s[20:23], s30 offen offset:3072 sc1
    v_mfma_f32_16x16x32_bf16 v[24:27], v[224:227], v[64:67], v[24:27]
    s_waitcnt vmcnt(10)
    v_mfma_f32_16x16x32_bf16 v[8:11], v[228:231], v[68:71], v[8:11]
    v_mfma_f32_16x16x32_bf16 v[12:15], v[232:235], v[68:71], v[12:15]
    s_add_u32 s30, s30, 4096
    buffer_load_dwordx4 v[112:115], v125, s[20:23], s30 offen offset:0 sc1
    v_mfma_f32_16x16x32_bf16 v[16:19], v[236:239], v[68:71], v[16:19]
    v_mfma_f32_16x16x32_bf16 v[20:23], v[240:243], v[68:71], v[20:23]
    buffer_load_dwordx4 v[116:119], v125, s[20:23], s30 offen offset:1024 sc1
    v_mfma_f32_16x16x32_bf16 v[24:27], v[244:247], v[68:71], v[24:27]
    s_waitcnt vmcnt(11)
    v_mfma_f32_16x16x32_bf16 v[28:31], v[128:131], v[72:75], 0
    v_mfma_f32_16x16x32_bf16 v[32:35], v[132:135], v[72:75], 0
    buffer_load_dwordx4 v[48:51], v125, s[20:23], s31 offen offset:0 sc1
    v_mfma_f32_16x16x32_bf16 v[36:39], v[136:139], v[72:75], 0
    v_mfma_f32_16x16x32_bf16 v[40:43], v[140:143], v[72:75], 0
    buffer_load_dwordx4 v[52:55], v125, s[20:23], s31 offen offset:1024 sc1
    v_mfma_f32_16x16x32_bf16 v[44:47], v[144:147], v[72:75], 0
    s_waitcnt vmcnt(12)
    v_mfma_f32_16x16x32_bf16 v[28:31], v[148:151], v[76:79], v[28:31]
    v_mfma_f32_16x16x32_bf16 v[32:35], v[152:155], v[76:79], v[32:35]
    buffer_load_dwordx4 v[56:59], v125, s[20:23], s31 offen offset:2048 sc1
    v_mfma_f32_16x16x32_bf16 v[36:39], v[156:159], v[76:79], v[36:39]
    v_mfma_f32_16x16x32_bf16 v[40:43], v[160:163], v[76:79], v[40:43]
    buffer_load_dwordx4 v[60:63], v125, s[20:23], s31 offen offset:3072 sc1
    v_mfma_f32_16x16x32_bf16 v[44:47], v[164:167], v[76:79], v[44:47]
    ds_write_b128 v248, v[8:11] offset:0
    s_waitcnt vmcnt(13)
    v_mfma_f32_16x16x32_bf16 v[28:31], v[168:171], v[80:83], v[28:31]
    v_mfma_f32_16x16x32_bf16 v[32:35], v[172:175], v[80:83], v[32:35]
    s_add_u32 s31, s31, 4096
    buffer_load_dwordx4 v[64:67], v125, s[20:23], s31 offen offset:0 sc1
    v_mfma_f32_16x16x32_bf16 v[36:39], v[176:179], v[80:83], v[36:39]
    v_mfma_f32_16x16x32_bf16 v[40:43], v[180:183], v[80:83], v[40:43]
    v_mfma_f32_16x16x32_bf16 v[44:47], v[184:187], v[80:83], v[44:47]
    ds_write_b128 v248, v[12:15] offset:64
    s_waitcnt vmcnt(13)
    v_mfma_f32_16x16x32_bf16 v[28:31], v[188:191], v[84:87], v[28:31]
    v_mfma_f32_16x16x32_bf16 v[32:35], v[192:195], v[84:87], v[32:35]
    buffer_load_dwordx4 v[68:71], v125, s[20:23], s31 offen offset:1024 sc1
    v_mfma_f32_16x16x32_bf16 v[36:39], v[196:199], v[84:87], v[36:39]
    v_mfma_f32_16x16x32_bf16 v[40:43], v[200:203], v[84:87], v[40:43]
    v_mfma_f32_16x16x32_bf16 v[44:47], v[204:207], v[84:87], v[44:47]
    ds_write_b128 v248, v[16:19] offset:128
    s_waitcnt vmcnt(13)
    v_mfma_f32_16x16x32_bf16 v[28:31], v[208:211], v[88:91], v[28:31]
    v_mfma_f32_16x16x32_bf16 v[32:35], v[212:215], v[88:91], v[32:35]
    v_mfma_f32_16x16x32_bf16 v[36:39], v[216:219], v[88:91], v[36:39]
    v_mfma_f32_16x16x32_bf16 v[40:43], v[220:223], v[88:91], v[40:43]
    v_mfma_f32_16x16x32_bf16 v[44:47], v[224:227], v[88:91], v[44:47]
    ds_write_b128 v248, v[20:23] offset:192
    s_waitcnt vmcnt(12)
    v_mfma_f32_16x16x32_bf16 v[28:31], v[228:231], v[92:95], v[28:31]
    v_mfma_f32_16x16x32_bf16 v[32:35], v[232:235], v[92:95], v[32:35]
    v_mfma_f32_16x16x32_bf16 v[36:39], v[236:239], v[92:95], v[36:39]
    v_mfma_f32_16x16x32_bf16 v[40:43], v[240:243], v[92:95], v[40:43]
    v_mfma_f32_16x16x32_bf16 v[44:47], v[244:247], v[92:95], v[44:47]
    ds_write_b128 v248, v[24:27] offset:256
    s_waitcnt vmcnt(11)
    v_mfma_f32_16x16x32_bf16 v[8:11], v[128:131], v[96:99], 0
    v_mfma_f32_16x16x32_bf16 v[12:15], v[132:135], v[96:99], 0
    v_mfma_f32_16x16x32_bf16 v[16:19], v[136:139], v[96:99], 0
    v_mfma_f32_16x16x32_bf16 v[20:23], v[140:143], v[96:99], 0
    v_mfma_f32_16x16x32_bf16 v[24:27], v[144:147], v[96:99], 0
    s_waitcnt vmcnt(10)
    v_mfma_f32_16x16x32_bf16 v[8:11], v[148:151], v[100:103], v[8:11]
    v_mfma_f32_16x16x32_bf16 v[12:15], v[152:155], v[100:103], v[12:15]
    v_mfma_f32_16x16x32_bf16 v[16:19], v[156:159], v[100:103], v[16:19]
    v_mfma_f32_16x16x32_bf16 v[20:23], v[160:163], v[100:103], v[20:23]
    v_mfma_f32_16x16x32_bf16 v[24:27], v[164:167], v[100:103], v[24:27]
    ds_write_b128 v249, v[28:31] offset:0
    s_waitcnt vmcnt(9)
    v_mfma_f32_16x16x32_bf16 v[8:11], v[168:171], v[104:107], v[8:11]
    v_mfma_f32_16x16x32_bf16 v[12:15], v[172:175], v[104:107], v[12:15]
    v_mfma_f32_16x16x32_bf16 v[16:19], v[176:179], v[104:107], v[16:19]
    v_mfma_f32_16x16x32_bf16 v[20:23], v[180:183], v[104:107], v[20:23]
    v_mfma_f32_16x16x32_bf16 v[24:27], v[184:187], v[104:107], v[24:27]
    ds_write_b128 v249, v[32:35] offset:64
    s_waitcnt vmcnt(8)
    v_mfma_f32_16x16x32_bf16 v[8:11], v[188:191], v[108:111], v[8:11]
    v_mfma_f32_16x16x32_bf16 v[12:15], v[192:195], v[108:111], v[12:15]
    v_mfma_f32_16x16x32_bf16 v[16:19], v[196:199], v[108:111], v[16:19]
    v_mfma_f32_16x16x32_bf16 v[20:23], v[200:203], v[108:111], v[20:23]
    v_mfma_f32_16x16x32_bf16 v[24:27], v[204:207], v[108:111], v[24:27]
    ds_write_b128 v249, v[36:39] offset:128
    s_waitcnt vmcnt(7)
    v_mfma_f32_16x16x32_bf16 v[8:11], v[208:211], v[112:115], v[8:11]
    v_mfma_f32_16x16x32_bf16 v[12:15], v[212:215], v[112:115], v[12:15]
    v_mfma_f32_16x16x32_bf16 v[16:19], v[216:219], v[112:115], v[16:19]
    v_mfma_f32_16x16x32_bf16 v[20:23], v[220:223], v[112:115], v[20:23]
    v_mfma_f32_16x16x32_bf16 v[24:27], v[224:227], v[112:115], v[24:27]
    ds_write_b128 v249, v[40:43] offset:192
    s_waitcnt vmcnt(6)
    v_mfma_f32_16x16x32_bf16 v[8:11], v[228:231], v[116:119], v[8:11]
    v_mfma_f32_16x16x32_bf16 v[12:15], v[232:235], v[116:119], v[12:15]
    v_mfma_f32_16x16x32_bf16 v[16:19], v[236:239], v[116:119], v[16:19]
    v_mfma_f32_16x16x32_bf16 v[20:23], v[240:243], v[116:119], v[20:23]
    v_mfma_f32_16x16x32_bf16 v[24:27], v[244:247], v[116:119], v[24:27]
    ds_write_b128 v249, v[44:47] offset:256
    s_waitcnt vmcnt(5)
    v_mfma_f32_16x16x32_bf16 v[28:31], v[128:131], v[48:51], 0
    v_mfma_f32_16x16x32_bf16 v[32:35], v[132:135], v[48:51], 0
    v_mfma_f32_16x16x32_bf16 v[36:39], v[136:139], v[48:51], 0
    v_mfma_f32_16x16x32_bf16 v[40:43], v[140:143], v[48:51], 0
    v_mfma_f32_16x16x32_bf16 v[44:47], v[144:147], v[48:51], 0
    s_waitcnt vmcnt(4)
    v_mfma_f32_16x16x32_bf16 v[28:31], v[148:151], v[52:55], v[28:31]
    v_mfma_f32_16x16x32_bf16 v[32:35], v[152:155], v[52:55], v[32:35]
    v_mfma_f32_16x16x32_bf16 v[36:39], v[156:159], v[52:55], v[36:39]
    v_mfma_f32_16x16x32_bf16 v[40:43], v[160:163], v[52:55], v[40:43]
    v_mfma_f32_16x16x32_bf16 v[44:47], v[164:167], v[52:55], v[44:47]
    ds_write_b128 v250, v[8:11] offset:0
    s_waitcnt vmcnt(3)
    v_mfma_f32_16x16x32_bf16 v[28:31], v[168:171], v[56:59], v[28:31]
    v_mfma_f32_16x16x32_bf16 v[32:35], v[172:175], v[56:59], v[32:35]
    v_mfma_f32_16x16x32_bf16 v[36:39], v[176:179], v[56:59], v[36:39]
    v_mfma_f32_16x16x32_bf16 v[40:43], v[180:183], v[56:59], v[40:43]
    v_mfma_f32_16x16x32_bf16 v[44:47], v[184:187], v[56:59], v[44:47]
    ds_write_b128 v250, v[12:15] offset:64
    s_waitcnt vmcnt(2)
    v_mfma_f32_16x16x32_bf16 v[28:31], v[188:191], v[60:63], v[28:31]
    v_mfma_f32_16x16x32_bf16 v[32:35], v[192:195], v[60:63], v[32:35]
    v_mfma_f32_16x16x32_bf16 v[36:39], v[196:199], v[60:63], v[36:39]
    v_mfma_f32_16x16x32_bf16 v[40:43], v[200:203], v[60:63], v[40:43]
    v_mfma_f32_16x16x32_bf16 v[44:47], v[204:207], v[60:63], v[44:47]
    ds_write_b128 v250, v[16:19] offset:128
    s_waitcnt vmcnt(1)
    v_mfma_f32_16x16x32_bf16 v[28:31], v[208:211], v[64:67], v[28:31]
    v_mfma_f32_16x16x32_bf16 v[32:35], v[212:215], v[64:67], v[32:35]
    v_mfma_f32_16x16x32_bf16 v[36:39], v[216:219], v[64:67], v[36:39]
    v_mfma_f32_16x16x32_bf16 v[40:43], v[220:223], v[64:67], v[40:43]
    v_mfma_f32_16x16x32_bf16 v[44:47], v[224:227], v[64:67], v[44:47]
    ds_write_b128 v250, v[20:23] offset:192
    s_waitcnt vmcnt(0)
    v_mfma_f32_16x16x32_bf16 v[28:31], v[228:231], v[68:71], v[28:31]
    v_mfma_f32_16x16x32_bf16 v[32:35], v[232:235], v[68:71], v[32:35]
    v_mfma_f32_16x16x32_bf16 v[36:39], v[236:239], v[68:71], v[36:39]
    v_mfma_f32_16x16x32_bf16 v[40:43], v[240:243], v[68:71], v[40:43]
    v_mfma_f32_16x16x32_bf16 v[44:47], v[244:247], v[68:71], v[44:47]
    ds_write_b128 v250, v[24:27] offset:256
    s_setprio 0
    v_add_u32 v48, 61440, v252
    v_add_u32 v49, 122880, v252
    v_add_u32 v50, 61440, v253
    v_add_u32 v51, 122880, v253
    v_add_u32 v52, 61440, v254
    v_add_u32 v53, 122880, v254
    s_nop 1
    ds_write_b128 v251, v[28:31] offset:0
    ds_write_b128 v251, v[32:35] offset:64
    ds_write_b128 v251, v[36:39] offset:128
    ds_write_b128 v251, v[40:43] offset:192
    ds_write_b128 v251, v[44:47] offset:256
    s_waitcnt lgkmcnt(0)
    s_barrier
    ds_read_b128 v[128:131], v252 offset:0
    ds_read_b128 v[132:135], v252 offset:20480
    ds_read_b128 v[136:139], v252 offset:40960
    ds_read_b128 v[140:143], v48 offset:0
    ds_read_b128 v[144:147], v48 offset:20480
    ds_read_b128 v[148:151], v48 offset:40960
    ds_read_b128 v[152:155], v49 offset:0
    ds_read_b128 v[156:159], v49 offset:20480
    s_waitcnt lgkmcnt(1)
    ds_read_b128 v[160:163], v253 offset:0
    ds_read_b128 v[164:167], v253 offset:20480
    ds_read_b128 v[168:171], v253 offset:40960
    ds_read_b128 v[172:175], v50 offset:0
    ds_read_b128 v[176:179], v50 offset:20480
    ds_read_b128 v[180:183], v50 offset:40960
    ds_read_b128 v[184:187], v51 offset:0
    ds_read_b128 v[188:191], v51 offset:20480
    s_waitcnt lgkmcnt(8)
    v_pk_add_f32 v[128:129], v[128:129], v[144:145]
    v_pk_add_f32 v[130:131], v[130:131], v[146:147]
    v_pk_add_f32 v[132:133], v[132:133], v[148:149]
    v_pk_add_f32 v[134:135], v[134:135], v[150:151]
    v_pk_add_f32 v[136:137], v[136:137], v[152:153]
    v_pk_add_f32 v[138:139], v[138:139], v[154:155]
    v_pk_add_f32 v[140:141], v[140:141], v[156:157]
    v_pk_add_f32 v[142:143], v[142:143], v[158:159]
    v_pk_add_f32 v[128:129], v[128:129], v[136:137]
    v_pk_add_f32 v[130:131], v[130:131], v[138:139]
    v_pk_add_f32 v[132:133], v[132:133], v[140:141]
    v_pk_add_f32 v[134:135], v[134:135], v[142:143]
    v_pk_add_f32 v[128:129], v[128:129], v[132:133]
    v_pk_add_f32 v[130:131], v[130:131], v[134:135]
    v_cvt_pk_bf16_f32 v128, v128, v129
    v_cvt_pk_bf16_f32 v129, v130, v131
    buffer_store_dwordx2 v[128:129], v121, s[40:43], s69 offen
    s_cmp_ge_u32 s24, 4
    s_cbranch_scc1 F_f1
    s_waitcnt lgkmcnt(1)
    ds_read_b128 v[192:195], v254 offset:0
    ds_read_b128 v[196:199], v254 offset:20480
    ds_read_b128 v[200:203], v254 offset:40960
    ds_read_b128 v[204:207], v52 offset:0
    ds_read_b128 v[208:211], v52 offset:20480
    ds_read_b128 v[212:215], v52 offset:40960
    ds_read_b128 v[216:219], v53 offset:0
    ds_read_b128 v[220:223], v53 offset:20480
    s_waitcnt lgkmcnt(8)
    v_pk_add_f32 v[160:161], v[160:161], v[176:177]
    v_pk_add_f32 v[162:163], v[162:163], v[178:179]
    v_pk_add_f32 v[164:165], v[164:165], v[180:181]
    v_pk_add_f32 v[166:167], v[166:167], v[182:183]
    v_pk_add_f32 v[168:169], v[168:169], v[184:185]
    v_pk_add_f32 v[170:171], v[170:171], v[186:187]
    v_pk_add_f32 v[172:173], v[172:173], v[188:189]
    v_pk_add_f32 v[174:175], v[174:175], v[190:191]
    v_pk_add_f32 v[160:161], v[160:161], v[168:169]
    v_pk_add_f32 v[162:163], v[162:163], v[170:171]
    v_pk_add_f32 v[164:165], v[164:165], v[172:173]
    v_pk_add_f32 v[166:167], v[166:167], v[174:175]
    v_pk_add_f32 v[160:161], v[160:161], v[164:165]
    v_pk_add_f32 v[162:163], v[162:163], v[166:167]
    v_cvt_pk_bf16_f32 v160, v160, v161
    v_cvt_pk_bf16_f32 v161, v162, v163
    buffer_store_dwordx2 v[160:161], v122, s[40:43], s69 offen
    s_waitcnt lgkmcnt(0)
    v_pk_add_f32 v[192:193], v[192:193], v[208:209]
    v_pk_add_f32 v[194:195], v[194:195], v[210:211]
    v_pk_add_f32 v[196:197], v[196:197], v[212:213]
    v_pk_add_f32 v[198:199], v[198:199], v[214:215]
    v_pk_add_f32 v[200:201], v[200:201], v[216:217]
    v_pk_add_f32 v[202:203], v[202:203], v[218:219]
    v_pk_add_f32 v[204:205], v[204:205], v[220:221]
    v_pk_add_f32 v[206:207], v[206:207], v[222:223]
    v_pk_add_f32 v[192:193], v[192:193], v[200:201]
    v_pk_add_f32 v[194:195], v[194:195], v[202:203]
    v_pk_add_f32 v[196:197], v[196:197], v[204:205]
    v_pk_add_f32 v[198:199], v[198:199], v[206:207]
    v_pk_add_f32 v[192:193], v[192:193], v[196:197]
    v_pk_add_f32 v[194:195], v[194:195], v[198:199]
    v_cvt_pk_bf16_f32 v192, v192, v193
    v_cvt_pk_bf16_f32 v193, v194, v195
    buffer_store_dwordx2 v[192:193], v123, s[40:43], s69 offen
    s_branch F_fin
F_f1:
    s_waitcnt lgkmcnt(0)
    v_pk_add_f32 v[160:161], v[160:161], v[176:177]
    v_pk_add_f32 v[162:163], v[162:163], v[178:179]
    v_pk_add_f32 v[164:165], v[164:165], v[180:181]
    v_pk_add_f32 v[166:167], v[166:167], v[182:183]
    v_pk_add_f32 v[168:169], v[168:169], v[184:185]
    v_pk_add_f32 v[170:171], v[170:171], v[186:187]
    v_pk_add_f32 v[172:173], v[172:173], v[188:189]
    v_pk_add_f32 v[174:175], v[174:175], v[190:191]
    v_pk_add_f32 v[160:161], v[160:161], v[168:169]
    v_pk_add_f32 v[162:163], v[162:163], v[170:171]
    v_pk_add_f32 v[164:165], v[164:165], v[172:173]
    v_pk_add_f32 v[166:167], v[166:167], v[174:175]
    v_pk_add_f32 v[160:161], v[160:161], v[164:165]
    v_pk_add_f32 v[162:163], v[162:163], v[166:167]
    v_cvt_pk_bf16_f32 v160, v160, v161
    v_cvt_pk_bf16_f32 v161, v162, v163
    buffer_store_dwordx2 v[160:161], v122, s[40:43], s69 offen
F_fin:
F_end:
    s_endpgm
F_slow:
    v_lshlrev_b32 v41, 3, v3
    v_add_u32 v41, 1024, v41
    v_subrev_u32 v42, 133120, v42
    v_mov_b32 v5, 0xff800000
    s_mov_b32 s31, 0
    s_mov_b32 s10, s29
    v_mov_b32 v96, 0
    v_mov_b32 v97, 0
    v_mov_b32 v98, 0
    v_mov_b32 v99, 0
    v_mov_b32 v100, 0
    v_mov_b32 v101, 0
    v_mov_b32 v102, 0
    v_mov_b32 v103, 0
    v_mov_b32 v104, 0
    v_mov_b32 v105, 0
    v_mov_b32 v106, 0
    v_mov_b32 v107, 0
    v_mov_b32 v108, 0
    v_mov_b32 v109, 0
    v_mov_b32 v110, 0
    v_mov_b32 v111, 0
F_sloop:
    buffer_load_dwordx4 v[44:47], v125, s[20:23], s10 offen sc1
    buffer_load_dwordx2 v[20:21], v41, s[20:23], s10 offen sc1
    s_mov_b64 exec, s[32:33]
    buffer_load_dwordx4 v[24:27], v42, s[20:23], s10 offen sc1
    buffer_load_dwordx4 v[28:31], v42, s[20:23], s10 offen offset:640 sc1
    s_mov_b64 exec, -1
    s_waitcnt vmcnt(0)
    v_mfma_f32_32x32x16_bf16 v[64:79], v[44:47], v[8:11], 0
    v_mfma_f32_32x32x8_bf16 v[64:79], v[20:21], v[12:13], v[64:79]
    s_nop 11
    v_max3_f32 v6, v64, v65, v5
    v_max3_f32 v6, v66, v67, v6
    v_max3_f32 v6, v68, v69, v6
    v_max3_f32 v6, v70, v71, v6
    v_max3_f32 v6, v72, v73, v6
    v_max3_f32 v6, v74, v75, v6
    v_max3_f32 v6, v76, v77, v6
    v_max3_f32 v6, v78, v79, v6
    v_mov_b32 v7, v6
    s_nop 1
    v_permlane32_swap_b32 v6, v7
    s_nop 1
    v_max_f32 v6, v6, v7
    v_sub_f32 v7, v5, v6
    v_exp_f32 v7, v7
    v_mov_b32 v5, v6
    v_mul_f32 v96, v96, v7
    v_mul_f32 v97, v97, v7
    v_mul_f32 v98, v98, v7
    v_mul_f32 v99, v99, v7
    v_mul_f32 v100, v100, v7
    v_mul_f32 v101, v101, v7
    v_mul_f32 v102, v102, v7
    v_mul_f32 v103, v103, v7
    v_mul_f32 v104, v104, v7
    v_mul_f32 v105, v105, v7
    v_mul_f32 v106, v106, v7
    v_mul_f32 v107, v107, v7
    v_mul_f32 v108, v108, v7
    v_mul_f32 v109, v109, v7
    v_mul_f32 v110, v110, v7
    v_mul_f32 v111, v111, v7
    v_sub_f32 v64, v64, v6
    v_sub_f32 v65, v65, v6
    v_sub_f32 v66, v66, v6
    v_sub_f32 v67, v67, v6
    v_sub_f32 v68, v68, v6
    v_sub_f32 v69, v69, v6
    v_sub_f32 v70, v70, v6
    v_sub_f32 v71, v71, v6
    v_sub_f32 v72, v72, v6
    v_sub_f32 v73, v73, v6
    v_sub_f32 v74, v74, v6
    v_sub_f32 v75, v75, v6
    v_sub_f32 v76, v76, v6
    v_sub_f32 v77, v77, v6
    v_sub_f32 v78, v78, v6
    v_sub_f32 v79, v79, v6
    v_exp_f32 v64, v64
    v_exp_f32 v65, v65
    v_exp_f32 v66, v66
    v_exp_f32 v67, v67
    v_exp_f32 v68, v68
    v_exp_f32 v69, v69
    v_exp_f32 v70, v70
    v_exp_f32 v71, v71
    v_exp_f32 v72, v72
    v_exp_f32 v73, v73
    v_exp_f32 v74, v74
    v_exp_f32 v75, v75
    v_exp_f32 v76, v76
    v_exp_f32 v77, v77
    v_exp_f32 v78, v78
    v_exp_f32 v79, v79
    s_nop 0
    v_cvt_pk_bf16_f32 v32, v64, v65
    v_cvt_pk_bf16_f32 v33, v66, v67
    v_cvt_pk_bf16_f32 v34, v68, v69
    v_cvt_pk_bf16_f32 v35, v70, v71
    v_cvt_pk_bf16_f32 v36, v72, v73
    v_cvt_pk_bf16_f32 v37, v74, v75
    v_cvt_pk_bf16_f32 v38, v76, v77
    v_cvt_pk_bf16_f32 v39, v78, v79
    s_nop 1
    v_mfma_f32_32x32x16_bf16 v[96:111], v[24:27], v[32:35], v[96:111]
    v_mfma_f32_32x32x16_bf16 v[96:111], v[28:31], v[36:39], v[96:111]
    s_add_u32 s10, s10, 2560
    s_add_u32 s31, s31, 1
    s_cmp_lt_u32 s31, 64
    s_nop 8
    s_cbranch_scc1 F_sloop
    s_nop 3
    s_branch F_out
F_kend:
.section .rodata,"a"
.p2align 6
.amdhsa_kernel sequential_preLN__softmax_full_mha__geglu_ffn__prompt_kernel
  .amdhsa_next_free_vgpr 256
  .amdhsa_next_free_sgpr 102
  .amdhsa_accum_offset 256
  .amdhsa_group_segment_fixed_size 0
  .amdhsa_kernarg_size 80
  .amdhsa_user_sgpr_count 2
  .amdhsa_user_sgpr_kernarg_segment_ptr 1
  .amdhsa_system_sgpr_workgroup_id_x 1
  .amdhsa_float_denorm_mode_32 3
  .amdhsa_float_denorm_mode_16_64 3
.end_amdhsa_kernel
```
